```python
import torch

def _softmax(x, axis=-1):
    return torch.softmax(x, dim=axis)
def _gelu(x):
    return torch.nn.functional.gelu(x, approximate="tanh")
def _silu(x):
    return torch.nn.functional.silu(x)
def _sigmoid(x):
    return torch.sigmoid(x)
def _layernorm(x, axis=-1, eps=1e-5):
    m = x.mean(dim=axis, keepdim=True)
    v = x.var(dim=axis, keepdim=True, unbiased=False)
    return (x - m) / torch.sqrt(v + eps)
def _scatter_add(tgt, idx, src, axis=0):
    return tgt.clone().index_add_(axis, idx, src)
def _segment_sum(src, seg, n):
    out = torch.zeros((n,) + src.shape[1:], dtype=src.dtype)
    return out.index_add_(0, seg, src)
def _pad(x, pw):
    flat = tuple(v for pair in reversed(pw) for v in pair)
    return torch.nn.functional.pad(x, flat)

kernel_name = 'recurrent_scan__ssm_conv_h3__mixer_s_mlp__prompt'

def setup_inputs():

    _w = (lambda a: (lambda t: t.to(torch.bfloat16) if t.is_floating_point() else t)(torch.as_tensor(a)))
    def _A_setup():
        B, S, D = 1, 2048, 576
        ks = 4
        return {
            "q": _w((lambda *s: torch.randn(*s, dtype=torch.bfloat16) * 0.05)(B, S, D)),
            "k": _w((lambda *s: torch.randn(*s, dtype=torch.bfloat16) * 0.2)(B, S, D)),
            "v": _w((lambda *s: torch.randn(*s, dtype=torch.bfloat16) * 0.2)(B, S, D)),
            "shift_k": _w((lambda *s: torch.randn(*s, dtype=torch.bfloat16) * 0.2)(D, ks) * 0.5),
            "ssm_k": _w((lambda *s: torch.randn(*s, dtype=torch.bfloat16) * 0.2)(D, S) * (1.0 / S ** 0.5)),
            "ssm_D": _w((lambda *s: torch.randn(*s, dtype=torch.bfloat16) * 0.2)(D)),
        }
    _A_in = _A_setup()

    def _B_setup():
        B, S, D, F = 1, 2048, 576, 4608
        return {
            "x":  _w((lambda *s: torch.randn(*s, dtype=torch.bfloat16) * 0.05)(B, S, D)),
            "w1": _w((lambda *s: torch.randn(*s, dtype=torch.bfloat16) * 3.2)(D, D) * (D ** -0.5)),
            "w2": _w((lambda *s: torch.randn(*s, dtype=torch.bfloat16) * 3.2)(D, D) * (D ** -0.5)),
            "w3": _w((lambda *s: torch.randn(*s, dtype=torch.bfloat16) * 3.2)(D, F) * (D ** -0.5)),
            "w4": _w((lambda *s: torch.randn(*s, dtype=torch.bfloat16) * 3.2)(F, D) * (F ** -0.5)),
        }
    _B_in = _B_setup()

    return {
        "A_q": _A_in["q"],
        "A_k": _A_in["k"],
        "A_v": _A_in["v"],
        "A_shift_k": _A_in["shift_k"],
        "A_ssm_k": _A_in["ssm_k"],
        "A_ssm_D": _A_in["ssm_D"],
        "B_x": _B_in["x"],
        "B_w1": _B_in["w1"],
        "B_w2": _B_in["w2"],
        "B_w3": _B_in["w3"],
        "B_w4": _B_in["w4"],
    }

def reference(A_q, A_k, A_v, A_shift_k, A_ssm_k, A_ssm_D, B_x, B_w1, B_w2, B_w3, B_w4):
    def _A_ref(q, k, v, shift_k, ssm_k, ssm_D):
        B, S, D = q.shape
        ks = shift_k.shape[-1]
        k_pad = _pad(k, ((0, 0), (ks - 1, 0), (0, 0)))
        k_shift = torch.zeros_like(k)
        for t in range(ks):
            k_shift = k_shift + k_pad[:, t:t + S, :] * shift_k[:, ks - 1 - t][None, None, :]
        kv = k_shift * v
        L = 2 * S
        kv_pad = _pad(kv, ((0, 0), (0, S), (0, 0)))
        kf_pad = _pad(ssm_k, ((0, 0), (0, S)))
        kv_f = (lambda x, axes=(-2,-1): torch.fft.rfft2(x.float(), dim=axes))(kv_pad[:, None, :, :], axes=(1, 2))
        kf_f = (lambda x, axes=(-2,-1): torch.fft.rfft2(x.float(), dim=axes))(kf_pad[:, None, :], axes=(1, 2))
        kf_f = (lambda x, *d: x.permute(*d))(kf_f, 1, 2, 0)
        y_f = kv_f * kf_f[None, :, :, :]
        y = (lambda x, s, axes=(-2,-1): torch.fft.irfft2(x, s=s, dim=axes).to(torch.bfloat16))(y_f, (1, L), axes=(1, 2))[:, 0, :S, :]
        y = y + kv * ssm_D[None, None, :]
        return q * y

    def _B_ref(x, w1, w2, w3, w4):
        B, S, D = x.shape
        h = _gelu(_layernorm(x, axis=-1) @ w1)
        c = D // 4
        g0 = _pad(h[:, :, 0*c:1*c], ((0, 0), (1, 0), (0, 0)))[:, :S, :]
        g1 = _pad(h[:, :, 1*c:2*c], ((0, 0), (0, 1), (0, 0)))[:, 1:, :]
        g2 = _pad(h[:, :, 2*c:3*c], ((0, 0), (2, 0), (0, 0)))[:, :S, :]
        g3 = _pad(h[:, :, 3*c:   ], ((0, 0), (0, 2), (0, 0)))[:, 2:, :]
        hs = torch.concatenate([g0, g1, g2, g3], axis=-1) @ w2
        x1 = x + hs
        h2 = _gelu(_layernorm(x1, axis=-1) @ w3) @ w4
        return x1 + h2

    x = A_q
    xn = _layernorm(x, axis=-1)
    s = _A_ref(xn, A_k, A_v, A_shift_k, A_ssm_k, A_ssm_D)
    g = _silu(_B_ref(xn, B_w1, B_w2, B_w3, B_w4))
    return x + s * g
```

```asm
; @launch grid=(256,1,1) block=(256,1,1) lds=163840
.amdgcn_target "amdgcn-amd-amdhsa--gfx950"
.text
.globl recurrent_scan__ssm_conv_h3__mixer_s_mlp__prompt_kernel
.p2align 8
.type recurrent_scan__ssm_conv_h3__mixer_s_mlp__prompt_kernel,@function
recurrent_scan__ssm_conv_h3__mixer_s_mlp__prompt_kernel:
KSTART:
    s_load_dwordx2 s[8:9], s[0:1], 0
    s_load_dwordx4 s[60:63], s[0:1], 56
    s_load_dwordx4 s[40:43], s[0:1], 32
    s_cmp_ge_u32 s2, 256
    s_cbranch_scc1 K_end
    s_load_dwordx2 s[28:29], s[0:1], 104
    s_load_dwordx2 s[16:17], s[0:1], 104
    s_load_dwordx2 s[100:101], s[0:1], 96
    s_getpc_b64 s[6:7]
    s_lshr_b32 s3, s2, 3
    v_mul_u32_u24 v1, 18, v0
    v_lshrrev_b32 v1, 8, v1
    s_mul_i32 s3, s3, 18
    v_add_lshl_u32 v1, s3, v1, 7
    v_min_u32 v1, KEND - KSTART - 256, v1
    global_load_dword v255, v1, s[6:7]
    v_lshrrev_b32 v1, 6, v0
    v_and_b32 v0, 63, v0
    v_readfirstlane_b32 s23, v1
    s_mov_b32 s18, 46006272
    s_mov_b32 s19, 0x20000
    s_cmp_ge_u32 s2, 144
    s_cbranch_scc1 K_side
    s_and_b32 s20, s2, 7
    s_lshl_b32 s20, s20, 1
    s_bfe_u32 s24, s2, 0x10003
    s_add_u32 s20, s20, s24
    s_lshr_b32 s21, s2, 4
    s_mul_i32 s24, s24, 1
    s_and_b32 s22, s2, 7
    s_mul_i32 s22, s22, 2
    s_add_u32 s22, s22, s24
    s_add_u32 s22, s22, s21
    s_mul_i32 s24, s22, 57
    s_lshr_b32 s24, s24, 9
    s_mul_i32 s24, s24, 9
    s_sub_u32 s22, s22, s24
    s_lshl_b32 s30, s20, 2
    s_add_u32 s30, s30, s23
    s_mul_i32 s26, s30, 36864
    s_mul_i32 s27, s23, 18432
    s_lshl_b32 s24, s21, 7
    s_add_u32 s27, s27, s24
    s_lshl_b32 s56, s23, 12
    s_add_u32 s56, s56, 8192
    s_lshl_b32 s57, s23, 11
    s_and_b32 s31, s23, 2
    s_and_b32 s32, s23, 1
    v_lshrrev_b32 v1, 3, v0
    v_mul_u32_u24 v1, 1152, v1
    v_and_b32 v2, 7, v0
    v_lshrrev_b32 v3, 4, v0
    v_xor_b32 v220, v2, v3
    v_lshl_add_u32 v220, v220, 4, v1
    v_xor_b32 v221, 64, v220
    v_add_u32 v221, 9216, v221
    v_add_u32 v222, 18432, v220
    v_add_u32 v223, 18432, v221
    v_lshlrev_b32 v216, 1, v3
    v_xor_b32 v216, v2, v216
    v_lshl_add_u32 v216, v216, 4, v1
    v_and_b32 v3, 1, v3
    v_lshlrev_b32 v3, 1, v3
    v_xor_b32 v224, v2, v3
    v_lshl_add_u32 v224, v224, 4, v1
    v_xor_b32 v225, 64, v224
    v_add_u32 v225, 9216, v225
    v_add_u32 v217, 9216, v216
    s_mov_b32 s10, 2359296
    s_mov_b32 s11, 0x20000
    s_mov_b32 s14, 663552
    s_mov_b32 s15, 0x20000
    s_waitcnt lgkmcnt(0)
    s_mov_b32 s12, s60
    s_mov_b32 s13, s61
    s_mul_i32 s25, s22, 73728
    s_add_u32 s25, s25, s27
    s_add_u32 m0, s57, 0
    s_lshl_b32 s24, s22, 7
    buffer_load_dwordx4 v224, s[12:15], s25 offen  lds
    s_add_u32 m0, s57, 1024
    s_add_u32 s24, s24, s26
    buffer_load_dwordx4 v225, s[12:15], s25 offen  lds
    s_add_u32 m0, s56, 0
    s_add_u32 s22, s22, 1
    buffer_load_dwordx4 v220, s[8:11], s24 offen  lds
    s_add_u32 m0, s56, 1024
    s_cmp_eq_u32 s22, 9
    s_cselect_b32 s22, 0, s22
    buffer_load_dwordx4 v221, s[8:11], s24 offen  lds
    s_add_u32 m0, s56, 2048
    s_nop 0
    buffer_load_dwordx4 v222, s[8:11], s24 offen  lds
    s_add_u32 m0, s56, 3072
    s_nop 0
    buffer_load_dwordx4 v223, s[8:11], s24 offen  lds
    s_barrier
    s_mul_i32 s25, s22, 73728
    s_add_u32 s25, s25, s27
    s_add_u32 m0, s57, 24576
    s_lshl_b32 s24, s22, 7
    buffer_load_dwordx4 v224, s[12:15], s25 offen  lds
    s_add_u32 m0, s57, 25600
    s_add_u32 s24, s24, s26
    buffer_load_dwordx4 v225, s[12:15], s25 offen  lds
    s_add_u32 m0, s56, 24576
    s_add_u32 s22, s22, 1
    buffer_load_dwordx4 v220, s[8:11], s24 offen  lds
    s_add_u32 m0, s56, 25600
    s_cmp_eq_u32 s22, 9
    s_cselect_b32 s22, 0, s22
    buffer_load_dwordx4 v221, s[8:11], s24 offen  lds
    s_add_u32 m0, s56, 26624
    s_nop 0
    buffer_load_dwordx4 v222, s[8:11], s24 offen  lds
    s_add_u32 m0, s56, 27648
    s_nop 0
    buffer_load_dwordx4 v223, s[8:11], s24 offen  lds
    s_lshl_b32 s44, s23, 10
    v_lshl_add_u32 v252, v0, 4, s44
    v_subrev_u32 v3, 16, v252
    s_lshr_b32 s52, s2, 2
    s_lshl_b32 s52, s52, 4
    s_and_b32 s53, s2, 3
    s_add_u32 s52, s52, s53
    s_add_u32 s52, s52, 12
    s_lshl_b32 s53, s52, 12
    s_lshl_b32 s52, s52, 1
    s_mov_b32 s46, 4096
    s_mov_b32 s47, 0x20000
    s_mov_b32 s50, 1152
    s_mov_b32 s51, 0x20000
    s_waitcnt lgkmcnt(0)
    s_add_u32 s44, s40, s53
    s_addc_u32 s45, s41, 0
    s_mov_b32 s48, s42
    s_mov_b32 s49, s43
    buffer_load_dwordx4 v[176:179], v3, s[44:47], 0 offen nt
    buffer_load_dwordx4 v[180:183], v252, s[44:47], 0 offen nt
    buffer_load_ushort v253, off, s[48:51], s52
    v_lshlrev_b32 v212, 4, v0
    v_and_b32 v1, 15, v0
    v_lshrrev_b32 v2, 4, v0
    s_lshl_b32 s24, s32, 2
    v_add_u32 v3, s24, v2
    v_lshrrev_b32 v226, 1, v1
    v_xor_b32 v3, v3, v226
    v_lshlrev_b32 v3, 4, v3
    v_lshl_add_u32 v3, v1, 7, v3
    v_add_u32 v226, s56, v3
    v_xor_b32 v227, 64, v226
    s_lshl_b32 s24, s30, 5
    v_add_u32 v214, s24, v1
    v_lshrrev_b32 v3, 2, v1
    v_lshl_add_u32 v213, v3, 4, v1
    v_lshlrev_b32 v213, 2, v213
    v_lshl_add_u32 v204, v2, 3, v3
    v_lshlrev_b32 v204, 7, v204
    v_lshrrev_b32 v3, 1, v3
    v_and_b32 v205, 1, v2
    v_lshl_add_u32 v3, v205, 1, v3
    v_xor_b32 v3, s31, v3
    v_lshl_add_u32 v204, v3, 5, v204
    v_and_b32 v3, 3, v0
    v_lshl_add_u32 v204, v3, 3, v204
    s_lshl_b32 s24, s32, 12
    v_add_u32 v204, s24, v204
    s_lshl_b32 s24, s31, 6
    s_add_u32 s24, s24, 147456
    v_lshl_add_u32 v218, v2, 4, s24
    v_xor_b32 v219, 128, v218
    v_xor_b32 v205, 32, v204
    v_xor_b32 v206, 64, v204
    v_xor_b32 v207, 96, v204
    v_xor_b32 v208, 4096, v204
    v_xor_b32 v209, 4096, v205
    v_xor_b32 v210, 4096, v206
    v_xor_b32 v211, 4096, v207
    v_mov_b32 v200, 0x3f803f80
    v_mov_b32 v201, 0x3f803f80
    v_mov_b32 v202, 0x3f803f80
    v_mov_b32 v203, 0x3f803f80
    v_mov_b32 v172, 0xc0135761
    v_mov_b32 v173, 0xc0135761
    v_mov_b32 v174, 0xbdd2d3e8
    v_mov_b32 v175, 0xbdd2d3e8
    s_movk_i32 s33, 18432
    s_lshl_b32 s65, s21, 2
    v_and_b32 v3, 48, v0
    s_xor_b32 s64, s31, 0
    s_add_u32 s64, s64, s65
    s_lshl_b32 s58, s64, 9
    v_lshl_add_u32 v232, v3, 4, s58
    s_mul_i32 s64, s64, 57
    s_lshr_b32 s64, s64, 7
    s_and_b32 s64, s64, 12
    s_lshr_b32 s64, 0x0413, s64
    s_and_b32 s64, s64, 15
    s_sub_u32 s34, s64, 2
    s_xor_b32 s64, s31, 1
    s_add_u32 s64, s64, s65
    s_mul_i32 s64, s64, 57
    s_lshr_b32 s64, s64, 7
    s_and_b32 s64, s64, 12
    s_lshr_b32 s64, 0x0413, s64
    s_and_b32 s64, s64, 15
    s_sub_u32 s35, s64, 2
    s_xor_b32 s64, s31, 2
    s_add_u32 s64, s64, s65
    s_lshl_b32 s58, s64, 9
    v_lshl_add_u32 v233, v3, 4, s58
    s_mul_i32 s64, s64, 57
    s_lshr_b32 s64, s64, 7
    s_and_b32 s64, s64, 12
    s_lshr_b32 s64, 0x0413, s64
    s_and_b32 s64, s64, 15
    s_sub_u32 s36, s64, 2
    s_xor_b32 s64, s31, 3
    s_add_u32 s64, s64, s65
    s_mul_i32 s64, s64, 57
    s_lshr_b32 s64, s64, 7
    s_and_b32 s64, s64, 12
    s_lshr_b32 s64, 0x0413, s64
    s_and_b32 s64, s64, 15
    s_sub_u32 s37, s64, 2
    s_add_u32 s64, s34, 0
    v_add_u32 v1, s64, v214
    v_and_b32 v1, 0x7ff, v1
    v_lshrrev_b32 v2, 4, v1
    v_and_b32 v1, 15, v1
    v_mad_u32_u24 v2, v2, s33, v232
    v_lshl_add_u32 v228, v1, 4, v2
    s_add_u32 s64, s34, 16
    v_add_u32 v1, s64, v214
    v_and_b32 v1, 0x7ff, v1
    v_lshrrev_b32 v2, 4, v1
    v_and_b32 v1, 15, v1
    v_mad_u32_u24 v2, v2, s33, v232
    v_lshl_add_u32 v230, v1, 4, v2
    s_add_u32 s64, s36, 0
    v_add_u32 v1, s64, v214
    v_and_b32 v1, 0x7ff, v1
    v_lshrrev_b32 v2, 4, v1
    v_and_b32 v1, 15, v1
    v_mad_u32_u24 v2, v2, s33, v233
    v_lshl_add_u32 v229, v1, 4, v2
    s_add_u32 s64, s36, 16
    v_add_u32 v1, s64, v214
    v_and_b32 v1, 0x7ff, v1
    v_lshrrev_b32 v2, 4, v1
    v_and_b32 v1, 15, v1
    v_mad_u32_u24 v2, v2, s33, v233
    v_lshl_add_u32 v231, v1, 4, v2
    s_waitcnt vmcnt(9)
    s_barrier
    ds_read_b128 v[4:7], v226 offset:0
    ds_read_b128 v[8:11], v226 offset:2048
    ds_read_b64_tr_b16 v[20:21], v204 offset:0
    ds_read_b64_tr_b16 v[22:23], v204 offset:512
    ds_read_b64_tr_b16 v[24:25], v205 offset:0
    ds_read_b64_tr_b16 v[26:27], v205 offset:512
    ds_read_b64_tr_b16 v[28:29], v206 offset:0
    ds_read_b64_tr_b16 v[30:31], v206 offset:512
    ds_read_b64_tr_b16 v[32:33], v207 offset:0
    ds_read_b64_tr_b16 v[34:35], v207 offset:512
    s_waitcnt lgkmcnt(0)
    v_mfma_f32_16x16x32_bf16 v[84:87], v[200:203], v[4:7], 0
    ds_read_b128 v[12:15], v227 offset:0
    ds_read_b128 v[16:19], v227 offset:2048
    v_mfma_f32_16x16x32_bf16 v[92:95], v[4:7], v[4:7], 0
    s_mul_i32 s25, s22, 73728
    s_add_u32 s25, s25, s27
    s_add_u32 m0, s57, 49152
    s_lshl_b32 s24, s22, 7
    v_mfma_f32_16x16x32_bf16 v[88:91], v[200:203], v[8:11], 0
    buffer_load_dwordx4 v224, s[12:15], s25 offen  lds
    v_mfma_f32_16x16x32_bf16 v[96:99], v[8:11], v[8:11], 0
    ds_read_b64_tr_b16 v[36:37], v208 offset:0
    ds_read_b64_tr_b16 v[38:39], v208 offset:512
    v_mfma_f32_16x16x32_bf16 v[100:103], v[20:23], v[200:203], 0
    ds_read_b64_tr_b16 v[40:41], v209 offset:0
    ds_read_b64_tr_b16 v[42:43], v209 offset:512
    v_mfma_f32_16x16x32_bf16 v[104:107], v[24:27], v[200:203], 0
    s_add_u32 m0, s57, 50176
    s_add_u32 s24, s24, s26
    v_mfma_f32_16x16x32_bf16 v[52:55], v[20:23], v[4:7], 0
    buffer_load_dwordx4 v225, s[12:15], s25 offen  lds
    v_mfma_f32_16x16x32_bf16 v[68:71], v[20:23], v[8:11], 0
    ds_read_b64_tr_b16 v[44:45], v210 offset:0
    ds_read_b64_tr_b16 v[46:47], v210 offset:512
    v_mfma_f32_16x16x32_bf16 v[56:59], v[24:27], v[4:7], 0
    ds_read_b64_tr_b16 v[48:49], v211 offset:0
    ds_read_b64_tr_b16 v[50:51], v211 offset:512
    v_mfma_f32_16x16x32_bf16 v[72:75], v[24:27], v[8:11], 0
    s_add_u32 m0, s56, 49152
    s_add_u32 s22, s22, 1
    v_mfma_f32_16x16x32_bf16 v[60:63], v[28:31], v[4:7], 0
    buffer_load_dwordx4 v220, s[8:11], s24 offen  lds
    v_mfma_f32_16x16x32_bf16 v[76:79], v[28:31], v[8:11], 0
    v_mfma_f32_16x16x32_bf16 v[64:67], v[32:35], v[4:7], 0
    v_mfma_f32_16x16x32_bf16 v[80:83], v[32:35], v[8:11], 0
    s_add_u32 m0, s56, 50176
    s_cmp_eq_u32 s22, 9
    s_cselect_b32 s22, 0, s22
    buffer_load_dwordx4 v221, s[8:11], s24 offen  lds
    s_add_u32 m0, s56, 51200
    s_nop 0
    buffer_load_dwordx4 v222, s[8:11], s24 offen  lds
    s_add_u32 m0, s56, 52224
    s_nop 0
    buffer_load_dwordx4 v223, s[8:11], s24 offen  lds
    s_waitcnt vmcnt(9) lgkmcnt(0)
    s_barrier
    v_mfma_f32_16x16x32_bf16 v[84:87], v[200:203], v[12:15], v[84:87]
    ds_read_b128 v[4:7], v226 offset:24576
    ds_read_b128 v[8:11], v226 offset:26624
    v_mfma_f32_16x16x32_bf16 v[92:95], v[12:15], v[12:15], v[92:95]
    s_mul_i32 s25, s22, 73728
    s_add_u32 s25, s25, s27
    s_add_u32 m0, s57, 0
    s_lshl_b32 s24, s22, 7
    v_mfma_f32_16x16x32_bf16 v[88:91], v[200:203], v[16:19], v[88:91]
    buffer_load_dwordx4 v224, s[12:15], s25 offen  lds
    v_mfma_f32_16x16x32_bf16 v[96:99], v[16:19], v[16:19], v[96:99]
    ds_read_b64_tr_b16 v[20:21], v204 offset:24576
    ds_read_b64_tr_b16 v[22:23], v204 offset:25088
    v_mfma_f32_16x16x32_bf16 v[52:55], v[36:39], v[12:15], v[52:55]
    ds_read_b64_tr_b16 v[24:25], v205 offset:24576
    ds_read_b64_tr_b16 v[26:27], v205 offset:25088
    v_mfma_f32_16x16x32_bf16 v[68:71], v[36:39], v[16:19], v[68:71]
    s_add_u32 m0, s57, 1024
    s_add_u32 s24, s24, s26
    v_mfma_f32_16x16x32_bf16 v[56:59], v[40:43], v[12:15], v[56:59]
    buffer_load_dwordx4 v225, s[12:15], s25 offen  lds
    v_mfma_f32_16x16x32_bf16 v[72:75], v[40:43], v[16:19], v[72:75]
    ds_read_b64_tr_b16 v[28:29], v206 offset:24576
    ds_read_b64_tr_b16 v[30:31], v206 offset:25088
    v_mfma_f32_16x16x32_bf16 v[60:63], v[44:47], v[12:15], v[60:63]
    ds_read_b64_tr_b16 v[32:33], v207 offset:24576
    ds_read_b64_tr_b16 v[34:35], v207 offset:25088
    v_mfma_f32_16x16x32_bf16 v[76:79], v[44:47], v[16:19], v[76:79]
    s_add_u32 m0, s56, 0
    s_add_u32 s22, s22, 1
    v_mfma_f32_16x16x32_bf16 v[64:67], v[48:51], v[12:15], v[64:67]
    buffer_load_dwordx4 v220, s[8:11], s24 offen  lds
    v_mfma_f32_16x16x32_bf16 v[80:83], v[48:51], v[16:19], v[80:83]
    s_waitcnt lgkmcnt(0)
    v_mfma_f32_16x16x32_bf16 v[84:87], v[200:203], v[4:7], v[84:87]
    ds_read_b128 v[12:15], v227 offset:24576
    ds_read_b128 v[16:19], v227 offset:26624
    v_mfma_f32_16x16x32_bf16 v[92:95], v[4:7], v[4:7], v[92:95]
    s_add_u32 m0, s56, 1024
    s_cmp_eq_u32 s22, 9
    s_cselect_b32 s22, 0, s22
    v_mfma_f32_16x16x32_bf16 v[88:91], v[200:203], v[8:11], v[88:91]
    buffer_load_dwordx4 v221, s[8:11], s24 offen  lds
    v_mfma_f32_16x16x32_bf16 v[96:99], v[8:11], v[8:11], v[96:99]
    ds_read_b64_tr_b16 v[36:37], v208 offset:24576
    ds_read_b64_tr_b16 v[38:39], v208 offset:25088
    v_mfma_f32_16x16x32_bf16 v[100:103], v[20:23], v[200:203], v[100:103]
    ds_read_b64_tr_b16 v[40:41], v209 offset:24576
    ds_read_b64_tr_b16 v[42:43], v209 offset:25088
    v_mfma_f32_16x16x32_bf16 v[104:107], v[24:27], v[200:203], v[104:107]
    s_add_u32 m0, s56, 2048
    ds_read_b64_tr_b16 v[44:45], v210 offset:24576
    v_mfma_f32_16x16x32_bf16 v[52:55], v[20:23], v[4:7], v[52:55]
    buffer_load_dwordx4 v222, s[8:11], s24 offen  lds
    v_mfma_f32_16x16x32_bf16 v[68:71], v[20:23], v[8:11], v[68:71]
    ds_read_b64_tr_b16 v[46:47], v210 offset:25088
    ds_read_b64_tr_b16 v[48:49], v211 offset:24576
    v_mfma_f32_16x16x32_bf16 v[56:59], v[24:27], v[4:7], v[56:59]
    ds_read_b64_tr_b16 v[50:51], v211 offset:25088
    v_mfma_f32_16x16x32_bf16 v[72:75], v[24:27], v[8:11], v[72:75]
    s_add_u32 m0, s56, 3072
    v_mfma_f32_16x16x32_bf16 v[60:63], v[28:31], v[4:7], v[60:63]
    buffer_load_dwordx4 v223, s[8:11], s24 offen  lds
    v_mfma_f32_16x16x32_bf16 v[76:79], v[28:31], v[8:11], v[76:79]
    v_mfma_f32_16x16x32_bf16 v[64:67], v[32:35], v[4:7], v[64:67]
    v_mfma_f32_16x16x32_bf16 v[80:83], v[32:35], v[8:11], v[80:83]
    s_waitcnt vmcnt(6) lgkmcnt(0)
    s_barrier
    v_mfma_f32_16x16x32_bf16 v[84:87], v[200:203], v[12:15], v[84:87]
    ds_read_b128 v[4:7], v226 offset:49152
    ds_read_b128 v[8:11], v226 offset:51200
    v_mfma_f32_16x16x32_bf16 v[92:95], v[12:15], v[12:15], v[92:95]
    s_mul_i32 s25, s22, 73728
    s_add_u32 s25, s25, s27
    s_add_u32 m0, s57, 24576
    s_lshl_b32 s24, s22, 7
    v_mfma_f32_16x16x32_bf16 v[88:91], v[200:203], v[16:19], v[88:91]
    buffer_load_dwordx4 v224, s[12:15], s25 offen  lds
    v_mfma_f32_16x16x32_bf16 v[96:99], v[16:19], v[16:19], v[96:99]
    ds_read_b64_tr_b16 v[20:21], v204 offset:49152
    ds_read_b64_tr_b16 v[22:23], v204 offset:49664
    v_mfma_f32_16x16x32_bf16 v[52:55], v[36:39], v[12:15], v[52:55]
    ds_read_b64_tr_b16 v[24:25], v205 offset:49152
    ds_read_b64_tr_b16 v[26:27], v205 offset:49664
    v_mfma_f32_16x16x32_bf16 v[68:71], v[36:39], v[16:19], v[68:71]
    s_add_u32 m0, s57, 25600
    s_add_u32 s24, s24, s26
    v_mfma_f32_16x16x32_bf16 v[56:59], v[40:43], v[12:15], v[56:59]
    buffer_load_dwordx4 v225, s[12:15], s25 offen  lds
    v_mfma_f32_16x16x32_bf16 v[72:75], v[40:43], v[16:19], v[72:75]
    ds_read_b64_tr_b16 v[28:29], v206 offset:49152
    ds_read_b64_tr_b16 v[30:31], v206 offset:49664
    v_mfma_f32_16x16x32_bf16 v[60:63], v[44:47], v[12:15], v[60:63]
    ds_read_b64_tr_b16 v[32:33], v207 offset:49152
    ds_read_b64_tr_b16 v[34:35], v207 offset:49664
    v_mfma_f32_16x16x32_bf16 v[76:79], v[44:47], v[16:19], v[76:79]
    s_add_u32 m0, s56, 24576
    s_add_u32 s22, s22, 1
    v_mfma_f32_16x16x32_bf16 v[64:67], v[48:51], v[12:15], v[64:67]
    buffer_load_dwordx4 v220, s[8:11], s24 offen  lds
    v_mfma_f32_16x16x32_bf16 v[80:83], v[48:51], v[16:19], v[80:83]
    s_waitcnt lgkmcnt(0)
    v_mfma_f32_16x16x32_bf16 v[84:87], v[200:203], v[4:7], v[84:87]
    ds_read_b128 v[12:15], v227 offset:49152
    ds_read_b128 v[16:19], v227 offset:51200
    v_mfma_f32_16x16x32_bf16 v[92:95], v[4:7], v[4:7], v[92:95]
    s_add_u32 m0, s56, 25600
    s_cmp_eq_u32 s22, 9
    s_cselect_b32 s22, 0, s22
    v_mfma_f32_16x16x32_bf16 v[88:91], v[200:203], v[8:11], v[88:91]
    buffer_load_dwordx4 v221, s[8:11], s24 offen  lds
    v_mfma_f32_16x16x32_bf16 v[96:99], v[8:11], v[8:11], v[96:99]
    ds_read_b64_tr_b16 v[36:37], v208 offset:49152
    ds_read_b64_tr_b16 v[38:39], v208 offset:49664
    v_mfma_f32_16x16x32_bf16 v[100:103], v[20:23], v[200:203], v[100:103]
    ds_read_b64_tr_b16 v[40:41], v209 offset:49152
    ds_read_b64_tr_b16 v[42:43], v209 offset:49664
    v_mfma_f32_16x16x32_bf16 v[104:107], v[24:27], v[200:203], v[104:107]
    s_add_u32 m0, s56, 26624
    ds_read_b64_tr_b16 v[44:45], v210 offset:49152
    v_mfma_f32_16x16x32_bf16 v[52:55], v[20:23], v[4:7], v[52:55]
    buffer_load_dwordx4 v222, s[8:11], s24 offen  lds
    v_mfma_f32_16x16x32_bf16 v[68:71], v[20:23], v[8:11], v[68:71]
    ds_read_b64_tr_b16 v[46:47], v210 offset:49664
    ds_read_b64_tr_b16 v[48:49], v211 offset:49152
    v_mfma_f32_16x16x32_bf16 v[56:59], v[24:27], v[4:7], v[56:59]
    ds_read_b64_tr_b16 v[50:51], v211 offset:49664
    v_mfma_f32_16x16x32_bf16 v[72:75], v[24:27], v[8:11], v[72:75]
    s_add_u32 m0, s56, 27648
    v_mfma_f32_16x16x32_bf16 v[60:63], v[28:31], v[4:7], v[60:63]
    buffer_load_dwordx4 v223, s[8:11], s24 offen  lds
    v_mfma_f32_16x16x32_bf16 v[76:79], v[28:31], v[8:11], v[76:79]
    v_mfma_f32_16x16x32_bf16 v[64:67], v[32:35], v[4:7], v[64:67]
    v_mfma_f32_16x16x32_bf16 v[80:83], v[32:35], v[8:11], v[80:83]
    s_waitcnt vmcnt(6) lgkmcnt(0)
    s_barrier
    v_mfma_f32_16x16x32_bf16 v[84:87], v[200:203], v[12:15], v[84:87]
    ds_read_b128 v[4:7], v226 offset:0
    ds_read_b128 v[8:11], v226 offset:2048
    v_mfma_f32_16x16x32_bf16 v[92:95], v[12:15], v[12:15], v[92:95]
    s_mul_i32 s25, s22, 73728
    s_add_u32 s25, s25, s27
    s_add_u32 m0, s57, 49152
    s_lshl_b32 s24, s22, 7
    v_mfma_f32_16x16x32_bf16 v[88:91], v[200:203], v[16:19], v[88:91]
    buffer_load_dwordx4 v224, s[12:15], s25 offen  lds
    v_mfma_f32_16x16x32_bf16 v[96:99], v[16:19], v[16:19], v[96:99]
    ds_read_b64_tr_b16 v[20:21], v204 offset:0
    ds_read_b64_tr_b16 v[22:23], v204 offset:512
    v_mfma_f32_16x16x32_bf16 v[52:55], v[36:39], v[12:15], v[52:55]
    ds_read_b64_tr_b16 v[24:25], v205 offset:0
    ds_read_b64_tr_b16 v[26:27], v205 offset:512
    v_mfma_f32_16x16x32_bf16 v[68:71], v[36:39], v[16:19], v[68:71]
    s_add_u32 m0, s57, 50176
    s_add_u32 s24, s24, s26
    v_mfma_f32_16x16x32_bf16 v[56:59], v[40:43], v[12:15], v[56:59]
    buffer_load_dwordx4 v225, s[12:15], s25 offen  lds
    v_mfma_f32_16x16x32_bf16 v[72:75], v[40:43], v[16:19], v[72:75]
    ds_read_b64_tr_b16 v[28:29], v206 offset:0
    ds_read_b64_tr_b16 v[30:31], v206 offset:512
    v_mfma_f32_16x16x32_bf16 v[60:63], v[44:47], v[12:15], v[60:63]
    ds_read_b64_tr_b16 v[32:33], v207 offset:0
    ds_read_b64_tr_b16 v[34:35], v207 offset:512
    v_mfma_f32_16x16x32_bf16 v[76:79], v[44:47], v[16:19], v[76:79]
    s_add_u32 m0, s56, 49152
    s_add_u32 s22, s22, 1
    v_mfma_f32_16x16x32_bf16 v[64:67], v[48:51], v[12:15], v[64:67]
    buffer_load_dwordx4 v220, s[8:11], s24 offen  lds
    v_mfma_f32_16x16x32_bf16 v[80:83], v[48:51], v[16:19], v[80:83]
    s_waitcnt lgkmcnt(0)
    v_mfma_f32_16x16x32_bf16 v[84:87], v[200:203], v[4:7], v[84:87]
    ds_read_b128 v[12:15], v227 offset:0
    ds_read_b128 v[16:19], v227 offset:2048
    v_mfma_f32_16x16x32_bf16 v[92:95], v[4:7], v[4:7], v[92:95]
    s_add_u32 m0, s56, 50176
    s_cmp_eq_u32 s22, 9
    s_cselect_b32 s22, 0, s22
    v_mfma_f32_16x16x32_bf16 v[88:91], v[200:203], v[8:11], v[88:91]
    buffer_load_dwordx4 v221, s[8:11], s24 offen  lds
    v_mfma_f32_16x16x32_bf16 v[96:99], v[8:11], v[8:11], v[96:99]
    ds_read_b64_tr_b16 v[36:37], v208 offset:0
    ds_read_b64_tr_b16 v[38:39], v208 offset:512
    v_mfma_f32_16x16x32_bf16 v[100:103], v[20:23], v[200:203], v[100:103]
    ds_read_b64_tr_b16 v[40:41], v209 offset:0
    ds_read_b64_tr_b16 v[42:43], v209 offset:512
    v_mfma_f32_16x16x32_bf16 v[104:107], v[24:27], v[200:203], v[104:107]
    s_add_u32 m0, s56, 51200
    ds_read_b64_tr_b16 v[44:45], v210 offset:0
    v_mfma_f32_16x16x32_bf16 v[52:55], v[20:23], v[4:7], v[52:55]
    buffer_load_dwordx4 v222, s[8:11], s24 offen  lds
    v_mfma_f32_16x16x32_bf16 v[68:71], v[20:23], v[8:11], v[68:71]
    ds_read_b64_tr_b16 v[46:47], v210 offset:512
    ds_read_b64_tr_b16 v[48:49], v211 offset:0
    v_mfma_f32_16x16x32_bf16 v[56:59], v[24:27], v[4:7], v[56:59]
    ds_read_b64_tr_b16 v[50:51], v211 offset:512
    v_mfma_f32_16x16x32_bf16 v[72:75], v[24:27], v[8:11], v[72:75]
    s_add_u32 m0, s56, 52224
    v_mfma_f32_16x16x32_bf16 v[60:63], v[28:31], v[4:7], v[60:63]
    buffer_load_dwordx4 v223, s[8:11], s24 offen  lds
    v_mfma_f32_16x16x32_bf16 v[76:79], v[28:31], v[8:11], v[76:79]
    v_mfma_f32_16x16x32_bf16 v[64:67], v[32:35], v[4:7], v[64:67]
    v_mfma_f32_16x16x32_bf16 v[80:83], v[32:35], v[8:11], v[80:83]
    s_waitcnt vmcnt(6) lgkmcnt(0)
    s_barrier
    v_mfma_f32_16x16x32_bf16 v[84:87], v[200:203], v[12:15], v[84:87]
    ds_read_b128 v[4:7], v226 offset:24576
    ds_read_b128 v[8:11], v226 offset:26624
    v_mfma_f32_16x16x32_bf16 v[92:95], v[12:15], v[12:15], v[92:95]
    s_mul_i32 s25, s22, 73728
    s_add_u32 s25, s25, s27
    s_add_u32 m0, s57, 0
    s_lshl_b32 s24, s22, 7
    v_mfma_f32_16x16x32_bf16 v[88:91], v[200:203], v[16:19], v[88:91]
    buffer_load_dwordx4 v224, s[12:15], s25 offen  lds
    v_mfma_f32_16x16x32_bf16 v[96:99], v[16:19], v[16:19], v[96:99]
    ds_read_b64_tr_b16 v[20:21], v204 offset:24576
    ds_read_b64_tr_b16 v[22:23], v204 offset:25088
    v_mfma_f32_16x16x32_bf16 v[52:55], v[36:39], v[12:15], v[52:55]
    ds_read_b64_tr_b16 v[24:25], v205 offset:24576
    ds_read_b64_tr_b16 v[26:27], v205 offset:25088
    v_mfma_f32_16x16x32_bf16 v[68:71], v[36:39], v[16:19], v[68:71]
    s_add_u32 m0, s57, 1024
    s_add_u32 s24, s24, s26
    v_mfma_f32_16x16x32_bf16 v[56:59], v[40:43], v[12:15], v[56:59]
    buffer_load_dwordx4 v225, s[12:15], s25 offen  lds
    v_mfma_f32_16x16x32_bf16 v[72:75], v[40:43], v[16:19], v[72:75]
    ds_read_b64_tr_b16 v[28:29], v206 offset:24576
    ds_read_b64_tr_b16 v[30:31], v206 offset:25088
    v_mfma_f32_16x16x32_bf16 v[60:63], v[44:47], v[12:15], v[60:63]
    ds_read_b64_tr_b16 v[32:33], v207 offset:24576
    ds_read_b64_tr_b16 v[34:35], v207 offset:25088
    v_mfma_f32_16x16x32_bf16 v[76:79], v[44:47], v[16:19], v[76:79]
    s_add_u32 m0, s56, 0
    s_add_u32 s22, s22, 1
    v_mfma_f32_16x16x32_bf16 v[64:67], v[48:51], v[12:15], v[64:67]
    buffer_load_dwordx4 v220, s[8:11], s24 offen  lds
    v_mfma_f32_16x16x32_bf16 v[80:83], v[48:51], v[16:19], v[80:83]
    s_waitcnt lgkmcnt(0)
    v_mfma_f32_16x16x32_bf16 v[84:87], v[200:203], v[4:7], v[84:87]
    ds_read_b128 v[12:15], v227 offset:24576
    ds_read_b128 v[16:19], v227 offset:26624
    v_mfma_f32_16x16x32_bf16 v[92:95], v[4:7], v[4:7], v[92:95]
    s_add_u32 m0, s56, 1024
    s_cmp_eq_u32 s22, 9
    s_cselect_b32 s22, 0, s22
    v_mfma_f32_16x16x32_bf16 v[88:91], v[200:203], v[8:11], v[88:91]
    buffer_load_dwordx4 v221, s[8:11], s24 offen  lds
    v_mfma_f32_16x16x32_bf16 v[96:99], v[8:11], v[8:11], v[96:99]
    ds_read_b64_tr_b16 v[36:37], v208 offset:24576
    ds_read_b64_tr_b16 v[38:39], v208 offset:25088
    v_mfma_f32_16x16x32_bf16 v[100:103], v[20:23], v[200:203], v[100:103]
    ds_read_b64_tr_b16 v[40:41], v209 offset:24576
    ds_read_b64_tr_b16 v[42:43], v209 offset:25088
    v_mfma_f32_16x16x32_bf16 v[104:107], v[24:27], v[200:203], v[104:107]
    s_add_u32 m0, s56, 2048
    ds_read_b64_tr_b16 v[44:45], v210 offset:24576
    v_mfma_f32_16x16x32_bf16 v[52:55], v[20:23], v[4:7], v[52:55]
    buffer_load_dwordx4 v222, s[8:11], s24 offen  lds
    v_mfma_f32_16x16x32_bf16 v[68:71], v[20:23], v[8:11], v[68:71]
    ds_read_b64_tr_b16 v[46:47], v210 offset:25088
    ds_read_b64_tr_b16 v[48:49], v211 offset:24576
    v_mfma_f32_16x16x32_bf16 v[56:59], v[24:27], v[4:7], v[56:59]
    ds_read_b64_tr_b16 v[50:51], v211 offset:25088
    v_mfma_f32_16x16x32_bf16 v[72:75], v[24:27], v[8:11], v[72:75]
    s_add_u32 m0, s56, 3072
    v_mfma_f32_16x16x32_bf16 v[60:63], v[28:31], v[4:7], v[60:63]
    buffer_load_dwordx4 v223, s[8:11], s24 offen  lds
    v_mfma_f32_16x16x32_bf16 v[76:79], v[28:31], v[8:11], v[76:79]
    v_mfma_f32_16x16x32_bf16 v[64:67], v[32:35], v[4:7], v[64:67]
    v_mfma_f32_16x16x32_bf16 v[80:83], v[32:35], v[8:11], v[80:83]
    s_waitcnt vmcnt(6) lgkmcnt(0)
    s_barrier
    v_mfma_f32_16x16x32_bf16 v[84:87], v[200:203], v[12:15], v[84:87]
    ds_read_b128 v[4:7], v226 offset:49152
    ds_read_b128 v[8:11], v226 offset:51200
    v_mfma_f32_16x16x32_bf16 v[92:95], v[12:15], v[12:15], v[92:95]
    s_mul_i32 s25, s22, 73728
    s_add_u32 s25, s25, s27
    s_add_u32 m0, s57, 24576
    s_lshl_b32 s24, s22, 7
    v_mfma_f32_16x16x32_bf16 v[88:91], v[200:203], v[16:19], v[88:91]
    buffer_load_dwordx4 v224, s[12:15], s25 offen  lds
    v_mfma_f32_16x16x32_bf16 v[96:99], v[16:19], v[16:19], v[96:99]
    ds_read_b64_tr_b16 v[20:21], v204 offset:49152
    ds_read_b64_tr_b16 v[22:23], v204 offset:49664
    v_mfma_f32_16x16x32_bf16 v[52:55], v[36:39], v[12:15], v[52:55]
    ds_read_b64_tr_b16 v[24:25], v205 offset:49152
    ds_read_b64_tr_b16 v[26:27], v205 offset:49664
    v_mfma_f32_16x16x32_bf16 v[68:71], v[36:39], v[16:19], v[68:71]
    s_add_u32 m0, s57, 25600
    s_add_u32 s24, s24, s26
    v_mfma_f32_16x16x32_bf16 v[56:59], v[40:43], v[12:15], v[56:59]
    buffer_load_dwordx4 v225, s[12:15], s25 offen  lds
    v_mfma_f32_16x16x32_bf16 v[72:75], v[40:43], v[16:19], v[72:75]
    ds_read_b64_tr_b16 v[28:29], v206 offset:49152
    ds_read_b64_tr_b16 v[30:31], v206 offset:49664
    v_mfma_f32_16x16x32_bf16 v[60:63], v[44:47], v[12:15], v[60:63]
    ds_read_b64_tr_b16 v[32:33], v207 offset:49152
    ds_read_b64_tr_b16 v[34:35], v207 offset:49664
    v_mfma_f32_16x16x32_bf16 v[76:79], v[44:47], v[16:19], v[76:79]
    s_add_u32 m0, s56, 24576
    s_add_u32 s22, s22, 1
    v_mfma_f32_16x16x32_bf16 v[64:67], v[48:51], v[12:15], v[64:67]
    buffer_load_dwordx4 v220, s[8:11], s24 offen  lds
    v_mfma_f32_16x16x32_bf16 v[80:83], v[48:51], v[16:19], v[80:83]
    s_waitcnt lgkmcnt(0)
    v_mfma_f32_16x16x32_bf16 v[84:87], v[200:203], v[4:7], v[84:87]
    ds_read_b128 v[12:15], v227 offset:49152
    ds_read_b128 v[16:19], v227 offset:51200
    v_mfma_f32_16x16x32_bf16 v[92:95], v[4:7], v[4:7], v[92:95]
    s_add_u32 m0, s56, 25600
    s_cmp_eq_u32 s22, 9
    s_cselect_b32 s22, 0, s22
    v_mfma_f32_16x16x32_bf16 v[88:91], v[200:203], v[8:11], v[88:91]
    buffer_load_dwordx4 v221, s[8:11], s24 offen  lds
    v_mfma_f32_16x16x32_bf16 v[96:99], v[8:11], v[8:11], v[96:99]
    ds_read_b64_tr_b16 v[36:37], v208 offset:49152
    ds_read_b64_tr_b16 v[38:39], v208 offset:49664
    v_mfma_f32_16x16x32_bf16 v[100:103], v[20:23], v[200:203], v[100:103]
    ds_read_b64_tr_b16 v[40:41], v209 offset:49152
    ds_read_b64_tr_b16 v[42:43], v209 offset:49664
    v_mfma_f32_16x16x32_bf16 v[104:107], v[24:27], v[200:203], v[104:107]
    s_add_u32 m0, s56, 26624
    ds_read_b64_tr_b16 v[44:45], v210 offset:49152
    v_mfma_f32_16x16x32_bf16 v[52:55], v[20:23], v[4:7], v[52:55]
    buffer_load_dwordx4 v222, s[8:11], s24 offen  lds
    v_mfma_f32_16x16x32_bf16 v[68:71], v[20:23], v[8:11], v[68:71]
    ds_read_b64_tr_b16 v[46:47], v210 offset:49664
    ds_read_b64_tr_b16 v[48:49], v211 offset:49152
    v_mfma_f32_16x16x32_bf16 v[56:59], v[24:27], v[4:7], v[56:59]
    ds_read_b64_tr_b16 v[50:51], v211 offset:49664
    v_mfma_f32_16x16x32_bf16 v[72:75], v[24:27], v[8:11], v[72:75]
    s_add_u32 m0, s56, 27648
    v_mfma_f32_16x16x32_bf16 v[60:63], v[28:31], v[4:7], v[60:63]
    buffer_load_dwordx4 v223, s[8:11], s24 offen  lds
    v_mfma_f32_16x16x32_bf16 v[76:79], v[28:31], v[8:11], v[76:79]
    v_mfma_f32_16x16x32_bf16 v[64:67], v[32:35], v[4:7], v[64:67]
    v_mfma_f32_16x16x32_bf16 v[80:83], v[32:35], v[8:11], v[80:83]
    s_waitcnt vmcnt(6) lgkmcnt(0)
    s_barrier
    v_mfma_f32_16x16x32_bf16 v[84:87], v[200:203], v[12:15], v[84:87]
    ds_read_b128 v[4:7], v226 offset:0
    ds_read_b128 v[8:11], v226 offset:2048
    v_mfma_f32_16x16x32_bf16 v[92:95], v[12:15], v[12:15], v[92:95]
    s_mul_i32 s25, s22, 73728
    s_add_u32 s25, s25, s27
    s_add_u32 m0, s57, 49152
    s_lshl_b32 s24, s22, 7
    v_mfma_f32_16x16x32_bf16 v[88:91], v[200:203], v[16:19], v[88:91]
    buffer_load_dwordx4 v224, s[12:15], s25 offen  lds
    v_mfma_f32_16x16x32_bf16 v[96:99], v[16:19], v[16:19], v[96:99]
    ds_read_b64_tr_b16 v[20:21], v204 offset:0
    ds_read_b64_tr_b16 v[22:23], v204 offset:512
    v_mfma_f32_16x16x32_bf16 v[52:55], v[36:39], v[12:15], v[52:55]
    ds_read_b64_tr_b16 v[24:25], v205 offset:0
    ds_read_b64_tr_b16 v[26:27], v205 offset:512
    v_mfma_f32_16x16x32_bf16 v[68:71], v[36:39], v[16:19], v[68:71]
    s_add_u32 m0, s57, 50176
    s_add_u32 s24, s24, s26
    v_mfma_f32_16x16x32_bf16 v[56:59], v[40:43], v[12:15], v[56:59]
    buffer_load_dwordx4 v225, s[12:15], s25 offen  lds
    v_mfma_f32_16x16x32_bf16 v[72:75], v[40:43], v[16:19], v[72:75]
    ds_read_b64_tr_b16 v[28:29], v206 offset:0
    ds_read_b64_tr_b16 v[30:31], v206 offset:512
    v_mfma_f32_16x16x32_bf16 v[60:63], v[44:47], v[12:15], v[60:63]
    ds_read_b64_tr_b16 v[32:33], v207 offset:0
    ds_read_b64_tr_b16 v[34:35], v207 offset:512
    v_mfma_f32_16x16x32_bf16 v[76:79], v[44:47], v[16:19], v[76:79]
    s_add_u32 m0, s56, 49152
    s_add_u32 s22, s22, 1
    v_mfma_f32_16x16x32_bf16 v[64:67], v[48:51], v[12:15], v[64:67]
    buffer_load_dwordx4 v220, s[8:11], s24 offen  lds
    v_mfma_f32_16x16x32_bf16 v[80:83], v[48:51], v[16:19], v[80:83]
    s_waitcnt lgkmcnt(0)
    v_mfma_f32_16x16x32_bf16 v[84:87], v[200:203], v[4:7], v[84:87]
    ds_read_b128 v[12:15], v227 offset:0
    ds_read_b128 v[16:19], v227 offset:2048
    v_mfma_f32_16x16x32_bf16 v[92:95], v[4:7], v[4:7], v[92:95]
    s_add_u32 m0, s56, 50176
    s_cmp_eq_u32 s22, 9
    s_cselect_b32 s22, 0, s22
    v_mfma_f32_16x16x32_bf16 v[88:91], v[200:203], v[8:11], v[88:91]
    buffer_load_dwordx4 v221, s[8:11], s24 offen  lds
    v_mfma_f32_16x16x32_bf16 v[96:99], v[8:11], v[8:11], v[96:99]
    ds_read_b64_tr_b16 v[36:37], v208 offset:0
    ds_read_b64_tr_b16 v[38:39], v208 offset:512
    v_mfma_f32_16x16x32_bf16 v[100:103], v[20:23], v[200:203], v[100:103]
    ds_read_b64_tr_b16 v[40:41], v209 offset:0
    ds_read_b64_tr_b16 v[42:43], v209 offset:512
    v_mfma_f32_16x16x32_bf16 v[104:107], v[24:27], v[200:203], v[104:107]
    s_add_u32 m0, s56, 51200
    ds_read_b64_tr_b16 v[44:45], v210 offset:0
    v_mfma_f32_16x16x32_bf16 v[52:55], v[20:23], v[4:7], v[52:55]
    buffer_load_dwordx4 v222, s[8:11], s24 offen  lds
    v_mfma_f32_16x16x32_bf16 v[68:71], v[20:23], v[8:11], v[68:71]
    ds_read_b64_tr_b16 v[46:47], v210 offset:512
    ds_read_b64_tr_b16 v[48:49], v211 offset:0
    v_mfma_f32_16x16x32_bf16 v[56:59], v[24:27], v[4:7], v[56:59]
    ds_read_b64_tr_b16 v[50:51], v211 offset:512
    v_mfma_f32_16x16x32_bf16 v[72:75], v[24:27], v[8:11], v[72:75]
    s_add_u32 m0, s56, 52224
    v_mfma_f32_16x16x32_bf16 v[60:63], v[28:31], v[4:7], v[60:63]
    buffer_load_dwordx4 v223, s[8:11], s24 offen  lds
    v_mfma_f32_16x16x32_bf16 v[76:79], v[28:31], v[8:11], v[76:79]
    v_mfma_f32_16x16x32_bf16 v[64:67], v[32:35], v[4:7], v[64:67]
    v_mfma_f32_16x16x32_bf16 v[80:83], v[32:35], v[8:11], v[80:83]
    s_waitcnt vmcnt(6) lgkmcnt(0)
    s_barrier
    v_mfma_f32_16x16x32_bf16 v[84:87], v[200:203], v[12:15], v[84:87]
    ds_read_b128 v[4:7], v226 offset:24576
    ds_read_b128 v[8:11], v226 offset:26624
    v_mfma_f32_16x16x32_bf16 v[92:95], v[12:15], v[12:15], v[92:95]
    s_mov_b32 s12, s62
    s_mov_b32 s13, s63
    s_mov_b32 s22, s21
    s_mul_i32 s25, s22, 73728
    s_add_u32 s25, s25, s27
    s_add_u32 m0, s57, 73728
    v_mfma_f32_16x16x32_bf16 v[88:91], v[200:203], v[16:19], v[88:91]
    buffer_load_dwordx4 v216, s[12:15], s25 offen lds
    v_mfma_f32_16x16x32_bf16 v[96:99], v[16:19], v[16:19], v[96:99]
    ds_read_b64_tr_b16 v[20:21], v204 offset:24576
    ds_read_b64_tr_b16 v[22:23], v204 offset:25088
    v_mfma_f32_16x16x32_bf16 v[52:55], v[36:39], v[12:15], v[52:55]
    ds_read_b64_tr_b16 v[24:25], v205 offset:24576
    ds_read_b64_tr_b16 v[26:27], v205 offset:25088
    v_mfma_f32_16x16x32_bf16 v[68:71], v[36:39], v[16:19], v[68:71]
    s_add_u32 m0, s57, 74752
    ds_read_b64_tr_b16 v[28:29], v206 offset:24576
    v_mfma_f32_16x16x32_bf16 v[56:59], v[40:43], v[12:15], v[56:59]
    buffer_load_dwordx4 v217, s[12:15], s25 offen lds
    v_mfma_f32_16x16x32_bf16 v[72:75], v[40:43], v[16:19], v[72:75]
    ds_read_b64_tr_b16 v[30:31], v206 offset:25088
    ds_read_b64_tr_b16 v[32:33], v207 offset:24576
    v_mfma_f32_16x16x32_bf16 v[60:63], v[44:47], v[12:15], v[60:63]
    ds_read_b64_tr_b16 v[34:35], v207 offset:25088
    v_mfma_f32_16x16x32_bf16 v[76:79], v[44:47], v[16:19], v[76:79]
    s_add_u32 s22, s22, 1
    s_cmp_eq_u32 s22, 9
    s_cselect_b32 s22, 0, s22
    v_mfma_f32_16x16x32_bf16 v[64:67], v[48:51], v[12:15], v[64:67]
    v_mfma_f32_16x16x32_bf16 v[80:83], v[48:51], v[16:19], v[80:83]
    s_waitcnt lgkmcnt(0)
    v_mfma_f32_16x16x32_bf16 v[84:87], v[200:203], v[4:7], v[84:87]
    ds_read_b128 v[12:15], v227 offset:24576
    ds_read_b128 v[16:19], v227 offset:26624
    v_mfma_f32_16x16x32_bf16 v[92:95], v[4:7], v[4:7], v[92:95]
    ds_read_b64_tr_b16 v[36:37], v208 offset:24576
    ds_read_b64_tr_b16 v[38:39], v208 offset:25088
    v_mfma_f32_16x16x32_bf16 v[88:91], v[200:203], v[8:11], v[88:91]
    ds_read_b64_tr_b16 v[40:41], v209 offset:24576
    ds_read_b64_tr_b16 v[42:43], v209 offset:25088
    v_mfma_f32_16x16x32_bf16 v[96:99], v[8:11], v[8:11], v[96:99]
    ds_read_b64_tr_b16 v[44:45], v210 offset:24576
    ds_read_b64_tr_b16 v[46:47], v210 offset:25088
    v_mfma_f32_16x16x32_bf16 v[100:103], v[20:23], v[200:203], v[100:103]
    ds_read_b64_tr_b16 v[48:49], v211 offset:24576
    ds_read_b64_tr_b16 v[50:51], v211 offset:25088
    v_mfma_f32_16x16x32_bf16 v[104:107], v[24:27], v[200:203], v[104:107]
    v_mfma_f32_16x16x32_bf16 v[52:55], v[20:23], v[4:7], v[52:55]
    v_mfma_f32_16x16x32_bf16 v[68:71], v[20:23], v[8:11], v[68:71]
    v_mfma_f32_16x16x32_bf16 v[56:59], v[24:27], v[4:7], v[56:59]
    v_mfma_f32_16x16x32_bf16 v[72:75], v[24:27], v[8:11], v[72:75]
    v_mfma_f32_16x16x32_bf16 v[60:63], v[28:31], v[4:7], v[60:63]
    v_mfma_f32_16x16x32_bf16 v[76:79], v[28:31], v[8:11], v[76:79]
    v_mfma_f32_16x16x32_bf16 v[64:67], v[32:35], v[4:7], v[64:67]
    v_mfma_f32_16x16x32_bf16 v[80:83], v[32:35], v[8:11], v[80:83]
    s_waitcnt vmcnt(2) lgkmcnt(0)
    s_barrier
    s_load_dword s4, s[100:101], 0
    v_mfma_f32_16x16x32_bf16 v[84:87], v[200:203], v[12:15], v[84:87]
    ds_read_b128 v[4:7], v226 offset:49152
    ds_read_b128 v[8:11], v226 offset:51200
    v_mfma_f32_16x16x32_bf16 v[92:95], v[12:15], v[12:15], v[92:95]
    s_mul_i32 s25, s22, 73728
    s_add_u32 s25, s25, s27
    s_add_u32 m0, s57, 81920
    v_mfma_f32_16x16x32_bf16 v[88:91], v[200:203], v[16:19], v[88:91]
    buffer_load_dwordx4 v216, s[12:15], s25 offen lds
    v_mfma_f32_16x16x32_bf16 v[96:99], v[16:19], v[16:19], v[96:99]
    ds_read_b64_tr_b16 v[20:21], v204 offset:49152
    ds_read_b64_tr_b16 v[22:23], v204 offset:49664
    v_mfma_f32_16x16x32_bf16 v[52:55], v[36:39], v[12:15], v[52:55]
    ds_read_b64_tr_b16 v[24:25], v205 offset:49152
    ds_read_b64_tr_b16 v[26:27], v205 offset:49664
    v_mfma_f32_16x16x32_bf16 v[68:71], v[36:39], v[16:19], v[68:71]
    s_add_u32 m0, s57, 82944
    ds_read_b64_tr_b16 v[28:29], v206 offset:49152
    v_mfma_f32_16x16x32_bf16 v[56:59], v[40:43], v[12:15], v[56:59]
    buffer_load_dwordx4 v217, s[12:15], s25 offen lds
    v_mfma_f32_16x16x32_bf16 v[72:75], v[40:43], v[16:19], v[72:75]
    ds_read_b64_tr_b16 v[30:31], v206 offset:49664
    ds_read_b64_tr_b16 v[32:33], v207 offset:49152
    v_mfma_f32_16x16x32_bf16 v[60:63], v[44:47], v[12:15], v[60:63]
    ds_read_b64_tr_b16 v[34:35], v207 offset:49664
    v_mfma_f32_16x16x32_bf16 v[76:79], v[44:47], v[16:19], v[76:79]
    s_add_u32 s22, s22, 1
    s_cmp_eq_u32 s22, 9
    s_cselect_b32 s22, 0, s22
    s_mul_i32 s25, s22, 73728
    s_add_u32 s25, s25, s27
    s_add_u32 m0, s57, 90112
    v_mfma_f32_16x16x32_bf16 v[64:67], v[48:51], v[12:15], v[64:67]
    buffer_load_dwordx4 v216, s[12:15], s25 offen lds
    v_mfma_f32_16x16x32_bf16 v[80:83], v[48:51], v[16:19], v[80:83]
    s_waitcnt lgkmcnt(0)
    v_mfma_f32_16x16x32_bf16 v[84:87], v[200:203], v[4:7], v[84:87]
    ds_read_b128 v[12:15], v227 offset:49152
    ds_read_b128 v[16:19], v227 offset:51200
    v_mfma_f32_16x16x32_bf16 v[92:95], v[4:7], v[4:7], v[92:95]
    s_add_u32 m0, s57, 91136
    ds_read_b64_tr_b16 v[36:37], v208 offset:49152
    v_mfma_f32_16x16x32_bf16 v[88:91], v[200:203], v[8:11], v[88:91]
    buffer_load_dwordx4 v217, s[12:15], s25 offen lds
    v_mfma_f32_16x16x32_bf16 v[96:99], v[8:11], v[8:11], v[96:99]
    ds_read_b64_tr_b16 v[38:39], v208 offset:49664
    ds_read_b64_tr_b16 v[40:41], v209 offset:49152
    v_mfma_f32_16x16x32_bf16 v[100:103], v[20:23], v[200:203], v[100:103]
    ds_read_b64_tr_b16 v[42:43], v209 offset:49664
    ds_read_b64_tr_b16 v[44:45], v210 offset:49152
    v_mfma_f32_16x16x32_bf16 v[104:107], v[24:27], v[200:203], v[104:107]
    s_add_u32 s22, s22, 1
    s_cmp_eq_u32 s22, 9
    s_cselect_b32 s22, 0, s22
    v_mfma_f32_16x16x32_bf16 v[52:55], v[20:23], v[4:7], v[52:55]
    ds_read_b64_tr_b16 v[46:47], v210 offset:49664
    ds_read_b64_tr_b16 v[48:49], v211 offset:49152
    v_mfma_f32_16x16x32_bf16 v[68:71], v[20:23], v[8:11], v[68:71]
    ds_read_b64_tr_b16 v[50:51], v211 offset:49664
    v_mfma_f32_16x16x32_bf16 v[56:59], v[24:27], v[4:7], v[56:59]
    v_mfma_f32_16x16x32_bf16 v[72:75], v[24:27], v[8:11], v[72:75]
    v_mfma_f32_16x16x32_bf16 v[60:63], v[28:31], v[4:7], v[60:63]
    v_mfma_f32_16x16x32_bf16 v[76:79], v[28:31], v[8:11], v[76:79]
    v_mfma_f32_16x16x32_bf16 v[64:67], v[32:35], v[4:7], v[64:67]
    v_mfma_f32_16x16x32_bf16 v[80:83], v[32:35], v[8:11], v[80:83]
    s_lshl_b32 s24, s32, 8
    v_add_u32 v1, s24, v218
    ds_write_b128 v1, v[100:103] offset:0
    ds_write_b128 v1, v[104:107] offset:64
    s_waitcnt lgkmcnt(0)
    s_barrier
    v_mfma_f32_16x16x32_bf16 v[84:87], v[200:203], v[12:15], v[84:87]
    ds_read_b128 v[108:111], v218 offset:0
    ds_read_b128 v[112:115], v218 offset:64
    v_mfma_f32_16x16x32_bf16 v[92:95], v[12:15], v[12:15], v[92:95]
    ds_read_b128 v[116:119], v219 offset:0
    ds_read_b128 v[120:123], v219 offset:64
    v_mfma_f32_16x16x32_bf16 v[88:91], v[200:203], v[16:19], v[88:91]
    ds_read_b128 v[124:127], v218 offset:256
    ds_read_b128 v[128:131], v218 offset:320
    v_mfma_f32_16x16x32_bf16 v[96:99], v[16:19], v[16:19], v[96:99]
    ds_read_b128 v[132:135], v219 offset:256
    ds_read_b128 v[136:139], v219 offset:320
    v_mfma_f32_16x16x32_bf16 v[52:55], v[36:39], v[12:15], v[52:55]
    v_mfma_f32_16x16x32_bf16 v[68:71], v[36:39], v[16:19], v[68:71]
    v_and_b32 v1, 3, v0
    v_cmp_eq_u32 vcc, 1, v1
    v_mfma_f32_16x16x32_bf16 v[56:59], v[40:43], v[12:15], v[56:59]
    v_cmp_eq_u32 s[58:59], 2, v1
    v_cmp_eq_u32 s[64:65], 3, v1
    v_mfma_f32_16x16x32_bf16 v[72:75], v[40:43], v[16:19], v[72:75]
    v_cndmask_b32 v92, v92, v93, vcc
    v_cndmask_b32 v92, v92, v94, s[58:59]
    v_mfma_f32_16x16x32_bf16 v[60:63], v[44:47], v[12:15], v[60:63]
    v_cndmask_b32 v92, v92, v95, s[64:65]
    ds_bpermute_b32 v93, v213, v92
    v_mfma_f32_16x16x32_bf16 v[76:79], v[44:47], v[16:19], v[76:79]
    v_cndmask_b32 v96, v96, v97, vcc
    v_cndmask_b32 v96, v96, v98, s[58:59]
    v_mfma_f32_16x16x32_bf16 v[64:67], v[48:51], v[12:15], v[64:67]
    v_cndmask_b32 v96, v96, v99, s[64:65]
    ds_bpermute_b32 v97, v213, v96
    v_mfma_f32_16x16x32_bf16 v[80:83], v[48:51], v[16:19], v[80:83]
    v_mul_f32 v184, 0x3ae38e39, v84
    v_mul_f32 v192, 0x3ae38e39, v88
    v_cvt_pk_bf16_f32 v186, v184, v184
    v_cvt_pk_bf16_f32 v194, v192, v192
    s_mul_i32 s25, s22, 73728
    s_add_u32 s25, s25, s27
    v_lshlrev_b32 v186, 16, v186
    v_lshlrev_b32 v194, 16, v194
    s_waitcnt lgkmcnt(0)
    v_mul_f32 v185, 0x3ae38e39, v93
    s_add_u32 m0, s57, 98304
    v_mul_f32 v193, 0x3ae38e39, v97
    v_fma_f32 v185, -v184, v184, v185
    v_fma_f32 v193, -v192, v192, v193
    v_max_f32 v185, 0, v185
    v_max_f32 v193, 0, v193
    buffer_load_dwordx4 v216, s[12:15], s25 offen lds
    v_cvt_pk_bf16_f32 v187, v185, v185
    v_cvt_pk_bf16_f32 v195, v193, v193
    v_lshlrev_b32 v187, 16, v187
    v_lshlrev_b32 v195, 16, v195
    v_add_f32 v187, 0x3727c5ac, v187
    s_add_u32 m0, s57, 99328
    v_add_f32 v195, 0x3727c5ac, v195
    v_cvt_pk_bf16_f32 v187, v187, v187
    v_cvt_pk_bf16_f32 v195, v195, v195
    v_lshlrev_b32 v187, 16, v187
    v_lshlrev_b32 v195, 16, v195
    buffer_load_dwordx4 v217, s[12:15], s25 offen lds
    v_sqrt_f32 v187, v187
    v_sqrt_f32 v195, v195
    v_cvt_pk_bf16_f32 v187, v187, v187
    v_cvt_pk_bf16_f32 v195, v195, v195
    v_lshlrev_b32 v187, 16, v187
    s_add_u32 s22, s22, 1
    s_cmp_eq_u32 s22, 9
    s_cselect_b32 s22, 0, s22
    v_lshlrev_b32 v195, 16, v195
    v_rcp_f32 v187, v187
    v_rcp_f32 v195, v195
    v_sub_f32 v188, v184, v186
    v_sub_f32 v196, v192, v194
    v_mul_f32 v188, v188, v187
    v_mul_f32 v196, v196, v195
    v_mul_f32 v185, v185, v187
    v_mul_f32 v193, v193, v195
    v_mul_f32 v185, v185, v187
    v_mul_f32 v193, v193, v195
    v_cvt_pk_bf16_f32 v188, v188, v188
    v_cvt_pk_bf16_f32 v196, v196, v196
    v_lshlrev_b32 v188, 16, v188
    v_lshlrev_b32 v196, 16, v196
    v_cvt_pk_bf16_f32 v189, v185, v185
    v_cvt_pk_bf16_f32 v197, v193, v193
    v_lshlrev_b32 v189, 16, v189
    v_lshlrev_b32 v197, 16, v197
    v_add_f32 v189, 0x3727c5ac, v189
    v_add_f32 v197, 0x3727c5ac, v197
    v_cvt_pk_bf16_f32 v189, v189, v189
    v_cvt_pk_bf16_f32 v197, v197, v197
    v_lshlrev_b32 v189, 16, v189
    v_lshlrev_b32 v197, 16, v197
    v_sqrt_f32 v189, v189
    v_sqrt_f32 v197, v197
    v_cvt_pk_bf16_f32 v189, v189, v189
    v_cvt_pk_bf16_f32 v197, v197, v197
    v_lshlrev_b32 v189, 16, v189
    v_lshlrev_b32 v197, 16, v197
    v_rcp_f32 v189, v189
    v_rcp_f32 v197, v197
    v_fma_f32 v188, v186, v187, v188
    v_fma_f32 v196, v194, v195, v196
    v_mul_f32 v190, v187, v189
    v_mul_f32 v198, v195, v197
    v_mul_f32 v191, v188, v189
    v_mul_f32 v199, v196, v197
    v_sub_f32 v191, 0, v191
    v_sub_f32 v199, 0, v199
    s_mov_b32 s3, 0
SP_1:
    s_waitcnt lgkmcnt(0)
    s_cmp_ge_u32 s4, 4
    s_cbranch_scc1 OK_2
    s_add_u32 s3, s3, 1
    s_cmp_gt_u32 s3, 200000
    s_cbranch_scc1 OK_2
    s_sleep 4
    v_mov_b32 v254, 0
    global_load_dword v255, v254, s[100:101] sc1
    s_waitcnt vmcnt(0)
    v_readfirstlane_b32 s4, v255
    s_nop 0
    s_branch SP_1
OK_2:
    v_pk_add_f32 v[108:109], v[108:109], v[124:125]
    v_pk_add_f32 v[110:111], v[110:111], v[126:127]
    v_pk_add_f32 v[112:113], v[112:113], v[128:129]
    v_pk_add_f32 v[114:115], v[114:115], v[130:131]
    v_pk_add_f32 v[116:117], v[116:117], v[132:133]
    v_pk_add_f32 v[118:119], v[118:119], v[134:135]
    v_pk_add_f32 v[120:121], v[120:121], v[136:137]
    v_pk_add_f32 v[122:123], v[122:123], v[138:139]
    v_lshlrev_b32 v1, 3, v214
    s_mov_b32 s24, 28311552
    s_cmp_eq_u32 s21, 0
    s_cselect_b32 s24, s24, 46006272
    buffer_store_dwordx2 v[186:187], v1, s[16:19], s24 offen offset:0 sc1
    buffer_store_dwordx2 v[194:195], v1, s[16:19], s24 offen offset:128 sc1
    v_pk_mul_f32 v[140:141], v[108:109], v[190:191] op_sel:[0,1] op_sel_hi:[1,1]
    v_pk_mul_f32 v[142:143], v[110:111], v[190:191] op_sel:[0,1] op_sel_hi:[1,1]
    v_pk_mul_f32 v[144:145], v[112:113], v[190:191] op_sel:[0,1] op_sel_hi:[1,1]
    s_lshl_b32 s24, s21, 7
    s_add_u32 s24, s24, s26
    v_pk_mul_f32 v[146:147], v[114:115], v[190:191] op_sel:[0,1] op_sel_hi:[1,1]
    v_pk_mul_f32 v[148:149], v[116:117], v[190:191] op_sel:[0,1] op_sel_hi:[1,1]
    v_pk_mul_f32 v[150:151], v[118:119], v[190:191] op_sel:[0,1] op_sel_hi:[1,1]
    s_add_u32 m0, s56, 32768
    v_pk_mul_f32 v[152:153], v[120:121], v[190:191] op_sel:[0,1] op_sel_hi:[1,1]
    v_pk_mul_f32 v[154:155], v[122:123], v[190:191] op_sel:[0,1] op_sel_hi:[1,1]
    v_pk_fma_f32 v[52:53], v[52:53], v[190:191], v[140:141] op_sel_hi:[1,0,1]
    buffer_load_dwordx4 v220, s[8:11], s24 offen lds
    v_pk_fma_f32 v[54:55], v[54:55], v[190:191], v[142:143] op_sel_hi:[1,0,1]
    v_pk_fma_f32 v[56:57], v[56:57], v[190:191], v[144:145] op_sel_hi:[1,0,1]
    v_pk_fma_f32 v[58:59], v[58:59], v[190:191], v[146:147] op_sel_hi:[1,0,1]
    s_add_u32 m0, s56, 33792
    v_pk_fma_f32 v[60:61], v[60:61], v[190:191], v[148:149] op_sel_hi:[1,0,1]
    v_pk_fma_f32 v[62:63], v[62:63], v[190:191], v[150:151] op_sel_hi:[1,0,1]
    v_pk_fma_f32 v[64:65], v[64:65], v[190:191], v[152:153] op_sel_hi:[1,0,1]
    buffer_load_dwordx4 v221, s[8:11], s24 offen lds
    v_pk_fma_f32 v[66:67], v[66:67], v[190:191], v[154:155] op_sel_hi:[1,0,1]
    v_pk_mul_f32 v[140:141], v[52:53], v[52:53]
    v_pk_mul_f32 v[142:143], v[54:55], v[54:55]
    s_add_u32 m0, s56, 34816
    v_pk_mul_f32 v[144:145], v[56:57], v[56:57]
    v_pk_mul_f32 v[146:147], v[58:59], v[58:59]
    v_pk_mul_f32 v[148:149], v[60:61], v[60:61]
    buffer_load_dwordx4 v222, s[8:11], s24 offen lds
    v_pk_mul_f32 v[150:151], v[62:63], v[62:63]
    v_pk_mul_f32 v[152:153], v[64:65], v[64:65]
    v_pk_mul_f32 v[154:155], v[66:67], v[66:67]
    s_add_u32 m0, s56, 35840
    v_pk_fma_f32 v[140:141], v[140:141], v[174:175], v[172:173]
    v_pk_fma_f32 v[142:143], v[142:143], v[174:175], v[172:173]
    v_pk_fma_f32 v[144:145], v[144:145], v[174:175], v[172:173]
    buffer_load_dwordx4 v223, s[8:11], s24 offen lds
    v_pk_fma_f32 v[146:147], v[146:147], v[174:175], v[172:173]
    v_pk_fma_f32 v[148:149], v[148:149], v[174:175], v[172:173]
    v_pk_fma_f32 v[150:151], v[150:151], v[174:175], v[172:173]
    s_mul_i32 s25, s22, 73728
    s_add_u32 s25, s25, s27
    v_pk_fma_f32 v[152:153], v[152:153], v[174:175], v[172:173]
    v_pk_fma_f32 v[154:155], v[154:155], v[174:175], v[172:173]
    v_pk_mul_f32 v[140:141], v[140:141], v[52:53]
    s_add_u32 m0, s57, 106496
    v_pk_mul_f32 v[142:143], v[142:143], v[54:55]
    v_pk_mul_f32 v[144:145], v[144:145], v[56:57]
    v_pk_mul_f32 v[146:147], v[146:147], v[58:59]
    buffer_load_dwordx4 v216, s[12:15], s25 offen lds
    v_pk_mul_f32 v[148:149], v[148:149], v[60:61]
    v_pk_mul_f32 v[150:151], v[150:151], v[62:63]
    v_pk_mul_f32 v[152:153], v[152:153], v[64:65]
    s_add_u32 m0, s57, 107520
    v_pk_mul_f32 v[154:155], v[154:155], v[66:67]
    v_exp_f32 v140, v140
    v_exp_f32 v141, v141
    buffer_load_dwordx4 v217, s[12:15], s25 offen lds
    v_exp_f32 v142, v142
    v_exp_f32 v143, v143
    v_exp_f32 v144, v144
    s_add_u32 s22, s22, 1
    s_cmp_eq_u32 s22, 9
    s_cselect_b32 s22, 0, s22
    v_exp_f32 v145, v145
    v_exp_f32 v146, v146
    v_exp_f32 v147, v147
    s_mul_i32 s25, s22, 73728
    s_add_u32 s25, s25, s27
    v_exp_f32 v148, v148
    v_exp_f32 v149, v149
    v_exp_f32 v150, v150
    s_add_u32 m0, s57, 114688
    v_exp_f32 v151, v151
    v_exp_f32 v152, v152
    v_exp_f32 v153, v153
    buffer_load_dwordx4 v216, s[12:15], s25 offen lds
    v_exp_f32 v154, v154
    v_exp_f32 v155, v155
    v_pk_add_f32 v[140:141], v[140:141], 1.0 op_sel_hi:[1,0]
    s_add_u32 m0, s57, 115712
    v_pk_add_f32 v[142:143], v[142:143], 1.0 op_sel_hi:[1,0]
    v_pk_add_f32 v[144:145], v[144:145], 1.0 op_sel_hi:[1,0]
    v_pk_add_f32 v[146:147], v[146:147], 1.0 op_sel_hi:[1,0]
    buffer_load_dwordx4 v217, s[12:15], s25 offen lds
    v_pk_add_f32 v[148:149], v[148:149], 1.0 op_sel_hi:[1,0]
    v_pk_add_f32 v[150:151], v[150:151], 1.0 op_sel_hi:[1,0]
    v_pk_add_f32 v[152:153], v[152:153], 1.0 op_sel_hi:[1,0]
    s_add_u32 s22, s22, 1
    s_cmp_eq_u32 s22, 9
    s_cselect_b32 s22, 0, s22
    v_pk_add_f32 v[154:155], v[154:155], 1.0 op_sel_hi:[1,0]
    v_rcp_f32 v140, v140
    v_rcp_f32 v141, v141
    v_rcp_f32 v142, v142
    v_rcp_f32 v143, v143
    v_rcp_f32 v144, v144
    v_rcp_f32 v145, v145
    v_rcp_f32 v146, v146
    v_rcp_f32 v147, v147
    v_rcp_f32 v148, v148
    v_rcp_f32 v149, v149
    v_rcp_f32 v150, v150
    v_rcp_f32 v151, v151
    v_rcp_f32 v152, v152
    v_rcp_f32 v153, v153
    v_rcp_f32 v154, v154
    v_rcp_f32 v155, v155
    v_pk_mul_f32 v[52:53], v[52:53], v[140:141]
    v_pk_mul_f32 v[54:55], v[54:55], v[142:143]
    v_pk_mul_f32 v[56:57], v[56:57], v[144:145]
    v_pk_mul_f32 v[58:59], v[58:59], v[146:147]
    v_pk_mul_f32 v[60:61], v[60:61], v[148:149]
    v_pk_mul_f32 v[62:63], v[62:63], v[150:151]
    v_pk_mul_f32 v[64:65], v[64:65], v[152:153]
    v_pk_mul_f32 v[66:67], v[66:67], v[154:155]
    v_cvt_pk_bf16_f32 v84, v52, v53
    v_cvt_pk_bf16_f32 v85, v54, v55
    v_cvt_pk_bf16_f32 v86, v56, v57
    v_cvt_pk_bf16_f32 v87, v58, v59
    v_cvt_pk_bf16_f32 v88, v60, v61
    v_cvt_pk_bf16_f32 v89, v62, v63
    v_cvt_pk_bf16_f32 v90, v64, v65
    v_cvt_pk_bf16_f32 v91, v66, v67
    s_cmp_lg_u32 s30, 0
    s_cbranch_scc1 HM_3
    s_movk_i32 s65, 0x800
    s_add_u32 s64, s34, 0
    v_add_u32 v1, s64, v214
    v_cmp_gt_u32 vcc, s65, v1
    s_nop 1
    v_cndmask_b32 v84, 0, v84, vcc
    v_cndmask_b32 v85, 0, v85, vcc
    s_add_u32 s64, s35, 0
    v_add_u32 v1, s64, v214
    v_cmp_gt_u32 vcc, s65, v1
    s_nop 1
    v_cndmask_b32 v86, 0, v86, vcc
    v_cndmask_b32 v87, 0, v87, vcc
    s_add_u32 s64, s36, 0
    v_add_u32 v1, s64, v214
    v_cmp_gt_u32 vcc, s65, v1
    s_nop 1
    v_cndmask_b32 v88, 0, v88, vcc
    v_cndmask_b32 v89, 0, v89, vcc
    s_add_u32 s64, s37, 0
    v_add_u32 v1, s64, v214
    v_cmp_gt_u32 vcc, s65, v1
    s_nop 1
    v_cndmask_b32 v90, 0, v90, vcc
    v_cndmask_b32 v91, 0, v91, vcc
HM_3:
    s_cmp_eq_u32 s34, s35
    s_cbranch_scc0 HS_4
    buffer_store_dwordx4 v[84:87], v228, s[16:19], 0 offen sc1
    s_branch HE_5
HS_4:
    buffer_store_dwordx2 v[84:85], v228, s[16:19], 0 offen sc1
    s_add_u32 s64, s35, 0
    v_add_u32 v1, s64, v214
    v_and_b32 v1, 0x7ff, v1
    v_lshrrev_b32 v2, 4, v1
    v_and_b32 v1, 15, v1
    v_mad_u32_u24 v2, v2, s33, v232
    v_lshl_add_u32 v1, v1, 4, v2
    buffer_store_dwordx2 v[86:87], v1, s[16:19], 0 offen offset:8 sc1
HE_5:
    s_cmp_eq_u32 s36, s37
    s_cbranch_scc0 HS_6
    buffer_store_dwordx4 v[88:91], v229, s[16:19], 0 offen sc1
    s_branch HE_7
HS_6:
    buffer_store_dwordx2 v[88:89], v229, s[16:19], 0 offen sc1
    s_add_u32 s64, s37, 0
    v_add_u32 v1, s64, v214
    v_and_b32 v1, 0x7ff, v1
    v_lshrrev_b32 v2, 4, v1
    v_and_b32 v1, 15, v1
    v_mad_u32_u24 v2, v2, s33, v233
    v_lshl_add_u32 v1, v1, 4, v2
    buffer_store_dwordx2 v[90:91], v1, s[16:19], 0 offen offset:8 sc1
HE_7:
    v_pk_mul_f32 v[156:157], v[108:109], v[198:199] op_sel:[0,1] op_sel_hi:[1,1]
    v_pk_mul_f32 v[158:159], v[110:111], v[198:199] op_sel:[0,1] op_sel_hi:[1,1]
    v_pk_mul_f32 v[160:161], v[112:113], v[198:199] op_sel:[0,1] op_sel_hi:[1,1]
    v_pk_mul_f32 v[162:163], v[114:115], v[198:199] op_sel:[0,1] op_sel_hi:[1,1]
    v_pk_mul_f32 v[164:165], v[116:117], v[198:199] op_sel:[0,1] op_sel_hi:[1,1]
    v_pk_mul_f32 v[166:167], v[118:119], v[198:199] op_sel:[0,1] op_sel_hi:[1,1]
    v_pk_mul_f32 v[168:169], v[120:121], v[198:199] op_sel:[0,1] op_sel_hi:[1,1]
    v_pk_mul_f32 v[170:171], v[122:123], v[198:199] op_sel:[0,1] op_sel_hi:[1,1]
    v_pk_fma_f32 v[68:69], v[68:69], v[198:199], v[156:157] op_sel_hi:[1,0,1]
    v_pk_fma_f32 v[70:71], v[70:71], v[198:199], v[158:159] op_sel_hi:[1,0,1]
    v_pk_fma_f32 v[72:73], v[72:73], v[198:199], v[160:161] op_sel_hi:[1,0,1]
    v_pk_fma_f32 v[74:75], v[74:75], v[198:199], v[162:163] op_sel_hi:[1,0,1]
    v_pk_fma_f32 v[76:77], v[76:77], v[198:199], v[164:165] op_sel_hi:[1,0,1]
    v_pk_fma_f32 v[78:79], v[78:79], v[198:199], v[166:167] op_sel_hi:[1,0,1]
    v_pk_fma_f32 v[80:81], v[80:81], v[198:199], v[168:169] op_sel_hi:[1,0,1]
    v_pk_fma_f32 v[82:83], v[82:83], v[198:199], v[170:171] op_sel_hi:[1,0,1]
    v_pk_mul_f32 v[156:157], v[68:69], v[68:69]
    v_pk_mul_f32 v[158:159], v[70:71], v[70:71]
    v_pk_mul_f32 v[160:161], v[72:73], v[72:73]
    v_pk_mul_f32 v[162:163], v[74:75], v[74:75]
    v_pk_mul_f32 v[164:165], v[76:77], v[76:77]
    v_pk_mul_f32 v[166:167], v[78:79], v[78:79]
    v_pk_mul_f32 v[168:169], v[80:81], v[80:81]
    v_pk_mul_f32 v[170:171], v[82:83], v[82:83]
    v_pk_fma_f32 v[156:157], v[156:157], v[174:175], v[172:173]
    v_pk_fma_f32 v[158:159], v[158:159], v[174:175], v[172:173]
    v_pk_fma_f32 v[160:161], v[160:161], v[174:175], v[172:173]
    v_pk_fma_f32 v[162:163], v[162:163], v[174:175], v[172:173]
    v_pk_fma_f32 v[164:165], v[164:165], v[174:175], v[172:173]
    v_pk_fma_f32 v[166:167], v[166:167], v[174:175], v[172:173]
    v_pk_fma_f32 v[168:169], v[168:169], v[174:175], v[172:173]
    v_pk_fma_f32 v[170:171], v[170:171], v[174:175], v[172:173]
    v_pk_mul_f32 v[156:157], v[156:157], v[68:69]
    v_pk_mul_f32 v[158:159], v[158:159], v[70:71]
    v_pk_mul_f32 v[160:161], v[160:161], v[72:73]
    v_pk_mul_f32 v[162:163], v[162:163], v[74:75]
    v_pk_mul_f32 v[164:165], v[164:165], v[76:77]
    v_pk_mul_f32 v[166:167], v[166:167], v[78:79]
    v_pk_mul_f32 v[168:169], v[168:169], v[80:81]
    v_pk_mul_f32 v[170:171], v[170:171], v[82:83]
    v_exp_f32 v156, v156
    v_exp_f32 v157, v157
    v_exp_f32 v158, v158
    v_exp_f32 v159, v159
    v_exp_f32 v160, v160
    v_exp_f32 v161, v161
    v_exp_f32 v162, v162
    v_exp_f32 v163, v163
    v_exp_f32 v164, v164
    v_exp_f32 v165, v165
    v_exp_f32 v166, v166
    v_exp_f32 v167, v167
    v_exp_f32 v168, v168
    v_exp_f32 v169, v169
    v_exp_f32 v170, v170
    v_exp_f32 v171, v171
    v_pk_add_f32 v[156:157], v[156:157], 1.0 op_sel_hi:[1,0]
    v_pk_add_f32 v[158:159], v[158:159], 1.0 op_sel_hi:[1,0]
    v_pk_add_f32 v[160:161], v[160:161], 1.0 op_sel_hi:[1,0]
    v_pk_add_f32 v[162:163], v[162:163], 1.0 op_sel_hi:[1,0]
    v_pk_add_f32 v[164:165], v[164:165], 1.0 op_sel_hi:[1,0]
    v_pk_add_f32 v[166:167], v[166:167], 1.0 op_sel_hi:[1,0]
    v_pk_add_f32 v[168:169], v[168:169], 1.0 op_sel_hi:[1,0]
    v_pk_add_f32 v[170:171], v[170:171], 1.0 op_sel_hi:[1,0]
    v_rcp_f32 v156, v156
    v_rcp_f32 v157, v157
    v_rcp_f32 v158, v158
    v_rcp_f32 v159, v159
    v_rcp_f32 v160, v160
    v_rcp_f32 v161, v161
    v_rcp_f32 v162, v162
    v_rcp_f32 v163, v163
    v_rcp_f32 v164, v164
    v_rcp_f32 v165, v165
    v_rcp_f32 v166, v166
    v_rcp_f32 v167, v167
    v_rcp_f32 v168, v168
    v_rcp_f32 v169, v169
    v_rcp_f32 v170, v170
    v_rcp_f32 v171, v171
    v_pk_mul_f32 v[68:69], v[68:69], v[156:157]
    v_pk_mul_f32 v[70:71], v[70:71], v[158:159]
    v_pk_mul_f32 v[72:73], v[72:73], v[160:161]
    v_pk_mul_f32 v[74:75], v[74:75], v[162:163]
    v_pk_mul_f32 v[76:77], v[76:77], v[164:165]
    v_pk_mul_f32 v[78:79], v[78:79], v[166:167]
    v_pk_mul_f32 v[80:81], v[80:81], v[168:169]
    v_pk_mul_f32 v[82:83], v[82:83], v[170:171]
    v_cvt_pk_bf16_f32 v92, v68, v69
    v_cvt_pk_bf16_f32 v93, v70, v71
    v_cvt_pk_bf16_f32 v94, v72, v73
    v_cvt_pk_bf16_f32 v95, v74, v75
    v_cvt_pk_bf16_f32 v96, v76, v77
    v_cvt_pk_bf16_f32 v97, v78, v79
    v_cvt_pk_bf16_f32 v98, v80, v81
    v_cvt_pk_bf16_f32 v99, v82, v83
    s_cmp_lg_u32 s30, 63
    s_cbranch_scc1 HM_8
    s_movk_i32 s65, 0x800
    s_add_u32 s64, s34, 16
    v_add_u32 v1, s64, v214
    v_cmp_gt_u32 vcc, s65, v1
    s_nop 1
    v_cndmask_b32 v92, 0, v92, vcc
    v_cndmask_b32 v93, 0, v93, vcc
    s_add_u32 s64, s35, 16
    v_add_u32 v1, s64, v214
    v_cmp_gt_u32 vcc, s65, v1
    s_nop 1
    v_cndmask_b32 v94, 0, v94, vcc
    v_cndmask_b32 v95, 0, v95, vcc
    s_add_u32 s64, s36, 16
    v_add_u32 v1, s64, v214
    v_cmp_gt_u32 vcc, s65, v1
    s_nop 1
    v_cndmask_b32 v96, 0, v96, vcc
    v_cndmask_b32 v97, 0, v97, vcc
    s_add_u32 s64, s37, 16
    v_add_u32 v1, s64, v214
    v_cmp_gt_u32 vcc, s65, v1
    s_nop 1
    v_cndmask_b32 v98, 0, v98, vcc
    v_cndmask_b32 v99, 0, v99, vcc
HM_8:
    s_cmp_eq_u32 s34, s35
    s_cbranch_scc0 HS_9
    buffer_store_dwordx4 v[92:95], v230, s[16:19], 0 offen sc1
    s_branch HE_10
HS_9:
    buffer_store_dwordx2 v[92:93], v230, s[16:19], 0 offen sc1
    s_add_u32 s64, s35, 16
    v_add_u32 v1, s64, v214
    v_and_b32 v1, 0x7ff, v1
    v_lshrrev_b32 v2, 4, v1
    v_and_b32 v1, 15, v1
    v_mad_u32_u24 v2, v2, s33, v232
    v_lshl_add_u32 v1, v1, 4, v2
    buffer_store_dwordx2 v[94:95], v1, s[16:19], 0 offen offset:8 sc1
HE_10:
    s_cmp_eq_u32 s36, s37
    s_cbranch_scc0 HS_11
    buffer_store_dwordx4 v[96:99], v231, s[16:19], 0 offen sc1
    s_branch HE_12
HS_11:
    buffer_store_dwordx2 v[96:97], v231, s[16:19], 0 offen sc1
    s_add_u32 s64, s37, 16
    v_add_u32 v1, s64, v214
    v_and_b32 v1, 0x7ff, v1
    v_lshrrev_b32 v2, 4, v1
    v_and_b32 v1, 15, v1
    v_mad_u32_u24 v2, v2, s33, v233
    v_lshl_add_u32 v1, v1, 4, v2
    buffer_store_dwordx2 v[98:99], v1, s[16:19], 0 offen offset:8 sc1
HE_12:
    s_mul_i32 s25, s22, 73728
    s_add_u32 s25, s25, s27
    s_add_u32 m0, s57, 122880
    s_nop 0
    buffer_load_dwordx4 v216, s[12:15], s25 offen lds
    s_add_u32 m0, s57, 123904
    s_nop 0
    buffer_load_dwordx4 v217, s[12:15], s25 offen lds
    s_add_u32 s22, s22, 1
    s_cmp_eq_u32 s22, 9
    s_cselect_b32 s22, 0, s22
    s_mul_i32 s25, s22, 73728
    s_add_u32 s25, s25, s27
    s_add_u32 m0, s57, 131072
    s_nop 0
    buffer_load_dwordx4 v216, s[12:15], s25 offen lds
    s_add_u32 m0, s57, 132096
    s_nop 0
    buffer_load_dwordx4 v217, s[12:15], s25 offen lds
    s_add_u32 s22, s22, 1
    s_cmp_eq_u32 s22, 9
    s_cselect_b32 s22, 0, s22
    v_and_b32 v1, 15, v0
    v_lshrrev_b32 v2, 5, v0
    v_lshrrev_b32 v3, 1, v1
    v_xor_b32 v2, v2, v3
    v_lshlrev_b32 v2, 4, v2
    v_lshl_add_u32 v2, v1, 7, v2
    v_bfe_u32 v3, v0, 4, 1
    v_lshl_add_u32 v2, v3, 3, v2
    s_add_u32 s24, s56, 32768
    v_add_u32 v2, s24, v2
    v_lshrrev_b32 v1, 2, v0
    v_lshlrev_b32 v3, 7, v1
    v_bfe_u32 v1, v1, 1, 2
    v_lshl_add_u32 v3, v1, 5, v3
    v_and_b32 v1, 3, v0
    v_lshl_add_u32 v3, v1, 3, v3
    v_add_u32 v204, 73728, v3
    v_xor_b32 v205, 32, v204
    v_xor_b32 v206, 64, v204
    v_xor_b32 v207, 96, v204
    v_add_u32 v208, 49152, v204
    v_add_u32 v209, 49152, v205
    v_add_u32 v210, 49152, v206
    v_add_u32 v211, 49152, v207
    s_waitcnt vmcnt(12)
    v_xor_b32 v1, 0, v2
    ds_read_b64 v[108:109], v1 offset:0
    ds_read_b64 v[110:111], v1 offset:2048
    v_xor_b32 v1, 32, v2
    ds_read_b64 v[112:113], v1 offset:0
    ds_read_b64 v[114:115], v1 offset:2048
    v_xor_b32 v1, 64, v2
    ds_read_b64 v[116:117], v1 offset:0
    ds_read_b64 v[118:119], v1 offset:2048
    v_xor_b32 v1, 96, v2
    ds_read_b64 v[120:121], v1 offset:0
    ds_read_b64 v[122:123], v1 offset:2048
    s_waitcnt vmcnt(4) lgkmcnt(0)
    s_barrier
    s_cmp_eq_u32 s23, 3
    s_cbranch_scc1 G_h3
    s_add_u32 s24, s20, s23
    s_add_u32 s24, s24, 15
    s_and_b32 s24, s24, 15
    s_lshl_b32 s24, s24, 2
    s_add_u32 s24, s24, s23
    s_mul_i32 s24, s24, 4352
    s_add_u32 s41, s24, 29198336
    s_mov_b32 s5, 1
    s_atomic_add s5, s[28:29], s41
G_h3:
    s_mul_i32 s25, s22, 73728
    s_add_u32 s25, s25, s27
    s_add_u32 m0, s57, 139264
    s_nop 0
    buffer_load_dwordx4 v216, s[12:15], s25 offen lds
    s_add_u32 m0, s57, 140288
    s_nop 0
    buffer_load_dwordx4 v217, s[12:15], s25 offen lds
    s_add_u32 s22, s22, 1
    s_cmp_eq_u32 s22, 9
    s_cselect_b32 s22, 0, s22
    v_mov_b32 v20, 0
    v_mov_b32 v21, 0
    v_mov_b32 v22, 0
    v_mov_b32 v23, 0
    v_lshlrev_b32 v1, 4, v0
    v_add_u32 v1, 37376, v1
    v_and_b32 v3, 7, v0
    v_mul_u32_u24 v3, 4160, v3
    v_cmp_gt_u32 vcc, 32, v0
    s_nop 1
    v_cndmask_b32 v1, v3, v1, vcc
    v_add_u32 v1, 0, v1
    ds_write_b128 v1, v[20:23]
    v_mov_b32 v24, v177
    v_mov_b32 v25, v178
    v_mov_b32 v26, v179
    v_mov_b32 v27, v180
    v_mov_b32 v28, v181
    v_mov_b32 v29, v182
    v_alignbit_b32 v30, v177, v176, 16
    v_alignbit_b32 v31, v178, v177, 16
    v_alignbit_b32 v32, v179, v178, 16
    v_alignbit_b32 v33, v180, v179, 16
    v_alignbit_b32 v34, v181, v180, 16
    v_alignbit_b32 v35, v182, v181, 16
    v_alignbit_b32 v36, v178, v177, 16
    v_alignbit_b32 v37, v179, v178, 16
    v_alignbit_b32 v38, v180, v179, 16
    v_alignbit_b32 v39, v181, v180, 16
    v_alignbit_b32 v40, v182, v181, 16
    v_alignbit_b32 v41, v183, v182, 16
    ds_write_b128 v252, v[178:181] offset:12496
    ds_write_b128 v252, v[180:183] offset:29136
    ds_write_b128 v252, v[24:27] offset:4176
    ds_write_b128 v252, v[26:29] offset:20816
    ds_write_b128 v252, v[30:33] offset:16
    ds_write_b128 v252, v[32:35] offset:16656
    ds_write_b128 v252, v[36:39] offset:8336
    ds_write_b128 v252, v[38:41] offset:24976
    s_mul_i32 s40, s30, 4352
    s_add_u32 s40, s40, 29198336
    s_lshr_b32 s27, s2, 2
    s_lshl_b32 s27, s27, 4
    s_and_b32 s42, s2, 3
    s_add_u32 s27, s27, s42
    s_add_u32 s27, s27, 12
    s_lshr_b32 s42, s27, 6
    s_mul_i32 s42, s42, 4352
    s_add_u32 s42, s42, 29685760
    s_and_b32 s20, s2, 3
    s_lshl_b32 s20, s20, 1
    s_lshr_b32 s64, s2, 7
    s_add_u32 s20, s20, s64
    s_mul_i32 s7, s20, 4352
    s_add_u32 s7, s7, 29616128
    s_mul_i32 s64, s20, 663552
    s_add_u32 s64, s64, 33030144
    s_mul_i32 s65, s23, 36864
    s_add_u32 s88, s64, s65
    s_lshr_b32 s65, s23, 1
    s_mul_i32 s65, s65, 36864
    s_add_u32 s59, s64, s65
    s_add_u32 s59, s59, 589824
    v_and_b32 v3, 15, v0
    v_lshrrev_b32 v1, 5, v0
    v_lshlrev_b32 v1, 8, v1
    v_lshl_add_u32 v1, v3, 4, v1
    v_bfe_u32 v2, v0, 4, 1
    v_mul_u32_u24 v241, 18432, v2
    s_and_b32 s65, s23, 1
    s_lshl_b32 s65, s65, 9
    v_add3_u32 v241, s65, v241, v1
    v_xor_b32 v242, 512, v241
    s_mul_i32 s26, s30, 36864
    s_mov_b32 s22, s21
    s_lshr_b32 s24, s30, 1
    s_mul_i32 s24, s24, 73728
    s_lshl_b32 s25, s21, 13
    s_add_u32 s24, s24, s25
    s_lshl_b32 s25, s32, 12
    s_add_u32 s24, s24, s25
    s_add_u32 s24, s24, 43646976
    buffer_store_dwordx4 v[108:111], v212, s[16:19], s24 offen offset:0 sc1
    buffer_store_dwordx4 v[112:115], v212, s[16:19], s24 offen offset:1024 sc1
    buffer_store_dwordx4 v[116:119], v212, s[16:19], s24 offen offset:2048 sc1
    buffer_store_dwordx4 v[120:123], v212, s[16:19], s24 offen offset:3072 sc1
    s_cmp_eq_u32 s23, 3
    s_cbranch_scc1 G_h6
    s_load_dword s4, s[28:29], s40 glc
G_h6:
    v_mul_f32 v186, v186, v187
    v_lshlrev_b32 v52, 16, v108
    v_and_b32 v53, 0xffff0000, v108
    v_lshlrev_b32 v54, 16, v109
    v_and_b32 v55, 0xffff0000, v109
    v_lshlrev_b32 v56, 16, v112
    v_and_b32 v57, 0xffff0000, v112
    v_lshlrev_b32 v58, 16, v113
    v_and_b32 v59, 0xffff0000, v113
    v_lshlrev_b32 v60, 16, v116
    v_and_b32 v61, 0xffff0000, v116
    v_lshlrev_b32 v62, 16, v117
    v_and_b32 v63, 0xffff0000, v117
    v_lshlrev_b32 v64, 16, v120
    v_and_b32 v65, 0xffff0000, v120
    v_lshlrev_b32 v66, 16, v121
    v_and_b32 v67, 0xffff0000, v121
    v_pk_fma_f32 v[52:53], v[52:53], v[186:187], v[186:187] op_sel:[0,1,0] op_sel_hi:[1,1,0] neg_lo:[0,0,1] neg_hi:[0,0,1]
    v_pk_fma_f32 v[54:55], v[54:55], v[186:187], v[186:187] op_sel:[0,1,0] op_sel_hi:[1,1,0] neg_lo:[0,0,1] neg_hi:[0,0,1]
    v_pk_fma_f32 v[56:57], v[56:57], v[186:187], v[186:187] op_sel:[0,1,0] op_sel_hi:[1,1,0] neg_lo:[0,0,1] neg_hi:[0,0,1]
    v_pk_fma_f32 v[58:59], v[58:59], v[186:187], v[186:187] op_sel:[0,1,0] op_sel_hi:[1,1,0] neg_lo:[0,0,1] neg_hi:[0,0,1]
    v_pk_fma_f32 v[60:61], v[60:61], v[186:187], v[186:187] op_sel:[0,1,0] op_sel_hi:[1,1,0] neg_lo:[0,0,1] neg_hi:[0,0,1]
    v_pk_fma_f32 v[62:63], v[62:63], v[186:187], v[186:187] op_sel:[0,1,0] op_sel_hi:[1,1,0] neg_lo:[0,0,1] neg_hi:[0,0,1]
    v_pk_fma_f32 v[64:65], v[64:65], v[186:187], v[186:187] op_sel:[0,1,0] op_sel_hi:[1,1,0] neg_lo:[0,0,1] neg_hi:[0,0,1]
    v_pk_fma_f32 v[66:67], v[66:67], v[186:187], v[186:187] op_sel:[0,1,0] op_sel_hi:[1,1,0] neg_lo:[0,0,1] neg_hi:[0,0,1]
    v_mul_f32 v194, v194, v195
    v_lshlrev_b32 v68, 16, v110
    v_and_b32 v69, 0xffff0000, v110
    v_lshlrev_b32 v70, 16, v111
    v_and_b32 v71, 0xffff0000, v111
    v_lshlrev_b32 v72, 16, v114
    v_and_b32 v73, 0xffff0000, v114
    v_lshlrev_b32 v74, 16, v115
    v_and_b32 v75, 0xffff0000, v115
    v_lshlrev_b32 v76, 16, v118
    v_and_b32 v77, 0xffff0000, v118
    v_lshlrev_b32 v78, 16, v119
    v_and_b32 v79, 0xffff0000, v119
    v_lshlrev_b32 v80, 16, v122
    v_and_b32 v81, 0xffff0000, v122
    v_lshlrev_b32 v82, 16, v123
    v_and_b32 v83, 0xffff0000, v123
    v_pk_fma_f32 v[68:69], v[68:69], v[194:195], v[194:195] op_sel:[0,1,0] op_sel_hi:[1,1,0] neg_lo:[0,0,1] neg_hi:[0,0,1]
    v_pk_fma_f32 v[70:71], v[70:71], v[194:195], v[194:195] op_sel:[0,1,0] op_sel_hi:[1,1,0] neg_lo:[0,0,1] neg_hi:[0,0,1]
    v_pk_fma_f32 v[72:73], v[72:73], v[194:195], v[194:195] op_sel:[0,1,0] op_sel_hi:[1,1,0] neg_lo:[0,0,1] neg_hi:[0,0,1]
    v_pk_fma_f32 v[74:75], v[74:75], v[194:195], v[194:195] op_sel:[0,1,0] op_sel_hi:[1,1,0] neg_lo:[0,0,1] neg_hi:[0,0,1]
    v_pk_fma_f32 v[76:77], v[76:77], v[194:195], v[194:195] op_sel:[0,1,0] op_sel_hi:[1,1,0] neg_lo:[0,0,1] neg_hi:[0,0,1]
    v_pk_fma_f32 v[78:79], v[78:79], v[194:195], v[194:195] op_sel:[0,1,0] op_sel_hi:[1,1,0] neg_lo:[0,0,1] neg_hi:[0,0,1]
    v_pk_fma_f32 v[80:81], v[80:81], v[194:195], v[194:195] op_sel:[0,1,0] op_sel_hi:[1,1,0] neg_lo:[0,0,1] neg_hi:[0,0,1]
    v_pk_fma_f32 v[82:83], v[82:83], v[194:195], v[194:195] op_sel:[0,1,0] op_sel_hi:[1,1,0] neg_lo:[0,0,1] neg_hi:[0,0,1]
    s_waitcnt vmcnt(4)
    s_cmp_ge_u32 s23, 3
    s_cbranch_scc1 OK_14
    s_mov_b32 s3, 0
SP_13:
    s_waitcnt lgkmcnt(0)
    s_cmp_ge_u32 s4, 9
    s_cbranch_scc1 OK_14
    s_add_u32 s3, s3, 1
    s_cmp_gt_u32 s3, 200000
    s_cbranch_scc1 OK_14
    s_load_dword s4, s[28:29], s40 glc
    s_branch SP_13
OK_14:
    s_waitcnt lgkmcnt(0)
    s_barrier
    s_lshl_b32 s24, s22, 11
    s_add_u32 s24, s24, s26
    s_add_u32 s25, s24, 18432
    s_add_u32 s22, s22, 1
    s_cmp_eq_u32 s22, 9
    s_cselect_b32 s22, 0, s22
    buffer_load_dwordx4 a[0:3], v212, s[16:19], s24 offen offset:0 sc1
    buffer_load_dwordx4 a[4:7], v212, s[16:19], s25 offen offset:0 sc1
    buffer_load_dwordx4 a[8:11], v212, s[16:19], s24 offen offset:1024 sc1
    buffer_load_dwordx4 a[12:15], v212, s[16:19], s25 offen offset:1024 sc1
    s_lshl_b32 s24, s22, 11
    s_add_u32 s24, s24, s26
    s_add_u32 s25, s24, 18432
    s_add_u32 s22, s22, 1
    s_cmp_eq_u32 s22, 9
    s_cselect_b32 s22, 0, s22
    buffer_load_dwordx4 a[16:19], v212, s[16:19], s24 offen offset:0 sc1
    buffer_load_dwordx4 a[20:23], v212, s[16:19], s25 offen offset:0 sc1
    buffer_load_dwordx4 a[24:27], v212, s[16:19], s24 offen offset:1024 sc1
    buffer_load_dwordx4 a[28:31], v212, s[16:19], s25 offen offset:1024 sc1
    s_lshl_b32 s24, s22, 11
    s_add_u32 s24, s24, s26
    s_add_u32 s25, s24, 18432
    s_add_u32 s22, s22, 1
    s_cmp_eq_u32 s22, 9
    s_cselect_b32 s22, 0, s22
    buffer_load_dwordx4 a[32:35], v212, s[16:19], s24 offen offset:0 sc1
    buffer_load_dwordx4 a[36:39], v212, s[16:19], s25 offen offset:0 sc1
    ds_read_b64_tr_b16 v[4:5], v204 offset:0
    ds_read_b64_tr_b16 v[6:7], v204 offset:2048
    ds_read_b64_tr_b16 v[8:9], v205 offset:0
    ds_read_b64_tr_b16 v[10:11], v205 offset:2048
    ds_read_b64_tr_b16 v[12:13], v206 offset:0
    ds_read_b64_tr_b16 v[14:15], v206 offset:2048
    ds_read_b64_tr_b16 v[16:17], v207 offset:0
    ds_read_b64_tr_b16 v[18:19], v207 offset:2048
    ds_read_b64_tr_b16 v[20:21], v204 offset:4096
    ds_read_b64_tr_b16 v[22:23], v204 offset:6144
    ds_read_b64_tr_b16 v[24:25], v205 offset:4096
    ds_read_b64_tr_b16 v[26:27], v205 offset:6144
    ds_read_b64_tr_b16 v[28:29], v206 offset:4096
    ds_read_b64_tr_b16 v[30:31], v206 offset:6144
    ds_read_b64_tr_b16 v[32:33], v207 offset:4096
    ds_read_b64_tr_b16 v[34:35], v207 offset:6144
    s_waitcnt vmcnt(8) lgkmcnt(8)
    v_mfma_f32_16x16x32_bf16 v[52:55], v[4:7], a[0:3], v[52:55]
    ds_read_b64_tr_b16 v[36:37], v204 offset:8192
    ds_read_b64_tr_b16 v[38:39], v204 offset:10240
    v_mfma_f32_16x16x32_bf16 v[68:71], v[4:7], a[4:7], v[68:71]
    buffer_load_dwordx4 a[40:43], v212, s[16:19], s24 offen offset:1024 sc1
    v_mfma_f32_16x16x32_bf16 v[56:59], v[8:11], a[0:3], v[56:59]
    ds_read_b64_tr_b16 v[40:41], v205 offset:8192
    ds_read_b64_tr_b16 v[42:43], v205 offset:10240
    v_mfma_f32_16x16x32_bf16 v[72:75], v[8:11], a[4:7], v[72:75]
    ds_read_b64_tr_b16 v[44:45], v206 offset:8192
    ds_read_b64_tr_b16 v[46:47], v206 offset:10240
    v_mfma_f32_16x16x32_bf16 v[60:63], v[12:15], a[0:3], v[60:63]
    buffer_load_dwordx4 a[44:47], v212, s[16:19], s25 offen offset:1024 sc1
    v_mfma_f32_16x16x32_bf16 v[76:79], v[12:15], a[4:7], v[76:79]
    ds_read_b64_tr_b16 v[48:49], v207 offset:8192
    ds_read_b64_tr_b16 v[50:51], v207 offset:10240
    v_mfma_f32_16x16x32_bf16 v[64:67], v[16:19], a[0:3], v[64:67]
    v_mfma_f32_16x16x32_bf16 v[80:83], v[16:19], a[4:7], v[80:83]
    s_waitcnt vmcnt(8) lgkmcnt(8)
    v_mfma_f32_16x16x32_bf16 v[52:55], v[20:23], a[8:11], v[52:55]
    ds_read_b64_tr_b16 v[4:5], v204 offset:12288
    ds_read_b64_tr_b16 v[6:7], v204 offset:14336
    v_mfma_f32_16x16x32_bf16 v[68:71], v[20:23], a[12:15], v[68:71]
    s_lshl_b32 s24, s22, 11
    s_add_u32 s24, s24, s26
    v_mfma_f32_16x16x32_bf16 v[56:59], v[24:27], a[8:11], v[56:59]
    buffer_load_dwordx4 a[48:51], v212, s[16:19], s24 offen offset:0 sc1
    v_mfma_f32_16x16x32_bf16 v[72:75], v[24:27], a[12:15], v[72:75]
    ds_read_b64_tr_b16 v[8:9], v205 offset:12288
    ds_read_b64_tr_b16 v[10:11], v205 offset:14336
    v_mfma_f32_16x16x32_bf16 v[60:63], v[28:31], a[8:11], v[60:63]
    ds_read_b64_tr_b16 v[12:13], v206 offset:12288
    ds_read_b64_tr_b16 v[14:15], v206 offset:14336
    v_mfma_f32_16x16x32_bf16 v[76:79], v[28:31], a[12:15], v[76:79]
    s_add_u32 s25, s24, 18432
    s_add_u32 s22, s22, 1
    s_cmp_eq_u32 s22, 9
    s_cselect_b32 s22, 0, s22
    v_mfma_f32_16x16x32_bf16 v[64:67], v[32:35], a[8:11], v[64:67]
    buffer_load_dwordx4 a[52:55], v212, s[16:19], s25 offen offset:0 sc1
    v_mfma_f32_16x16x32_bf16 v[80:83], v[32:35], a[12:15], v[80:83]
    ds_read_b64_tr_b16 v[16:17], v207 offset:12288
    ds_read_b64_tr_b16 v[18:19], v207 offset:14336
    s_waitcnt vmcnt(8) lgkmcnt(8)
    v_mfma_f32_16x16x32_bf16 v[52:55], v[36:39], a[16:19], v[52:55]
    ds_read_b64_tr_b16 v[20:21], v204 offset:16384
    ds_read_b64_tr_b16 v[22:23], v204 offset:18432
    v_mfma_f32_16x16x32_bf16 v[68:71], v[36:39], a[20:23], v[68:71]
    buffer_load_dwordx4 a[56:59], v212, s[16:19], s24 offen offset:1024 sc1
    v_mfma_f32_16x16x32_bf16 v[56:59], v[40:43], a[16:19], v[56:59]
    ds_read_b64_tr_b16 v[24:25], v205 offset:16384
    ds_read_b64_tr_b16 v[26:27], v205 offset:18432
    v_mfma_f32_16x16x32_bf16 v[72:75], v[40:43], a[20:23], v[72:75]
    ds_read_b64_tr_b16 v[28:29], v206 offset:16384
    ds_read_b64_tr_b16 v[30:31], v206 offset:18432
    v_mfma_f32_16x16x32_bf16 v[60:63], v[44:47], a[16:19], v[60:63]
    buffer_load_dwordx4 a[60:63], v212, s[16:19], s25 offen offset:1024 sc1
    v_mfma_f32_16x16x32_bf16 v[76:79], v[44:47], a[20:23], v[76:79]
    ds_read_b64_tr_b16 v[32:33], v207 offset:16384
    ds_read_b64_tr_b16 v[34:35], v207 offset:18432
    v_mfma_f32_16x16x32_bf16 v[64:67], v[48:51], a[16:19], v[64:67]
    v_mfma_f32_16x16x32_bf16 v[80:83], v[48:51], a[20:23], v[80:83]
    s_waitcnt vmcnt(8) lgkmcnt(8)
    v_mfma_f32_16x16x32_bf16 v[52:55], v[4:7], a[24:27], v[52:55]
    ds_read_b64_tr_b16 v[36:37], v204 offset:20480
    ds_read_b64_tr_b16 v[38:39], v204 offset:22528
    v_mfma_f32_16x16x32_bf16 v[68:71], v[4:7], a[28:31], v[68:71]
    s_lshl_b32 s24, s22, 11
    s_add_u32 s24, s24, s26
    v_mfma_f32_16x16x32_bf16 v[56:59], v[8:11], a[24:27], v[56:59]
    buffer_load_dwordx4 a[64:67], v212, s[16:19], s24 offen offset:0 sc1
    v_mfma_f32_16x16x32_bf16 v[72:75], v[8:11], a[28:31], v[72:75]
    ds_read_b64_tr_b16 v[40:41], v205 offset:20480
    ds_read_b64_tr_b16 v[42:43], v205 offset:22528
    v_mfma_f32_16x16x32_bf16 v[60:63], v[12:15], a[24:27], v[60:63]
    ds_read_b64_tr_b16 v[44:45], v206 offset:20480
    ds_read_b64_tr_b16 v[46:47], v206 offset:22528
    v_mfma_f32_16x16x32_bf16 v[76:79], v[12:15], a[28:31], v[76:79]
    s_add_u32 s25, s24, 18432
    s_add_u32 s22, s22, 1
    s_cmp_eq_u32 s22, 9
    s_cselect_b32 s22, 0, s22
    v_mfma_f32_16x16x32_bf16 v[64:67], v[16:19], a[24:27], v[64:67]
    buffer_load_dwordx4 a[68:71], v212, s[16:19], s25 offen offset:0 sc1
    v_mfma_f32_16x16x32_bf16 v[80:83], v[16:19], a[28:31], v[80:83]
    ds_read_b64_tr_b16 v[48:49], v207 offset:20480
    ds_read_b64_tr_b16 v[50:51], v207 offset:22528
    s_waitcnt vmcnt(8) lgkmcnt(8)
    v_mfma_f32_16x16x32_bf16 v[52:55], v[20:23], a[32:35], v[52:55]
    ds_read_b64_tr_b16 v[4:5], v204 offset:24576
    ds_read_b64_tr_b16 v[6:7], v204 offset:26624
    v_mfma_f32_16x16x32_bf16 v[68:71], v[20:23], a[36:39], v[68:71]
    buffer_load_dwordx4 a[72:75], v212, s[16:19], s24 offen offset:1024 sc1
    v_mfma_f32_16x16x32_bf16 v[56:59], v[24:27], a[32:35], v[56:59]
    ds_read_b64_tr_b16 v[8:9], v205 offset:24576
    ds_read_b64_tr_b16 v[10:11], v205 offset:26624
    v_mfma_f32_16x16x32_bf16 v[72:75], v[24:27], a[36:39], v[72:75]
    ds_read_b64_tr_b16 v[12:13], v206 offset:24576
    ds_read_b64_tr_b16 v[14:15], v206 offset:26624
    v_mfma_f32_16x16x32_bf16 v[60:63], v[28:31], a[32:35], v[60:63]
    buffer_load_dwordx4 a[76:79], v212, s[16:19], s25 offen offset:1024 sc1
    v_mfma_f32_16x16x32_bf16 v[76:79], v[28:31], a[36:39], v[76:79]
    ds_read_b64_tr_b16 v[16:17], v207 offset:24576
    ds_read_b64_tr_b16 v[18:19], v207 offset:26624
    v_mfma_f32_16x16x32_bf16 v[64:67], v[32:35], a[32:35], v[64:67]
    v_mfma_f32_16x16x32_bf16 v[80:83], v[32:35], a[36:39], v[80:83]
    s_cmp_lt_u32 s23, 2
    s_cbranch_scc1 G_d0
    s_cmp_eq_u32 s23, 3
    s_cselect_b32 s43, s42, s7
    s_cselect_b32 s44, 32, 27
    s_load_dword s4, s[28:29], s43 glc
G_d0:
    s_waitcnt vmcnt(8) lgkmcnt(8)
    v_mfma_f32_16x16x32_bf16 v[52:55], v[36:39], a[40:43], v[52:55]
    ds_read_b64_tr_b16 v[20:21], v204 offset:28672
    ds_read_b64_tr_b16 v[22:23], v204 offset:30720
    v_mfma_f32_16x16x32_bf16 v[68:71], v[36:39], a[44:47], v[68:71]
    s_lshl_b32 s24, s22, 11
    s_add_u32 s24, s24, s26
    v_mfma_f32_16x16x32_bf16 v[56:59], v[40:43], a[40:43], v[56:59]
    buffer_load_dwordx4 a[80:83], v212, s[16:19], s24 offen offset:0 sc1
    v_mfma_f32_16x16x32_bf16 v[72:75], v[40:43], a[44:47], v[72:75]
    ds_read_b64_tr_b16 v[24:25], v205 offset:28672
    ds_read_b64_tr_b16 v[26:27], v205 offset:30720
    v_mfma_f32_16x16x32_bf16 v[60:63], v[44:47], a[40:43], v[60:63]
    ds_read_b64_tr_b16 v[28:29], v206 offset:28672
    ds_read_b64_tr_b16 v[30:31], v206 offset:30720
    v_mfma_f32_16x16x32_bf16 v[76:79], v[44:47], a[44:47], v[76:79]
    s_add_u32 s25, s24, 18432
    s_add_u32 s22, s22, 1
    s_cmp_eq_u32 s22, 9
    s_cselect_b32 s22, 0, s22
    v_mfma_f32_16x16x32_bf16 v[64:67], v[48:51], a[40:43], v[64:67]
    buffer_load_dwordx4 a[84:87], v212, s[16:19], s25 offen offset:0 sc1
    v_mfma_f32_16x16x32_bf16 v[80:83], v[48:51], a[44:47], v[80:83]
    ds_read_b64_tr_b16 v[32:33], v207 offset:28672
    ds_read_b64_tr_b16 v[34:35], v207 offset:30720
    s_waitcnt vmcnt(8) lgkmcnt(8)
    v_mfma_f32_16x16x32_bf16 v[52:55], v[4:7], a[48:51], v[52:55]
    ds_read_b64_tr_b16 v[36:37], v204 offset:32768
    ds_read_b64_tr_b16 v[38:39], v204 offset:34816
    v_mfma_f32_16x16x32_bf16 v[68:71], v[4:7], a[52:55], v[68:71]
    buffer_load_dwordx4 a[88:91], v212, s[16:19], s24 offen offset:1024 sc1
    v_mfma_f32_16x16x32_bf16 v[56:59], v[8:11], a[48:51], v[56:59]
    ds_read_b64_tr_b16 v[40:41], v205 offset:32768
    ds_read_b64_tr_b16 v[42:43], v205 offset:34816
    v_mfma_f32_16x16x32_bf16 v[72:75], v[8:11], a[52:55], v[72:75]
    ds_read_b64_tr_b16 v[44:45], v206 offset:32768
    ds_read_b64_tr_b16 v[46:47], v206 offset:34816
    v_mfma_f32_16x16x32_bf16 v[60:63], v[12:15], a[48:51], v[60:63]
    buffer_load_dwordx4 a[92:95], v212, s[16:19], s25 offen offset:1024 sc1
    v_mfma_f32_16x16x32_bf16 v[76:79], v[12:15], a[52:55], v[76:79]
    ds_read_b64_tr_b16 v[48:49], v207 offset:32768
    ds_read_b64_tr_b16 v[50:51], v207 offset:34816
    v_mfma_f32_16x16x32_bf16 v[64:67], v[16:19], a[48:51], v[64:67]
    v_mfma_f32_16x16x32_bf16 v[80:83], v[16:19], a[52:55], v[80:83]
    s_waitcnt vmcnt(8) lgkmcnt(8)
    v_mfma_f32_16x16x32_bf16 v[52:55], v[20:23], a[56:59], v[52:55]
    ds_read_b64_tr_b16 v[4:5], v204 offset:36864
    ds_read_b64_tr_b16 v[6:7], v204 offset:38912
    v_mfma_f32_16x16x32_bf16 v[68:71], v[20:23], a[60:63], v[68:71]
    s_lshl_b32 s24, s22, 11
    s_add_u32 s24, s24, s26
    v_mfma_f32_16x16x32_bf16 v[56:59], v[24:27], a[56:59], v[56:59]
    buffer_load_dwordx4 a[96:99], v212, s[16:19], s24 offen offset:0 sc1
    v_mfma_f32_16x16x32_bf16 v[72:75], v[24:27], a[60:63], v[72:75]
    ds_read_b64_tr_b16 v[8:9], v205 offset:36864
    ds_read_b64_tr_b16 v[10:11], v205 offset:38912
    v_mfma_f32_16x16x32_bf16 v[60:63], v[28:31], a[56:59], v[60:63]
    ds_read_b64_tr_b16 v[12:13], v206 offset:36864
    ds_read_b64_tr_b16 v[14:15], v206 offset:38912
    v_mfma_f32_16x16x32_bf16 v[76:79], v[28:31], a[60:63], v[76:79]
    s_add_u32 s25, s24, 18432
    s_add_u32 s22, s22, 1
    s_cmp_eq_u32 s22, 9
    s_cselect_b32 s22, 0, s22
    v_mfma_f32_16x16x32_bf16 v[64:67], v[32:35], a[56:59], v[64:67]
    buffer_load_dwordx4 a[100:103], v212, s[16:19], s25 offen offset:0 sc1
    v_mfma_f32_16x16x32_bf16 v[80:83], v[32:35], a[60:63], v[80:83]
    ds_read_b64_tr_b16 v[16:17], v207 offset:36864
    ds_read_b64_tr_b16 v[18:19], v207 offset:38912
    s_waitcnt vmcnt(8) lgkmcnt(8)
    v_mfma_f32_16x16x32_bf16 v[52:55], v[36:39], a[64:67], v[52:55]
    ds_read_b64_tr_b16 v[20:21], v204 offset:40960
    ds_read_b64_tr_b16 v[22:23], v204 offset:43008
    v_mfma_f32_16x16x32_bf16 v[68:71], v[36:39], a[68:71], v[68:71]
    buffer_load_dwordx4 a[104:107], v212, s[16:19], s24 offen offset:1024 sc1
    v_mfma_f32_16x16x32_bf16 v[56:59], v[40:43], a[64:67], v[56:59]
    ds_read_b64_tr_b16 v[24:25], v205 offset:40960
    ds_read_b64_tr_b16 v[26:27], v205 offset:43008
    v_mfma_f32_16x16x32_bf16 v[72:75], v[40:43], a[68:71], v[72:75]
    ds_read_b64_tr_b16 v[28:29], v206 offset:40960
    ds_read_b64_tr_b16 v[30:31], v206 offset:43008
    v_mfma_f32_16x16x32_bf16 v[60:63], v[44:47], a[64:67], v[60:63]
    buffer_load_dwordx4 a[108:111], v212, s[16:19], s25 offen offset:1024 sc1
    v_mfma_f32_16x16x32_bf16 v[76:79], v[44:47], a[68:71], v[76:79]
    ds_read_b64_tr_b16 v[32:33], v207 offset:40960
    ds_read_b64_tr_b16 v[34:35], v207 offset:43008
    v_mfma_f32_16x16x32_bf16 v[64:67], v[48:51], a[64:67], v[64:67]
    v_mfma_f32_16x16x32_bf16 v[80:83], v[48:51], a[68:71], v[80:83]
    s_waitcnt vmcnt(8) lgkmcnt(8)
    v_mfma_f32_16x16x32_bf16 v[52:55], v[4:7], a[72:75], v[52:55]
    ds_read_b64_tr_b16 v[36:37], v204 offset:45056
    ds_read_b64_tr_b16 v[38:39], v204 offset:47104
    v_mfma_f32_16x16x32_bf16 v[68:71], v[4:7], a[76:79], v[68:71]
    s_lshl_b32 s24, s22, 11
    s_add_u32 s24, s24, s26
    v_mfma_f32_16x16x32_bf16 v[56:59], v[8:11], a[72:75], v[56:59]
    buffer_load_dwordx4 a[112:115], v212, s[16:19], s24 offen offset:0 sc1
    v_mfma_f32_16x16x32_bf16 v[72:75], v[8:11], a[76:79], v[72:75]
    ds_read_b64_tr_b16 v[40:41], v205 offset:45056
    ds_read_b64_tr_b16 v[42:43], v205 offset:47104
    v_mfma_f32_16x16x32_bf16 v[60:63], v[12:15], a[72:75], v[60:63]
    ds_read_b64_tr_b16 v[44:45], v206 offset:45056
    ds_read_b64_tr_b16 v[46:47], v206 offset:47104
    v_mfma_f32_16x16x32_bf16 v[76:79], v[12:15], a[76:79], v[76:79]
    s_add_u32 s25, s24, 18432
    s_add_u32 s22, s22, 1
    s_cmp_eq_u32 s22, 9
    s_cselect_b32 s22, 0, s22
    v_mfma_f32_16x16x32_bf16 v[64:67], v[16:19], a[72:75], v[64:67]
    buffer_load_dwordx4 a[116:119], v212, s[16:19], s25 offen offset:0 sc1
    v_mfma_f32_16x16x32_bf16 v[80:83], v[16:19], a[76:79], v[80:83]
    ds_read_b64_tr_b16 v[48:49], v207 offset:45056
    ds_read_b64_tr_b16 v[50:51], v207 offset:47104
    s_waitcnt vmcnt(8) lgkmcnt(8)
    v_mfma_f32_16x16x32_bf16 v[52:55], v[20:23], a[80:83], v[52:55]
    ds_read_b64_tr_b16 v[4:5], v208 offset:0
    ds_read_b64_tr_b16 v[6:7], v208 offset:2048
    v_mfma_f32_16x16x32_bf16 v[68:71], v[20:23], a[84:87], v[68:71]
    buffer_load_dwordx4 a[120:123], v212, s[16:19], s24 offen offset:1024 sc1
    v_mfma_f32_16x16x32_bf16 v[56:59], v[24:27], a[80:83], v[56:59]
    ds_read_b64_tr_b16 v[8:9], v209 offset:0
    ds_read_b64_tr_b16 v[10:11], v209 offset:2048
    v_mfma_f32_16x16x32_bf16 v[72:75], v[24:27], a[84:87], v[72:75]
    ds_read_b64_tr_b16 v[12:13], v210 offset:0
    ds_read_b64_tr_b16 v[14:15], v210 offset:2048
    v_mfma_f32_16x16x32_bf16 v[60:63], v[28:31], a[80:83], v[60:63]
    buffer_load_dwordx4 a[124:127], v212, s[16:19], s25 offen offset:1024 sc1
    v_mfma_f32_16x16x32_bf16 v[76:79], v[28:31], a[84:87], v[76:79]
    ds_read_b64_tr_b16 v[16:17], v211 offset:0
    ds_read_b64_tr_b16 v[18:19], v211 offset:2048
    v_mfma_f32_16x16x32_bf16 v[64:67], v[32:35], a[80:83], v[64:67]
    v_mfma_f32_16x16x32_bf16 v[80:83], v[32:35], a[84:87], v[80:83]
    s_cmp_lt_u32 s23, 2
    s_cbranch_scc1 G_d1
    s_mov_b32 s3, 0
SP_15:
    s_waitcnt lgkmcnt(0)
    s_cmp_ge_u32 s4, s44
    s_cbranch_scc1 OK_16
    s_add_u32 s3, s3, 1
    s_cmp_gt_u32 s3, 200000
    s_cbranch_scc1 OK_16
    s_sleep 2
    s_load_dword s4, s[28:29], s43 glc
    s_branch SP_15
OK_16:
    s_cmp_lg_u32 s23, 3
    s_cbranch_scc1 G_d1
    s_mov_b32 m0, 33280
    s_lshl_b32 s54, s27, 12
    s_add_u32 s54, s54, 4718592
    buffer_load_dwordx4 v212, s[16:19], s54 offen offset:0 sc1 lds
    buffer_load_dwordx4 v212, s[16:19], s54 offen offset:1024 sc1 lds
    buffer_load_dwordx4 v212, s[16:19], s54 offen offset:2048 sc1 lds
    buffer_load_dwordx4 v212, s[16:19], s54 offen offset:3072 sc1 lds
G_d1:
    s_waitcnt vmcnt(8) lgkmcnt(8)
    v_mfma_f32_16x16x32_bf16 v[52:55], v[36:39], a[88:91], v[52:55]
    ds_read_b64_tr_b16 v[20:21], v208 offset:4096
    ds_read_b64_tr_b16 v[22:23], v208 offset:6144
    v_mfma_f32_16x16x32_bf16 v[68:71], v[36:39], a[92:95], v[68:71]
    s_lshl_b32 s24, s22, 11
    s_add_u32 s24, s24, s26
    v_mfma_f32_16x16x32_bf16 v[56:59], v[40:43], a[88:91], v[56:59]
    buffer_load_dwordx4 a[128:131], v212, s[16:19], s24 offen offset:0 sc1
    v_mfma_f32_16x16x32_bf16 v[72:75], v[40:43], a[92:95], v[72:75]
    ds_read_b64_tr_b16 v[24:25], v209 offset:4096
    ds_read_b64_tr_b16 v[26:27], v209 offset:6144
    v_mfma_f32_16x16x32_bf16 v[60:63], v[44:47], a[88:91], v[60:63]
    ds_read_b64_tr_b16 v[28:29], v210 offset:4096
    ds_read_b64_tr_b16 v[30:31], v210 offset:6144
    v_mfma_f32_16x16x32_bf16 v[76:79], v[44:47], a[92:95], v[76:79]
    s_add_u32 s25, s24, 18432
    s_add_u32 s22, s22, 1
    s_cmp_eq_u32 s22, 9
    s_cselect_b32 s22, 0, s22
    v_mfma_f32_16x16x32_bf16 v[64:67], v[48:51], a[88:91], v[64:67]
    buffer_load_dwordx4 a[132:135], v212, s[16:19], s25 offen offset:0 sc1
    v_mfma_f32_16x16x32_bf16 v[80:83], v[48:51], a[92:95], v[80:83]
    ds_read_b64_tr_b16 v[32:33], v211 offset:4096
    ds_read_b64_tr_b16 v[34:35], v211 offset:6144
    s_waitcnt vmcnt(8) lgkmcnt(8)
    v_mfma_f32_16x16x32_bf16 v[52:55], v[4:7], a[96:99], v[52:55]
    ds_read_b64_tr_b16 v[36:37], v208 offset:8192
    ds_read_b64_tr_b16 v[38:39], v208 offset:10240
    v_mfma_f32_16x16x32_bf16 v[68:71], v[4:7], a[100:103], v[68:71]
    buffer_load_dwordx4 a[136:139], v212, s[16:19], s24 offen offset:1024 sc1
    v_mfma_f32_16x16x32_bf16 v[56:59], v[8:11], a[96:99], v[56:59]
    ds_read_b64_tr_b16 v[40:41], v209 offset:8192
    ds_read_b64_tr_b16 v[42:43], v209 offset:10240
    v_mfma_f32_16x16x32_bf16 v[72:75], v[8:11], a[100:103], v[72:75]
    ds_read_b64_tr_b16 v[44:45], v210 offset:8192
    ds_read_b64_tr_b16 v[46:47], v210 offset:10240
    v_mfma_f32_16x16x32_bf16 v[60:63], v[12:15], a[96:99], v[60:63]
    buffer_load_dwordx4 a[140:143], v212, s[16:19], s25 offen offset:1024 sc1
    v_mfma_f32_16x16x32_bf16 v[76:79], v[12:15], a[100:103], v[76:79]
    ds_read_b64_tr_b16 v[48:49], v211 offset:8192
    ds_read_b64_tr_b16 v[50:51], v211 offset:10240
    v_mfma_f32_16x16x32_bf16 v[64:67], v[16:19], a[96:99], v[64:67]
    v_mfma_f32_16x16x32_bf16 v[80:83], v[16:19], a[100:103], v[80:83]
    s_waitcnt vmcnt(8) lgkmcnt(8)
    v_mfma_f32_16x16x32_bf16 v[52:55], v[20:23], a[104:107], v[52:55]
    ds_read_b64_tr_b16 v[4:5], v208 offset:12288
    ds_read_b64_tr_b16 v[6:7], v208 offset:14336
    v_mfma_f32_16x16x32_bf16 v[68:71], v[20:23], a[108:111], v[68:71]
    ds_read_b64_tr_b16 v[8:9], v209 offset:12288
    ds_read_b64_tr_b16 v[10:11], v209 offset:14336
    v_mfma_f32_16x16x32_bf16 v[56:59], v[24:27], a[104:107], v[56:59]
    ds_read_b64_tr_b16 v[12:13], v210 offset:12288
    ds_read_b64_tr_b16 v[14:15], v210 offset:14336
    v_mfma_f32_16x16x32_bf16 v[72:75], v[24:27], a[108:111], v[72:75]
    ds_read_b64_tr_b16 v[16:17], v211 offset:12288
    ds_read_b64_tr_b16 v[18:19], v211 offset:14336
    v_mfma_f32_16x16x32_bf16 v[60:63], v[28:31], a[104:107], v[60:63]
    v_mfma_f32_16x16x32_bf16 v[76:79], v[28:31], a[108:111], v[76:79]
    v_mfma_f32_16x16x32_bf16 v[64:67], v[32:35], a[104:107], v[64:67]
    v_mfma_f32_16x16x32_bf16 v[80:83], v[32:35], a[108:111], v[80:83]
    s_waitcnt vmcnt(6) lgkmcnt(8)
    v_mfma_f32_16x16x32_bf16 v[52:55], v[36:39], a[112:115], v[52:55]
    ds_read_b64_tr_b16 v[20:21], v208 offset:16384
    ds_read_b64_tr_b16 v[22:23], v208 offset:18432
    v_mfma_f32_16x16x32_bf16 v[68:71], v[36:39], a[116:119], v[68:71]
    ds_read_b64_tr_b16 v[24:25], v209 offset:16384
    ds_read_b64_tr_b16 v[26:27], v209 offset:18432
    v_mfma_f32_16x16x32_bf16 v[56:59], v[40:43], a[112:115], v[56:59]
    ds_read_b64_tr_b16 v[28:29], v210 offset:16384
    ds_read_b64_tr_b16 v[30:31], v210 offset:18432
    v_mfma_f32_16x16x32_bf16 v[72:75], v[40:43], a[116:119], v[72:75]
    ds_read_b64_tr_b16 v[32:33], v211 offset:16384
    ds_read_b64_tr_b16 v[34:35], v211 offset:18432
    v_mfma_f32_16x16x32_bf16 v[60:63], v[44:47], a[112:115], v[60:63]
    v_mfma_f32_16x16x32_bf16 v[76:79], v[44:47], a[116:119], v[76:79]
    v_mfma_f32_16x16x32_bf16 v[64:67], v[48:51], a[112:115], v[64:67]
    v_mfma_f32_16x16x32_bf16 v[80:83], v[48:51], a[116:119], v[80:83]
    s_waitcnt vmcnt(4) lgkmcnt(8)
    v_mfma_f32_16x16x32_bf16 v[52:55], v[4:7], a[120:123], v[52:55]
    ds_read_b64_tr_b16 v[36:37], v208 offset:20480
    ds_read_b64_tr_b16 v[38:39], v208 offset:22528
    v_mfma_f32_16x16x32_bf16 v[68:71], v[4:7], a[124:127], v[68:71]
    ds_read_b64_tr_b16 v[40:41], v209 offset:20480
    ds_read_b64_tr_b16 v[42:43], v209 offset:22528
    v_mfma_f32_16x16x32_bf16 v[56:59], v[8:11], a[120:123], v[56:59]
    ds_read_b64_tr_b16 v[44:45], v210 offset:20480
    ds_read_b64_tr_b16 v[46:47], v210 offset:22528
    v_mfma_f32_16x16x32_bf16 v[72:75], v[8:11], a[124:127], v[72:75]
    ds_read_b64_tr_b16 v[48:49], v211 offset:20480
    ds_read_b64_tr_b16 v[50:51], v211 offset:22528
    v_mfma_f32_16x16x32_bf16 v[60:63], v[12:15], a[120:123], v[60:63]
    v_mfma_f32_16x16x32_bf16 v[76:79], v[12:15], a[124:127], v[76:79]
    v_mfma_f32_16x16x32_bf16 v[64:67], v[16:19], a[120:123], v[64:67]
    v_mfma_f32_16x16x32_bf16 v[80:83], v[16:19], a[124:127], v[80:83]
    s_waitcnt vmcnt(2) lgkmcnt(8)
    v_mfma_f32_16x16x32_bf16 v[52:55], v[20:23], a[128:131], v[52:55]
    v_mfma_f32_16x16x32_bf16 v[68:71], v[20:23], a[132:135], v[68:71]
    v_mfma_f32_16x16x32_bf16 v[56:59], v[24:27], a[128:131], v[56:59]
    v_mfma_f32_16x16x32_bf16 v[72:75], v[24:27], a[132:135], v[72:75]
    v_mfma_f32_16x16x32_bf16 v[60:63], v[28:31], a[128:131], v[60:63]
    v_mfma_f32_16x16x32_bf16 v[76:79], v[28:31], a[132:135], v[76:79]
    v_mfma_f32_16x16x32_bf16 v[64:67], v[32:35], a[128:131], v[64:67]
    v_mfma_f32_16x16x32_bf16 v[80:83], v[32:35], a[132:135], v[80:83]
    s_waitcnt vmcnt(0) lgkmcnt(0)
    v_mfma_f32_16x16x32_bf16 v[52:55], v[36:39], a[136:139], v[52:55]
    v_mfma_f32_16x16x32_bf16 v[68:71], v[36:39], a[140:143], v[68:71]
    v_mfma_f32_16x16x32_bf16 v[56:59], v[40:43], a[136:139], v[56:59]
    v_mfma_f32_16x16x32_bf16 v[72:75], v[40:43], a[140:143], v[72:75]
    v_mfma_f32_16x16x32_bf16 v[60:63], v[44:47], a[136:139], v[60:63]
    v_mfma_f32_16x16x32_bf16 v[76:79], v[44:47], a[140:143], v[76:79]
    v_mfma_f32_16x16x32_bf16 v[64:67], v[48:51], a[136:139], v[64:67]
    v_mfma_f32_16x16x32_bf16 v[80:83], v[48:51], a[140:143], v[80:83]
    s_lshl_b32 s24, s21, 11
    s_add_u32 s24, s24, s26
    s_add_u32 s24, s24, 2359296
    v_cvt_pk_bf16_f32 v84, v52, v53
    v_cvt_pk_bf16_f32 v85, v54, v55
    v_cvt_pk_bf16_f32 v86, v56, v57
    v_cvt_pk_bf16_f32 v87, v58, v59
    v_cvt_pk_bf16_f32 v88, v60, v61
    v_cvt_pk_bf16_f32 v89, v62, v63
    v_cvt_pk_bf16_f32 v90, v64, v65
    v_cvt_pk_bf16_f32 v91, v66, v67
    buffer_store_dwordx4 v[84:87], v212, s[16:19], s24 offen offset:0 sc1
    buffer_store_dwordx4 v[88:91], v212, s[16:19], s24 offen offset:1024 sc1
    v_cvt_pk_bf16_f32 v92, v68, v69
    v_cvt_pk_bf16_f32 v93, v70, v71
    v_cvt_pk_bf16_f32 v94, v72, v73
    v_cvt_pk_bf16_f32 v95, v74, v75
    v_cvt_pk_bf16_f32 v96, v76, v77
    v_cvt_pk_bf16_f32 v97, v78, v79
    v_cvt_pk_bf16_f32 v98, v80, v81
    v_cvt_pk_bf16_f32 v99, v82, v83
    s_add_u32 s24, s24, 18432
    buffer_store_dwordx4 v[92:95], v212, s[16:19], s24 offen offset:0 sc1
    buffer_store_dwordx4 v[96:99], v212, s[16:19], s24 offen offset:1024 sc1
    v_mov_b32 v184, 0
    v_mov_b32 v185, 0
    v_mov_b32 v186, 0
    v_mov_b32 v187, 0
    v_dot2c_f32_bf16 v184, v200, v84
    v_dot2c_f32_bf16 v185, v84, v84
    v_dot2c_f32_bf16 v186, v200, v92
    v_dot2c_f32_bf16 v187, v92, v92
    v_dot2c_f32_bf16 v184, v200, v85
    v_dot2c_f32_bf16 v185, v85, v85
    v_dot2c_f32_bf16 v186, v200, v93
    v_dot2c_f32_bf16 v187, v93, v93
    v_dot2c_f32_bf16 v184, v200, v86
    v_dot2c_f32_bf16 v185, v86, v86
    v_dot2c_f32_bf16 v186, v200, v94
    v_dot2c_f32_bf16 v187, v94, v94
    v_dot2c_f32_bf16 v184, v200, v87
    v_dot2c_f32_bf16 v185, v87, v87
    v_dot2c_f32_bf16 v186, v200, v95
    v_dot2c_f32_bf16 v187, v95, v95
    v_dot2c_f32_bf16 v184, v200, v88
    v_dot2c_f32_bf16 v185, v88, v88
    v_dot2c_f32_bf16 v186, v200, v96
    v_dot2c_f32_bf16 v187, v96, v96
    v_dot2c_f32_bf16 v184, v200, v89
    v_dot2c_f32_bf16 v185, v89, v89
    v_dot2c_f32_bf16 v186, v200, v97
    v_dot2c_f32_bf16 v187, v97, v97
    v_dot2c_f32_bf16 v184, v200, v90
    v_dot2c_f32_bf16 v185, v90, v90
    v_dot2c_f32_bf16 v186, v200, v98
    v_dot2c_f32_bf16 v187, v98, v98
    v_dot2c_f32_bf16 v184, v200, v91
    v_dot2c_f32_bf16 v185, v91, v91
    v_dot2c_f32_bf16 v186, v200, v99
    v_dot2c_f32_bf16 v187, v99, v99
    s_nop 1
    v_permlane16_swap_b32 v184, v186
    v_permlane16_swap_b32 v185, v187
    v_add_f32 v184, v184, v186
    v_add_f32 v185, v185, v187
    v_mov_b32 v186, v184
    v_mov_b32 v187, v185
    s_nop 0
    v_permlane32_swap_b32 v184, v186
    v_permlane32_swap_b32 v185, v187
    v_add_f32 v184, v184, v186
    v_add_f32 v185, v185, v187
    v_and_b32 v1, 31, v0
    v_lshlrev_b32 v1, 3, v1
    s_lshl_b32 s24, s21, 14
    s_lshl_b32 s25, s30, 8
    s_add_u32 s24, s24, s25
    s_add_u32 s24, s24, 28327936
    buffer_store_dwordx2 v[184:185], v1, s[16:19], s24 offen sc1
    s_lshr_b32 s24, s30, 1
    s_mul_i32 s24, s24, 4352
    s_add_u32 s89, s24, 29476864
    s_load_dwordx2 s[8:9], s[0:1], 88
    s_load_dwordx2 s[12:13], s[0:1], 80
    s_bfe_u32 s21, s2, 262147
    s_bfe_u32 s65, s2, 65538
    s_lshl_b32 s65, s65, 4
    s_add_u32 s21, s21, s65
    v_lshlrev_b32 v240, 4, v0
    s_mov_b32 s10, 2359296
    s_mov_b32 s11, 0x20000
    s_mov_b32 s14, 5308416
    s_mov_b32 s15, 0x20000
    v_lshlrev_b32 v249, 2, v0
    s_mul_i32 s7, s21, 4352
    s_add_u32 s7, s7, 29476864
    s_barrier
    v_and_b32 v3, 7, v0
    v_mul_u32_u24 v3, 4160, v3
    v_bfe_u32 v1, v0, 3, 1
    v_lshrrev_b32 v22, 4, v0
    v_add_u32 v1, v1, v22
    v_lshl_add_u32 v20, v1, 4, v3
    s_lshl_b32 s54, s23, 6
    s_add_u32 s54, s54, 0
    v_add_u32 v20, s54, v20
    v_and_b32 v1, 15, v0
    v_lshlrev_b32 v1, 5, v1
    v_lshlrev_b32 v21, 4, v22
    v_sub_u32 v21, v21, v1
    s_add_u32 s54, s54, 33760
    v_add_u32 v21, s54, v21
    ds_read_b128 v[4:7], v20 offset:0
    ds_read_b128 a[204:207], v21 offset:0
    ds_read_b128 a[196:199], v21 offset:512
    ds_read_b128 a[188:191], v21 offset:1024
    ds_read_b128 a[180:183], v21 offset:1536
    ds_read_b128 a[172:175], v21 offset:2048
    ds_read_b128 a[164:167], v21 offset:2560
    ds_read_b128 a[156:159], v21 offset:3072
    ds_read_b128 a[148:151], v21 offset:3584
    ds_read_b128 v[8:11], v20 offset:256
    ds_read_b128 a[200:203], v21 offset:256
    ds_read_b128 a[192:195], v21 offset:768
    ds_read_b128 a[184:187], v21 offset:1280
    ds_read_b128 a[176:179], v21 offset:1792
    ds_read_b128 a[168:171], v21 offset:2304
    ds_read_b128 a[160:163], v21 offset:2816
    ds_read_b128 a[152:155], v21 offset:3328
    ds_read_b128 a[144:147], v21 offset:3840
    ds_read_b128 v[12:15], v20 offset:512
    ds_read_b128 v[16:19], v20 offset:768
    s_waitcnt lgkmcnt(15)
    v_mfma_f32_16x16x32_bf16 v[64:67], v[4:7], a[204:207], 0
    v_mfma_f32_16x16x32_bf16 v[60:63], v[4:7], a[196:199], 0
    v_mfma_f32_16x16x32_bf16 v[56:59], v[4:7], a[188:191], 0
    v_mfma_f32_16x16x32_bf16 v[52:55], v[4:7], a[180:183], 0
    s_waitcnt lgkmcnt(14)
    v_mfma_f32_16x16x32_bf16 v[48:51], v[4:7], a[172:175], 0
    s_waitcnt lgkmcnt(13)
    v_mfma_f32_16x16x32_bf16 v[44:47], v[4:7], a[164:167], 0
    s_waitcnt lgkmcnt(12)
    v_mfma_f32_16x16x32_bf16 v[40:43], v[4:7], a[156:159], 0
    s_waitcnt lgkmcnt(11)
    v_mfma_f32_16x16x32_bf16 v[36:39], v[4:7], a[148:151], 0
    ds_read_b128 v[4:7], v20 offset:1024
    s_waitcnt lgkmcnt(10)
    v_mfma_f32_16x16x32_bf16 v[64:67], v[8:11], a[200:203], v[64:67]
    s_waitcnt lgkmcnt(9)
    v_mfma_f32_16x16x32_bf16 v[60:63], v[8:11], a[192:195], v[60:63]
    s_waitcnt lgkmcnt(8)
    v_mfma_f32_16x16x32_bf16 v[56:59], v[8:11], a[184:187], v[56:59]
    s_waitcnt lgkmcnt(7)
    v_mfma_f32_16x16x32_bf16 v[52:55], v[8:11], a[176:179], v[52:55]
    s_waitcnt lgkmcnt(6)
    v_mfma_f32_16x16x32_bf16 v[48:51], v[8:11], a[168:171], v[48:51]
    s_waitcnt lgkmcnt(5)
    v_mfma_f32_16x16x32_bf16 v[44:47], v[8:11], a[160:163], v[44:47]
    s_waitcnt lgkmcnt(4)
    v_mfma_f32_16x16x32_bf16 v[40:43], v[8:11], a[152:155], v[40:43]
    s_waitcnt lgkmcnt(3)
    v_mfma_f32_16x16x32_bf16 v[36:39], v[8:11], a[144:147], v[36:39]
    s_waitcnt vmcnt(0)
    s_barrier
    s_bitcmp1_b32 s23, 0
    s_cbranch_scc0 K_nx
    s_mov_b32 s5, 1
    s_atomic_add s5, s[28:29], s89
K_nx:
    ds_read_b128 v[8:11], v20 offset:1280
    s_waitcnt lgkmcnt(3)
    v_mfma_f32_16x16x32_bf16 v[64:67], v[12:15], a[196:199], v[64:67]
    v_lshrrev_b32 v1, 2, v0
    v_and_b32 v1, 8, v1
    v_mfma_f32_16x16x32_bf16 v[60:63], v[12:15], a[188:191], v[60:63]
    v_xor_b32 v1, v1, v0
    s_lshl_b32 s54, s23, 13
    s_add_u32 s64, s59, 0
    buffer_load_dwordx4 v[100:103], v241, s[16:19], s64 offen offset:0 sc1
    v_mfma_f32_16x16x32_bf16 v[56:59], v[12:15], a[180:183], v[56:59]
    s_add_u32 s54, s54, 37888
    v_lshl_add_u32 v1, v1, 4, s54
    v_mfma_f32_16x16x32_bf16 v[52:55], v[12:15], a[172:175], v[52:55]
    v_bfe_u32 v2, v0, 1, 4
    v_and_b32 v3, 1, v0
    buffer_load_dwordx4 v[104:107], v241, s[16:19], s64 offen offset:1024 sc1
    v_mfma_f32_16x16x32_bf16 v[48:51], v[12:15], a[164:167], v[48:51]
    v_lshlrev_b32 v22, 3, v3
    v_xor_b32 v2, v2, v22
    v_mfma_f32_16x16x32_bf16 v[44:47], v[12:15], a[156:159], v[44:47]
    v_lshl_add_u32 v2, v3, 5, v2
    v_lshrrev_b32 v3, 5, v0
    buffer_load_dwordx4 v[108:111], v241, s[16:19], s64 offen offset:2048 sc1
    v_mfma_f32_16x16x32_bf16 v[40:43], v[12:15], a[148:151], v[40:43]
    v_lshl_add_u32 v2, v3, 6, v2
    s_lshl_b32 s54, s23, 11
    ds_read_b128 v[12:15], v20 offset:1536
    s_waitcnt lgkmcnt(3)
    v_mfma_f32_16x16x32_bf16 v[64:67], v[16:19], a[192:195], v[64:67]
    s_add_u32 s54, s54, 37888
    v_lshl_add_u32 v2, v2, 4, s54
    buffer_load_dwordx4 v[112:115], v241, s[16:19], s64 offen offset:3072 sc1
    v_mfma_f32_16x16x32_bf16 v[60:63], v[16:19], a[184:187], v[60:63]
    v_sub_u32 v3, 37360, v252
    ds_read_b128 v[32:35], v3
    v_mfma_f32_16x16x32_bf16 v[56:59], v[16:19], a[176:179], v[56:59]
    v_lshlrev_b32 v253, 16, v253
    s_waitcnt lgkmcnt(0)
    v_and_b32 v24, 0xffff0000, v35
    s_add_u32 s64, s59, 4096
    buffer_load_dwordx4 v[116:119], v241, s[16:19], s64 offen offset:0 sc1
    v_mfma_f32_16x16x32_bf16 v[52:55], v[16:19], a[168:171], v[52:55]
    v_lshlrev_b32 v25, 16, v35
    v_and_b32 v26, 0xffff0000, v34
    v_mfma_f32_16x16x32_bf16 v[48:51], v[16:19], a[160:163], v[48:51]
    v_lshlrev_b32 v27, 16, v34
    v_and_b32 v28, 0xffff0000, v33
    buffer_load_dwordx4 v[120:123], v241, s[16:19], s64 offen offset:1024 sc1
    v_mfma_f32_16x16x32_bf16 v[44:47], v[16:19], a[152:155], v[44:47]
    v_lshlrev_b32 v29, 16, v33
    v_and_b32 v30, 0xffff0000, v32
    v_mfma_f32_16x16x32_bf16 v[40:43], v[16:19], a[144:147], v[40:43]
    v_lshlrev_b32 v31, 16, v32
    v_mul_f32 v24, v24, v253
    buffer_load_dwordx4 v[124:127], v241, s[16:19], s64 offen offset:2048 sc1
    ds_read_b128 v[16:19], v20 offset:1792
    v_mfma_f32_16x16x32_bf16 v[64:67], v[4:7], a[188:191], v[64:67]
    v_mul_f32 v25, v25, v253
    v_mul_f32 v26, v26, v253
    v_mfma_f32_16x16x32_bf16 v[60:63], v[4:7], a[180:183], v[60:63]
    v_mul_f32 v27, v27, v253
    v_mul_f32 v28, v28, v253
    buffer_load_dwordx4 v[128:131], v241, s[16:19], s64 offen offset:3072 sc1
    v_mfma_f32_16x16x32_bf16 v[56:59], v[4:7], a[172:175], v[56:59]
    v_mul_f32 v29, v29, v253
    v_mul_f32 v30, v30, v253
    v_mfma_f32_16x16x32_bf16 v[52:55], v[4:7], a[164:167], v[52:55]
    v_mul_f32 v31, v31, v253
    ds_write_b128 v1, v[36:39] offset:0
    s_add_u32 s64, s59, 8192
    buffer_load_dwordx4 v[132:135], v241, s[16:19], s64 offen offset:0 sc1
    v_mfma_f32_16x16x32_bf16 v[48:51], v[4:7], a[156:159], v[48:51]
    v_mfma_f32_16x16x32_bf16 v[44:47], v[4:7], a[148:151], v[44:47]
    buffer_load_dwordx4 v[136:139], v241, s[16:19], s64 offen offset:1024 sc1
    ds_read_b128 v[4:7], v20 offset:2048
    v_mfma_f32_16x16x32_bf16 v[64:67], v[8:11], a[184:187], v[64:67]
    v_mfma_f32_16x16x32_bf16 v[60:63], v[8:11], a[176:179], v[60:63]
    buffer_load_dwordx4 v[140:143], v241, s[16:19], s64 offen offset:2048 sc1
    v_mfma_f32_16x16x32_bf16 v[56:59], v[8:11], a[168:171], v[56:59]
    v_mfma_f32_16x16x32_bf16 v[52:55], v[8:11], a[160:163], v[52:55]
    buffer_load_dwordx4 v[144:147], v241, s[16:19], s64 offen offset:3072 sc1
    v_mfma_f32_16x16x32_bf16 v[48:51], v[8:11], a[152:155], v[48:51]
    v_mfma_f32_16x16x32_bf16 v[44:47], v[8:11], a[144:147], v[44:47]
    s_add_u32 s64, s59, 12288
    buffer_load_dwordx4 v[148:151], v241, s[16:19], s64 offen offset:0 sc1
    ds_read_b128 v[8:11], v20 offset:2304
    v_mfma_f32_16x16x32_bf16 v[64:67], v[12:15], a[180:183], v[64:67]
    ds_write_b128 v1, v[40:43] offset:1024
    v_mfma_f32_16x16x32_bf16 v[60:63], v[12:15], a[172:175], v[60:63]
    buffer_load_dwordx4 v[152:155], v241, s[16:19], s64 offen offset:1024 sc1
    v_mfma_f32_16x16x32_bf16 v[56:59], v[12:15], a[164:167], v[56:59]
    v_mfma_f32_16x16x32_bf16 v[52:55], v[12:15], a[156:159], v[52:55]
    buffer_load_dwordx4 v[156:159], v241, s[16:19], s64 offen offset:2048 sc1
    v_mfma_f32_16x16x32_bf16 v[48:51], v[12:15], a[148:151], v[48:51]
    ds_read_b128 v[12:15], v20 offset:2560
    s_waitcnt lgkmcnt(5)
    v_mfma_f32_16x16x32_bf16 v[64:67], v[16:19], a[176:179], v[64:67]
    buffer_load_dwordx4 v[160:163], v241, s[16:19], s64 offen offset:3072 sc1
    v_mfma_f32_16x16x32_bf16 v[60:63], v[16:19], a[168:171], v[60:63]
    v_mfma_f32_16x16x32_bf16 v[56:59], v[16:19], a[160:163], v[56:59]
    s_add_u32 s64, s59, 16384
    buffer_load_dwordx4 v[164:167], v241, s[16:19], s64 offen offset:0 sc1
    v_mfma_f32_16x16x32_bf16 v[52:55], v[16:19], a[152:155], v[52:55]
    v_mfma_f32_16x16x32_bf16 v[48:51], v[16:19], a[144:147], v[48:51]
    buffer_load_dwordx4 v[168:171], v241, s[16:19], s64 offen offset:1024 sc1
    s_cmp_lg_u32 s23, 0
    s_cbranch_scc1 XP_17
    s_load_dword s4, s[28:29], s7 glc
XP_17:
    ds_read_b128 v[16:19], v20 offset:2816
    s_waitcnt lgkmcnt(4)
    v_mfma_f32_16x16x32_bf16 v[64:67], v[4:7], a[172:175], v[64:67]
    ds_write_b128 v1, v[44:47] offset:2048
    v_mfma_f32_16x16x32_bf16 v[60:63], v[4:7], a[164:167], v[60:63]
    s_add_u32 s64, s88, 0
    buffer_load_dwordx4 v[172:175], v241, s[16:19], s64 offen offset:0 sc1
    v_mfma_f32_16x16x32_bf16 v[56:59], v[4:7], a[156:159], v[56:59]
    v_mfma_f32_16x16x32_bf16 v[52:55], v[4:7], a[148:151], v[52:55]
    ds_read_b128 v[4:7], v20 offset:3072
    s_waitcnt lgkmcnt(5)
    v_mfma_f32_16x16x32_bf16 v[64:67], v[8:11], a[168:171], v[64:67]
    v_mfma_f32_16x16x32_bf16 v[60:63], v[8:11], a[160:163], v[60:63]
    v_mfma_f32_16x16x32_bf16 v[56:59], v[8:11], a[152:155], v[56:59]
    v_mfma_f32_16x16x32_bf16 v[52:55], v[8:11], a[144:147], v[52:55]
    ds_read_b128 v[8:11], v20 offset:3328
    s_waitcnt lgkmcnt(4)
    v_mfma_f32_16x16x32_bf16 v[64:67], v[12:15], a[164:167], v[64:67]
    ds_write_b128 v1, v[48:51] offset:3072
    v_mfma_f32_16x16x32_bf16 v[60:63], v[12:15], a[156:159], v[60:63]
    v_mfma_f32_16x16x32_bf16 v[56:59], v[12:15], a[148:151], v[56:59]
    ds_read_b128 v[12:15], v20 offset:3584
    s_waitcnt lgkmcnt(5)
    v_mfma_f32_16x16x32_bf16 v[64:67], v[16:19], a[160:163], v[64:67]
    v_mfma_f32_16x16x32_bf16 v[60:63], v[16:19], a[152:155], v[60:63]
    v_mfma_f32_16x16x32_bf16 v[56:59], v[16:19], a[144:147], v[56:59]
    ds_read_b128 v[16:19], v20 offset:3840
    s_waitcnt lgkmcnt(4)
    v_mfma_f32_16x16x32_bf16 v[64:67], v[4:7], a[156:159], v[64:67]
    ds_write_b128 v1, v[52:55] offset:4096
    v_mfma_f32_16x16x32_bf16 v[60:63], v[4:7], a[148:151], v[60:63]
    s_waitcnt lgkmcnt(4)
    v_mfma_f32_16x16x32_bf16 v[64:67], v[8:11], a[152:155], v[64:67]
    v_mfma_f32_16x16x32_bf16 v[60:63], v[8:11], a[144:147], v[60:63]
    s_waitcnt lgkmcnt(2)
    v_mfma_f32_16x16x32_bf16 v[64:67], v[12:15], a[148:151], v[64:67]
    ds_write_b128 v1, v[56:59] offset:5120
    s_waitcnt lgkmcnt(2)
    v_mfma_f32_16x16x32_bf16 v[64:67], v[16:19], a[144:147], v[64:67]
    s_nop 2
    ds_write_b128 v1, v[60:63] offset:6144
    s_nop 3
    ds_write_b128 v1, v[64:67] offset:7168
    s_mul_i32 s65, s23, 18432
    s_mul_i32 s66, s21, 73728
    s_add_u32 s66, s66, s65
    s_add_u32 m0, s65, 90112
    s_add_u32 s66, s66, 2359296
    s_lshl_b32 s65, s21, 6
    v_add_u32 v248, s65, v0
    v_lshlrev_b32 v248, 3, v248
    s_cmp_ge_u32 s23, 1
    s_cbranch_scc1 OK_19
    s_mov_b32 s3, 0
SP_18:
    s_waitcnt lgkmcnt(0)
    s_cmp_ge_u32 s4, 9
    s_cbranch_scc1 OK_19
    s_add_u32 s3, s3, 1
    s_cmp_gt_u32 s3, 200000
    s_cbranch_scc1 OK_19
    s_load_dword s4, s[28:29], s7 glc
    s_branch SP_18
OK_19:
    s_waitcnt lgkmcnt(0)
    s_barrier
    buffer_load_dwordx4 v240, s[16:19], s66 offen offset:0 sc1 lds
    buffer_load_dwordx4 v240, s[16:19], s66 offen offset:1024 sc1 lds
    buffer_load_dwordx4 v240, s[16:19], s66 offen offset:2048 sc1 lds
    buffer_load_dwordx4 v240, s[16:19], s66 offen offset:3072 sc1 lds
    s_add_u32 m0, m0, 4096
    s_add_u32 s66, s66, 4096
    buffer_load_dwordx4 v240, s[16:19], s66 offen offset:0 sc1 lds
    buffer_load_dwordx4 v240, s[16:19], s66 offen offset:1024 sc1 lds
    s_barrier
    buffer_load_dwordx4 v240, s[16:19], s66 offen offset:2048 sc1 lds
    buffer_load_dwordx4 v240, s[16:19], s66 offen offset:3072 sc1 lds
    s_add_u32 m0, m0, 4096
    s_add_u32 s66, s66, 4096
    buffer_load_dwordx4 v240, s[16:19], s66 offen offset:0 sc1 lds
    buffer_load_dwordx4 v240, s[16:19], s66 offen offset:1024 sc1 lds
    buffer_load_dwordx4 v240, s[16:19], s66 offen offset:2048 sc1 lds
    buffer_load_dwordx4 v240, s[16:19], s66 offen offset:3072 sc1 lds
    ds_read_b128 v[68:71], v2 offset:0
    ds_read_b128 v[72:75], v2 offset:256
    ds_read_b128 v[76:79], v2 offset:8192
    ds_read_b128 v[80:83], v2 offset:8448
    ds_read_b128 v[84:87], v2 offset:16384
    ds_read_b128 v[88:91], v2 offset:16640
    ds_read_b128 v[92:95], v2 offset:24576
    ds_read_b128 v[96:99], v2 offset:24832
    s_waitcnt lgkmcnt(4)
    v_pk_add_f32 v[68:69], v[68:69], v[76:77]
    v_pk_add_f32 v[70:71], v[70:71], v[78:79]
    v_pk_add_f32 v[72:73], v[72:73], v[80:81]
    v_pk_add_f32 v[74:75], v[74:75], v[82:83]
    s_waitcnt lgkmcnt(2)
    v_pk_add_f32 v[68:69], v[68:69], v[84:85]
    v_pk_add_f32 v[70:71], v[70:71], v[86:87]
    v_pk_add_f32 v[72:73], v[72:73], v[88:89]
    v_pk_add_f32 v[74:75], v[74:75], v[90:91]
    s_waitcnt lgkmcnt(0)
    v_pk_add_f32 v[68:69], v[68:69], v[92:93]
    v_pk_add_f32 v[70:71], v[70:71], v[94:95]
    v_pk_add_f32 v[72:73], v[72:73], v[96:97]
    v_pk_add_f32 v[74:75], v[74:75], v[98:99]
    v_pk_add_f32 v[68:69], v[68:69], v[24:25]
    v_pk_add_f32 v[70:71], v[70:71], v[26:27]
    v_pk_add_f32 v[72:73], v[72:73], v[28:29]
    v_pk_add_f32 v[74:75], v[74:75], v[30:31]
    v_cvt_pk_bf16_f32 v76, v68, v69
    v_cvt_pk_bf16_f32 v77, v70, v71
    v_cvt_pk_bf16_f32 v78, v72, v73
    v_cvt_pk_bf16_f32 v79, v74, v75
    s_lshr_b32 s54, s27, 4
    s_lshl_b32 s54, s54, 16
    s_and_b32 s5, s27, 15
    s_lshl_b32 s5, s5, 6
    s_add_u32 s54, s54, s5
    s_add_u32 s54, s54, 7077888
    v_lshrrev_b32 v1, 2, v0
    v_and_b32 v3, 3, v0
    v_lshlrev_b32 v3, 4, v3
    v_lshl_add_u32 v1, v1, 10, v3
    s_lshl_b32 s5, s23, 14
    s_add_u32 s54, s54, s5
    buffer_store_dwordx4 v[76:79], v1, s[16:19], s54 offen sc1
    s_bfe_u32 s27, s27, 0x20004
    s_mul_i32 s27, s27, 4352
    s_add_u32 s27, s27, 29724928
    s_mov_b32 s54, 4
    s_branch K_p3
K_side:
    s_load_dwordx4 s[48:51], s[0:1], 8
    s_load_dwordx2 s[52:53], s[0:1], 24
    s_load_dwordx4 s[64:67], s[0:1], 72
    s_sub_u32 s24, s2, 144
    s_lshl_b32 s20, s24, 2
    s_add_u32 s20, s20, s23
    s_mul_i32 s25, s24, 9363
    s_lshr_b32 s25, s25, 16
    s_mul_i32 s26, s25, 7
    s_sub_u32 s26, s24, s26
    s_min_u32 s27, s26, 4
    s_lshl_b32 s24, s26, 1
    s_add_u32 s21, s24, s27
    s_sub_u32 s24, s24, s27
    s_cmp_lt_u32 s26, 4
    s_cselect_b32 s26, 3, 2
    s_mul_i32 s27, s25, 18
    s_add_u32 s21, s21, s27
    s_add_u32 s21, s21, s23
    s_mul_i32 s27, s25, 10
    s_add_u32 s24, s24, s27
    s_add_u32 s24, s24, s23
    s_sub_u32 s24, s24, s26
    s_cmp_lt_u32 s23, s26
    s_cselect_b32 s47, 1, 0
    s_cselect_b32 s21, s21, s24
    s_and_b32 s22, s21, 31
    s_lshr_b32 s30, s21, 5
    s_sub_u32 s34, 32, s22
    s_min_u32 s34, s34, s26
    s_sub_u32 s37, s26, s34
    s_mul_i32 s45, s23, 37888
    s_mul_i32 s24, s20, 5462
    s_lshr_b32 s24, s24, 16
    s_lshl_b32 s24, s24, 2
    s_add_u32 s44, s20, s24
    v_lshlrev_b32 v252, 4, v0
    s_waitcnt lgkmcnt(0)
    s_mov_b32 s54, s66
    s_mov_b32 s55, s67
    s_mov_b64 s[58:59], s[62:63]
    s_mov_b64 s[60:61], s[40:41]
    s_mov_b64 s[62:63], s[42:43]
    s_min_u32 s43, s44, 575
    s_cmp_lg_u32 s2, 255
    s_cbranch_scc1 NZ_20
    s_cmp_lt_u32 s23, 3
    s_cbranch_scc1 NZ_21
    v_mov_b32 v4, 0
    v_mov_b32 v5, 0
    v_mov_b32 v6, 0
    v_mov_b32 v7, 0
    s_mov_b32 s24, 28641280
    v_mul_u32_u24 v1, 4352, v0
    buffer_store_dwordx4 v[4:7], v1, s[16:19], s24 offen sc1
    s_add_u32 s24, s24, 278528
    buffer_store_dwordx4 v[4:7], v1, s[16:19], s24 offen sc1
    s_add_u32 s24, s24, 278528
    buffer_store_dwordx4 v[4:7], v1, s[16:19], s24 offen sc1
    s_add_u32 s24, s24, 278528
    buffer_store_dwordx4 v[4:7], v1, s[16:19], s24 offen sc1
    s_add_u32 s24, s24, 278528
    s_mov_b32 s24, 28475392
    buffer_store_dwordx4 v[4:7], v252, s[16:19], s24 offen offset:0 sc1
    buffer_store_dwordx4 v[4:7], v252, s[16:19], s24 offen offset:1024 sc1
    buffer_store_dwordx4 v[4:7], v252, s[16:19], s24 offen offset:2048 sc1
    buffer_store_dwordx4 v[4:7], v252, s[16:19], s24 offen offset:3072 sc1
    s_add_u32 s24, s24, 4096
    buffer_store_dwordx4 v[4:7], v252, s[16:19], s24 offen offset:0 sc1
    buffer_store_dwordx4 v[4:7], v252, s[16:19], s24 offen offset:1024 sc1
    buffer_store_dwordx4 v[4:7], v252, s[16:19], s24 offen offset:2048 sc1
    buffer_store_dwordx4 v[4:7], v252, s[16:19], s24 offen offset:3072 sc1
    s_add_u32 s24, s24, 4096
    buffer_store_dwordx4 v[4:7], v252, s[16:19], s24 offen offset:0 sc1
    buffer_store_dwordx4 v[4:7], v252, s[16:19], s24 offen offset:1024 sc1
    buffer_store_dwordx4 v[4:7], v252, s[16:19], s24 offen offset:2048 sc1
    buffer_store_dwordx4 v[4:7], v252, s[16:19], s24 offen offset:3072 sc1
    s_add_u32 s24, s24, 4096
    buffer_store_dwordx4 v[4:7], v252, s[16:19], s24 offen offset:0 sc1
    buffer_store_dwordx4 v[4:7], v252, s[16:19], s24 offen offset:1024 sc1
    buffer_store_dwordx4 v[4:7], v252, s[16:19], s24 offen offset:2048 sc1
    buffer_store_dwordx4 v[4:7], v252, s[16:19], s24 offen offset:3072 sc1
    s_add_u32 s24, s24, 4096
    buffer_store_dwordx4 v[4:7], v252, s[16:19], s24 offen offset:0 sc1
    buffer_store_dwordx4 v[4:7], v252, s[16:19], s24 offen offset:1024 sc1
NZ_21:
    s_barrier
NZ_20:
    s_lshl_b32 s24, s43, 12
    s_add_u32 s8, s60, s24
    s_addc_u32 s9, s61, 0
    s_mov_b32 s10, 4096
    s_mov_b32 s11, 0x20000
    s_mov_b32 s12, s62
    s_mov_b32 s13, s63
    s_mov_b32 s14, 1152
    s_mov_b32 s15, 0x20000
    buffer_load_dwordx4 v[214:217], v252, s[8:11], 0 offen offset:0 nt
    buffer_load_dwordx4 v[222:225], v252, s[8:11], 0 offen offset:1024 nt
    buffer_load_dwordx4 v[230:233], v252, s[8:11], 0 offen offset:2048 nt
    buffer_load_dwordx4 v[238:241], v252, s[8:11], 0 offen offset:3072 nt
    s_lshl_b32 s25, s43, 1
    buffer_load_ushort v253, off, s[12:15], s25
    s_cmp_eq_u32 s47, 0
    s_cbranch_scc1 NK0_22
    v_lshrrev_b32 v1, 3, v0
    v_and_b32 v2, 7, v0
    s_lshl_b32 s24, s22, 3
    v_add_u32 v3, s24, v1
    v_mul_u32_u24 v206, 9216, v3
    v_lshl_add_u32 v206, v2, 4, v206
    s_lshl_b32 s24, s30, 7
    v_add_u32 v206, s24, v206
    v_subrev_u32 v207, 3456, v206
    v_lshlrev_b32 v209, 6, v2
    s_mul_i32 s44, s30, 4352
    s_add_u32 s44, s44, 29685760
    s_mov_b32 s8, s52
    s_mov_b32 s9, s53
    s_mov_b32 s10, 4608
    s_lshl_b32 s25, s30, 9
    buffer_load_dwordx4 v[132:135], v209, s[8:11], s25 offen offset:0
    buffer_load_dwordx4 v[136:139], v209, s[8:11], s25 offen offset:16
    buffer_load_dwordx4 v[140:143], v209, s[8:11], s25 offen offset:32
    buffer_load_dwordx4 v[144:147], v209, s[8:11], s25 offen offset:48
    s_mov_b32 s8, s48
    s_mov_b32 s9, s49
    s_mov_b32 s10, 2359296
    s_mov_b32 s24, 0
    buffer_load_dwordx4 v[68:71], v206, s[8:11], s24 offen offset:0 nt
    buffer_load_dwordx4 v[72:75], v206, s[8:11], s24 offen offset:1152 nt
    buffer_load_dwordx4 v[76:79], v206, s[8:11], s24 offen offset:2304 nt
    s_mov_b32 s24, 3456
    buffer_load_dwordx4 v[80:83], v206, s[8:11], s24 offen offset:0 nt
    buffer_load_dwordx4 v[84:87], v206, s[8:11], s24 offen offset:1152 nt
    buffer_load_dwordx4 v[88:91], v206, s[8:11], s24 offen offset:2304 nt
    s_mov_b32 s24, 6912
    buffer_load_dwordx4 v[92:95], v206, s[8:11], s24 offen offset:0 nt
    buffer_load_dwordx4 v[96:99], v206, s[8:11], s24 offen offset:1152 nt
    buffer_load_dwordx4 v[56:59], v207, s[8:11], 0 offen offset:0 nt
    buffer_load_dwordx4 v[60:63], v207, s[8:11], 0 offen offset:1152 nt
    buffer_load_dwordx4 v[64:67], v207, s[8:11], 0 offen offset:2304 nt
    s_mov_b32 s8, s50
    s_mov_b32 s9, s51
    s_mov_b32 s24, 0
    buffer_load_dwordx4 v[100:103], v206, s[8:11], s24 offen offset:0 nt
    buffer_load_dwordx4 v[104:107], v206, s[8:11], s24 offen offset:1152 nt
    buffer_load_dwordx4 v[108:111], v206, s[8:11], s24 offen offset:2304 nt
    s_mov_b32 s24, 3456
    buffer_load_dwordx4 v[112:115], v206, s[8:11], s24 offen offset:0 nt
    buffer_load_dwordx4 v[116:119], v206, s[8:11], s24 offen offset:1152 nt
    buffer_load_dwordx4 v[120:123], v206, s[8:11], s24 offen offset:2304 nt
    s_mov_b32 s24, 6912
    buffer_load_dwordx4 v[124:127], v206, s[8:11], s24 offen offset:0 nt
    buffer_load_dwordx4 v[128:131], v206, s[8:11], s24 offen offset:1152 nt
    v_sub_u32 v1, 7, v1
    v_xor_b32 v1, v1, v2
    v_lshlrev_b32 v1, 4, v1
    v_lshl_add_u32 v208, v2, 9, v1
    v_add_u32 v208, s45, v208
    v_lshrrev_b32 v1, 3, v0
    v_and_b32 v2, 6, v1
    v_and_b32 v3, 7, v0
    v_xor_b32 v2, v2, v3
    v_lshlrev_b32 v2, 4, v2
    v_mul_u32_u24 v250, 9216, v1
    v_add_u32 v250, v250, v2
    v_mul_u32_u24 v251, 1152, v1
    v_add_u32 v251, v251, v2
    v_lshrrev_b32 v1, 2, v0
    v_lshlrev_b32 v3, 7, v1
    v_bfe_u32 v2, v1, 1, 2
    v_lshl_add_u32 v3, v2, 5, v3
    v_and_b32 v2, 3, v0
    v_lshl_add_u32 v3, v2, 3, v3
    s_mul_i32 s24, s23, 37888
    v_add_u32 v244, s24, v3
    v_xor_b32 v245, 32, v244
    v_xor_b32 v246, 64, v244
    v_xor_b32 v247, 96, v244
    v_lshlrev_b32 v252, 4, v0
    s_branch NK1_23
NK0_22:
    v_lshrrev_b32 v1, 3, v0
    v_and_b32 v2, 6, v1
    v_and_b32 v3, 7, v0
    v_xor_b32 v2, v2, v3
    v_lshlrev_b32 v2, 4, v2
    v_mul_u32_u24 v250, 9216, v1
    v_add_u32 v250, v250, v2
    v_mul_u32_u24 v251, 1152, v1
    v_add_u32 v251, v251, v2
    v_lshrrev_b32 v1, 2, v0
    v_lshlrev_b32 v3, 7, v1
    v_bfe_u32 v2, v1, 1, 2
    v_lshl_add_u32 v3, v2, 5, v3
    v_and_b32 v2, 3, v0
    v_lshl_add_u32 v3, v2, 3, v3
    s_mul_i32 s24, s23, 37888
    v_add_u32 v244, s24, v3
    v_xor_b32 v245, 32, v244
    v_xor_b32 v246, 64, v244
    v_xor_b32 v247, 96, v244
    v_lshlrev_b32 v252, 4, v0
    s_cmp_lg_u32 s20, 447
    s_cbranch_scc1 NZ_24
    s_waitcnt vmcnt(5)
    s_mov_b32 s5, 4
    s_atomic_add s5, s[100:101], 0
NZ_24:
NK1_23:
    v_add_u32 v202, s45, v252
    v_mov_b32 v8, 0
    v_mov_b32 v9, 0
    v_mov_b32 v10, 0
    v_mov_b32 v11, 0
    v_lshlrev_b32 v1, 4, v0
    v_add_u32 v1, 37376, v1
    v_and_b32 v3, 7, v0
    v_mul_u32_u24 v3, 4160, v3
    v_cmp_gt_u32 vcc, 32, v0
    s_nop 1
    v_cndmask_b32 v1, v3, v1, vcc
    v_add_u32 v1, s45, v1
    ds_write_b128 v1, v[8:11]
    v_mov_b32 v4, 0x3f803f80
    v_mov_b32 v5, 0x3f803f80
    v_mov_b32 v6, 0x3f803f80
    v_mov_b32 v7, 0x3f803f80
    s_cmp_eq_u32 s47, 0
    s_cbranch_scc1 W0_25
    s_waitcnt vmcnt(23)
    s_branch W1_26
W0_25:
    s_waitcnt vmcnt(0)
    s_mov_b32 s8, s58
    s_mov_b32 s9, s59
    s_mov_b32 s10, 663552
    s_mov_b32 s11, 0x20000
    s_mul_i32 s24, s21, 4224
    v_min_u32 v1, 32, v0
    v_lshlrev_b32 v1, 7, v1
    buffer_load_dword v249, v1, s[8:11], s24 offen
W1_26:
    ds_write_b128 v202, v[214:217] offset:29136
    ds_write_b128 v202, v[222:225] offset:30160
    ds_write_b128 v202, v[230:233] offset:31184
    ds_write_b128 v202, v[238:241] offset:32208
    ds_read_b128 v[210:213], v202 offset:29120
    ds_read_b128 v[218:221], v202 offset:30144
    ds_read_b128 v[226:229], v202 offset:31168
    ds_read_b128 v[234:237], v202 offset:32192
    s_waitcnt lgkmcnt(3)
    v_mov_b32 v12, v211
    v_mov_b32 v13, v212
    v_mov_b32 v14, v213
    v_mov_b32 v15, v214
    v_mov_b32 v16, v215
    v_mov_b32 v17, v216
    v_alignbit_b32 v18, v211, v210, 16
    v_alignbit_b32 v19, v212, v211, 16
    v_alignbit_b32 v20, v213, v212, 16
    v_alignbit_b32 v21, v214, v213, 16
    v_alignbit_b32 v22, v215, v214, 16
    v_alignbit_b32 v23, v216, v215, 16
    v_alignbit_b32 v24, v212, v211, 16
    v_alignbit_b32 v25, v213, v212, 16
    v_alignbit_b32 v26, v214, v213, 16
    v_alignbit_b32 v27, v215, v214, 16
    v_alignbit_b32 v28, v216, v215, 16
    v_alignbit_b32 v29, v217, v216, 16
    ds_write_b128 v202, v[212:215] offset:12496
    ds_write_b128 v202, v[12:15] offset:4176
    ds_write_b128 v202, v[14:17] offset:20816
    ds_write_b128 v202, v[18:21] offset:16
    ds_write_b128 v202, v[20:23] offset:16656
    ds_write_b128 v202, v[24:27] offset:8336
    ds_write_b128 v202, v[26:29] offset:24976
    s_waitcnt lgkmcnt(9)
    v_mov_b32 v32, v219
    v_mov_b32 v33, v220
    v_mov_b32 v34, v221
    v_mov_b32 v35, v222
    v_mov_b32 v36, v223
    v_mov_b32 v37, v224
    v_alignbit_b32 v38, v219, v218, 16
    v_alignbit_b32 v39, v220, v219, 16
    v_alignbit_b32 v40, v221, v220, 16
    v_alignbit_b32 v41, v222, v221, 16
    v_alignbit_b32 v42, v223, v222, 16
    v_alignbit_b32 v43, v224, v223, 16
    v_alignbit_b32 v44, v220, v219, 16
    v_alignbit_b32 v45, v221, v220, 16
    v_alignbit_b32 v46, v222, v221, 16
    v_alignbit_b32 v47, v223, v222, 16
    v_alignbit_b32 v48, v224, v223, 16
    v_alignbit_b32 v49, v225, v224, 16
    ds_write_b128 v202, v[220:223] offset:13520
    ds_write_b128 v202, v[32:35] offset:5200
    ds_write_b128 v202, v[34:37] offset:21840
    ds_write_b128 v202, v[38:41] offset:1040
    ds_write_b128 v202, v[40:43] offset:17680
    ds_write_b128 v202, v[44:47] offset:9360
    ds_write_b128 v202, v[46:49] offset:26000
    s_waitcnt lgkmcnt(15)
    v_mov_b32 v12, v227
    v_mov_b32 v13, v228
    v_mov_b32 v14, v229
    v_mov_b32 v15, v230
    v_mov_b32 v16, v231
    v_mov_b32 v17, v232
    v_alignbit_b32 v18, v227, v226, 16
    v_alignbit_b32 v19, v228, v227, 16
    v_alignbit_b32 v20, v229, v228, 16
    v_alignbit_b32 v21, v230, v229, 16
    v_alignbit_b32 v22, v231, v230, 16
    v_alignbit_b32 v23, v232, v231, 16
    v_alignbit_b32 v24, v228, v227, 16
    v_alignbit_b32 v25, v229, v228, 16
    v_alignbit_b32 v26, v230, v229, 16
    v_alignbit_b32 v27, v231, v230, 16
    v_alignbit_b32 v28, v232, v231, 16
    v_alignbit_b32 v29, v233, v232, 16
    ds_write_b128 v202, v[228:231] offset:14544
    ds_write_b128 v202, v[12:15] offset:6224
    ds_write_b128 v202, v[14:17] offset:22864
    ds_write_b128 v202, v[18:21] offset:2064
    ds_write_b128 v202, v[20:23] offset:18704
    ds_write_b128 v202, v[24:27] offset:10384
    ds_write_b128 v202, v[26:29] offset:27024
    s_waitcnt lgkmcnt(15)
    v_mov_b32 v32, v235
    v_mov_b32 v33, v236
    v_mov_b32 v34, v237
    v_mov_b32 v35, v238
    v_mov_b32 v36, v239
    v_mov_b32 v37, v240
    v_alignbit_b32 v38, v235, v234, 16
    v_alignbit_b32 v39, v236, v235, 16
    v_alignbit_b32 v40, v237, v236, 16
    v_alignbit_b32 v41, v238, v237, 16
    v_alignbit_b32 v42, v239, v238, 16
    v_alignbit_b32 v43, v240, v239, 16
    v_alignbit_b32 v44, v236, v235, 16
    v_alignbit_b32 v45, v237, v236, 16
    v_alignbit_b32 v46, v238, v237, 16
    v_alignbit_b32 v47, v239, v238, 16
    v_alignbit_b32 v48, v240, v239, 16
    v_alignbit_b32 v49, v241, v240, 16
    ds_write_b128 v202, v[236:239] offset:15568
    ds_write_b128 v202, v[32:35] offset:7248
    ds_write_b128 v202, v[34:37] offset:23888
    ds_write_b128 v202, v[38:41] offset:3088
    ds_write_b128 v202, v[40:43] offset:19728
    ds_write_b128 v202, v[44:47] offset:11408
    ds_write_b128 v202, v[46:49] offset:28048
    s_cmp_eq_u32 s47, 0
    s_movk_i32 s24, 320
    s_cselect_b32 s24, 608, s24
    s_add_u32 s31, s21, s24
    s_mul_i32 s25, s31, 911
    s_lshr_b32 s25, s25, 16
    s_mul_i32 s24, s25, 72
    s_sub_u32 s26, s31, s24
    s_mul_i32 s24, s26, 57
    s_lshr_b32 s24, s24, 9
    s_mul_i32 s27, s24, 9
    s_sub_u32 s26, s26, s27
    s_mul_i32 s90, s24, 4352
    s_add_u32 s90, s90, 29616128
    s_cmp_lt_u32 s25, 3
    s_cselect_b32 s24, 0, 34816
    s_add_u32 s90, s90, s24
    s_cmp_eq_u32 s25, 0
    s_cselect_b32 s25, 9, s25
    s_sub_u32 s25, s25, 1
    s_add_u32 s89, s27, s25
    s_lshl_b32 s91, s89, 8
    s_add_u32 s91, s91, 28475392
    s_lshl_b32 s88, s89, 7
    s_mul_i32 s24, s26, 589824
    s_add_u32 s88, s88, s24
    s_mul_i32 s89, s89, 73728
    s_lshl_b32 s24, s26, 11
    s_add_u32 s89, s89, s24
    s_add_u32 s89, s89, 33030144
    s_cmp_ge_u32 s31, 648
    s_cselect_b32 s49, 0, 1
    s_cselect_b32 s88, 5308416, s88
    s_cselect_b32 s89, 46006272, s89
    s_cselect_b32 s91, 46006272, s91
    s_mov_b32 s12, s64
    s_mov_b32 s13, s65
    s_mov_b32 s14, 5308416
    s_mov_b32 s15, 0x20000
    s_load_dword s4, s[100:101], 0
    s_cmp_eq_u32 s47, 0
    s_cbranch_scc1 NOKV_27
    v_add_u32 v1, 33280, v202
    v_lshrrev_b32 v2, 3, v0
    v_lshrrev_b32 v3, 2, v2
    v_lshlrev_b32 v207, 4, v3
    v_xor_b32 v1, v1, v207
    v_and_b32 v2, 3, v2
    v_lshl_add_u32 v2, v3, 3, v2
    v_lshlrev_b32 v2, 12, v2
    v_and_b32 v3, 7, v0
    v_lshl_add_u32 v2, v3, 4, v2
    s_lshl_b32 s26, s30, 18
    s_sub_u32 s25, 31, s22
    s_lshl_b32 s25, s25, 7
    s_add_u32 s26, s26, s25
    s_add_u32 s26, s26, 4718592
    s_waitcnt vmcnt(19)
    v_lshlrev_b32 v148, 16, v132
    v_and_b32 v150, 0xffff0000, v132
    v_lshlrev_b32 v152, 16, v133
    v_and_b32 v154, 0xffff0000, v133
    v_lshlrev_b32 v149, 16, v134
    v_and_b32 v151, 0xffff0000, v134
    v_lshlrev_b32 v153, 16, v135
    v_and_b32 v155, 0xffff0000, v135
    v_lshlrev_b32 v156, 16, v136
    v_and_b32 v158, 0xffff0000, v136
    v_lshlrev_b32 v160, 16, v137
    v_and_b32 v162, 0xffff0000, v137
    v_lshlrev_b32 v157, 16, v138
    v_and_b32 v159, 0xffff0000, v138
    v_lshlrev_b32 v161, 16, v139
    v_and_b32 v163, 0xffff0000, v139
    v_lshlrev_b32 v164, 16, v140
    v_and_b32 v166, 0xffff0000, v140
    v_lshlrev_b32 v168, 16, v141
    v_and_b32 v170, 0xffff0000, v141
    v_lshlrev_b32 v165, 16, v142
    v_and_b32 v167, 0xffff0000, v142
    v_lshlrev_b32 v169, 16, v143
    v_and_b32 v171, 0xffff0000, v143
    v_lshlrev_b32 v172, 16, v144
    v_and_b32 v174, 0xffff0000, v144
    v_lshlrev_b32 v176, 16, v145
    v_and_b32 v178, 0xffff0000, v145
    v_lshlrev_b32 v173, 16, v146
    v_and_b32 v175, 0xffff0000, v146
    v_lshlrev_b32 v177, 16, v147
    v_and_b32 v179, 0xffff0000, v147
    s_waitcnt vmcnt(0)
    v_lshlrev_b32 v180, 16, v56
    v_and_b32 v181, 0xffff0000, v56
    v_lshlrev_b32 v182, 16, v60
    v_and_b32 v183, 0xffff0000, v60
    v_lshlrev_b32 v184, 16, v64
    v_and_b32 v185, 0xffff0000, v64
    v_lshlrev_b32 v186, 16, v68
    v_and_b32 v187, 0xffff0000, v68
    v_lshlrev_b32 v188, 16, v72
    v_and_b32 v189, 0xffff0000, v72
    v_lshlrev_b32 v190, 16, v76
    v_and_b32 v191, 0xffff0000, v76
    v_lshlrev_b32 v192, 16, v80
    v_and_b32 v193, 0xffff0000, v80
    v_lshlrev_b32 v194, 16, v84
    v_and_b32 v195, 0xffff0000, v84
    v_lshlrev_b32 v196, 16, v88
    v_and_b32 v197, 0xffff0000, v88
    v_lshlrev_b32 v198, 16, v92
    v_and_b32 v199, 0xffff0000, v92
    v_lshlrev_b32 v200, 16, v96
    v_and_b32 v201, 0xffff0000, v96
    v_pk_mul_f32 v[24:25], v[180:181], v[154:155]
    v_pk_mul_f32 v[26:27], v[182:183], v[154:155]
    v_pk_mul_f32 v[28:29], v[184:185], v[154:155]
    v_pk_mul_f32 v[30:31], v[186:187], v[154:155]
    v_pk_mul_f32 v[32:33], v[188:189], v[154:155]
    v_pk_mul_f32 v[34:35], v[190:191], v[154:155]
    v_pk_mul_f32 v[36:37], v[192:193], v[154:155]
    v_pk_mul_f32 v[38:39], v[194:195], v[154:155]
    v_pk_fma_f32 v[24:25], v[182:183], v[152:153], v[24:25]
    v_pk_fma_f32 v[26:27], v[184:185], v[152:153], v[26:27]
    v_pk_fma_f32 v[28:29], v[186:187], v[152:153], v[28:29]
    v_pk_fma_f32 v[30:31], v[188:189], v[152:153], v[30:31]
    v_pk_fma_f32 v[32:33], v[190:191], v[152:153], v[32:33]
    v_pk_fma_f32 v[34:35], v[192:193], v[152:153], v[34:35]
    v_pk_fma_f32 v[36:37], v[194:195], v[152:153], v[36:37]
    v_pk_fma_f32 v[38:39], v[196:197], v[152:153], v[38:39]
    v_pk_fma_f32 v[24:25], v[184:185], v[150:151], v[24:25]
    v_pk_fma_f32 v[26:27], v[186:187], v[150:151], v[26:27]
    v_pk_fma_f32 v[28:29], v[188:189], v[150:151], v[28:29]
    v_pk_fma_f32 v[30:31], v[190:191], v[150:151], v[30:31]
    v_pk_fma_f32 v[32:33], v[192:193], v[150:151], v[32:33]
    v_pk_fma_f32 v[34:35], v[194:195], v[150:151], v[34:35]
    v_pk_fma_f32 v[36:37], v[196:197], v[150:151], v[36:37]
    v_pk_fma_f32 v[38:39], v[198:199], v[150:151], v[38:39]
    v_pk_fma_f32 v[24:25], v[186:187], v[148:149], v[24:25]
    v_pk_fma_f32 v[26:27], v[188:189], v[148:149], v[26:27]
    v_pk_fma_f32 v[28:29], v[190:191], v[148:149], v[28:29]
    v_pk_fma_f32 v[30:31], v[192:193], v[148:149], v[30:31]
    v_pk_fma_f32 v[32:33], v[194:195], v[148:149], v[32:33]
    v_pk_fma_f32 v[34:35], v[196:197], v[148:149], v[34:35]
    v_pk_fma_f32 v[36:37], v[198:199], v[148:149], v[36:37]
    v_pk_fma_f32 v[38:39], v[200:201], v[148:149], v[38:39]
    v_lshlrev_b32 v180, 16, v100
    v_and_b32 v181, 0xffff0000, v100
    v_lshlrev_b32 v182, 16, v104
    v_and_b32 v183, 0xffff0000, v104
    v_lshlrev_b32 v184, 16, v108
    v_and_b32 v185, 0xffff0000, v108
    v_lshlrev_b32 v186, 16, v112
    v_and_b32 v187, 0xffff0000, v112
    v_lshlrev_b32 v188, 16, v116
    v_and_b32 v189, 0xffff0000, v116
    v_lshlrev_b32 v190, 16, v120
    v_and_b32 v191, 0xffff0000, v120
    v_lshlrev_b32 v192, 16, v124
    v_and_b32 v193, 0xffff0000, v124
    v_lshlrev_b32 v194, 16, v128
    v_and_b32 v195, 0xffff0000, v128
    v_pk_mul_f32 v[24:25], v[24:25], v[180:181]
    v_pk_mul_f32 v[26:27], v[26:27], v[182:183]
    v_pk_mul_f32 v[28:29], v[28:29], v[184:185]
    v_pk_mul_f32 v[30:31], v[30:31], v[186:187]
    v_pk_mul_f32 v[32:33], v[32:33], v[188:189]
    v_pk_mul_f32 v[34:35], v[34:35], v[190:191]
    v_pk_mul_f32 v[36:37], v[36:37], v[192:193]
    v_pk_mul_f32 v[38:39], v[38:39], v[194:195]
    v_cvt_pk_bf16_f32 v40, v38, v36
    v_cvt_pk_bf16_f32 v41, v34, v32
    v_cvt_pk_bf16_f32 v42, v30, v28
    v_cvt_pk_bf16_f32 v43, v26, v24
    ds_write_b128 v208, v[40:43] offset:33280
    v_cvt_pk_bf16_f32 v44, v39, v37
    v_cvt_pk_bf16_f32 v45, v35, v33
    v_cvt_pk_bf16_f32 v46, v31, v29
    v_cvt_pk_bf16_f32 v47, v27, v25
    ds_write_b128 v208, v[44:47] offset:33408
    v_lshlrev_b32 v180, 16, v57
    v_and_b32 v181, 0xffff0000, v57
    v_lshlrev_b32 v182, 16, v61
    v_and_b32 v183, 0xffff0000, v61
    v_lshlrev_b32 v184, 16, v65
    v_and_b32 v185, 0xffff0000, v65
    v_lshlrev_b32 v186, 16, v69
    v_and_b32 v187, 0xffff0000, v69
    v_lshlrev_b32 v188, 16, v73
    v_and_b32 v189, 0xffff0000, v73
    v_lshlrev_b32 v190, 16, v77
    v_and_b32 v191, 0xffff0000, v77
    v_lshlrev_b32 v192, 16, v81
    v_and_b32 v193, 0xffff0000, v81
    v_lshlrev_b32 v194, 16, v85
    v_and_b32 v195, 0xffff0000, v85
    v_lshlrev_b32 v196, 16, v89
    v_and_b32 v197, 0xffff0000, v89
    v_lshlrev_b32 v198, 16, v93
    v_and_b32 v199, 0xffff0000, v93
    v_lshlrev_b32 v200, 16, v97
    v_and_b32 v201, 0xffff0000, v97
    v_pk_mul_f32 v[24:25], v[180:181], v[162:163]
    v_pk_mul_f32 v[26:27], v[182:183], v[162:163]
    v_pk_mul_f32 v[28:29], v[184:185], v[162:163]
    v_pk_mul_f32 v[30:31], v[186:187], v[162:163]
    v_pk_mul_f32 v[32:33], v[188:189], v[162:163]
    v_pk_mul_f32 v[34:35], v[190:191], v[162:163]
    v_pk_mul_f32 v[36:37], v[192:193], v[162:163]
    v_pk_mul_f32 v[38:39], v[194:195], v[162:163]
    v_pk_fma_f32 v[24:25], v[182:183], v[160:161], v[24:25]
    v_pk_fma_f32 v[26:27], v[184:185], v[160:161], v[26:27]
    v_pk_fma_f32 v[28:29], v[186:187], v[160:161], v[28:29]
    v_pk_fma_f32 v[30:31], v[188:189], v[160:161], v[30:31]
    v_pk_fma_f32 v[32:33], v[190:191], v[160:161], v[32:33]
    v_pk_fma_f32 v[34:35], v[192:193], v[160:161], v[34:35]
    v_pk_fma_f32 v[36:37], v[194:195], v[160:161], v[36:37]
    v_pk_fma_f32 v[38:39], v[196:197], v[160:161], v[38:39]
    v_pk_fma_f32 v[24:25], v[184:185], v[158:159], v[24:25]
    v_pk_fma_f32 v[26:27], v[186:187], v[158:159], v[26:27]
    v_pk_fma_f32 v[28:29], v[188:189], v[158:159], v[28:29]
    v_pk_fma_f32 v[30:31], v[190:191], v[158:159], v[30:31]
    v_pk_fma_f32 v[32:33], v[192:193], v[158:159], v[32:33]
    v_pk_fma_f32 v[34:35], v[194:195], v[158:159], v[34:35]
    v_pk_fma_f32 v[36:37], v[196:197], v[158:159], v[36:37]
    v_pk_fma_f32 v[38:39], v[198:199], v[158:159], v[38:39]
    v_pk_fma_f32 v[24:25], v[186:187], v[156:157], v[24:25]
    v_pk_fma_f32 v[26:27], v[188:189], v[156:157], v[26:27]
    v_pk_fma_f32 v[28:29], v[190:191], v[156:157], v[28:29]
    v_pk_fma_f32 v[30:31], v[192:193], v[156:157], v[30:31]
    v_pk_fma_f32 v[32:33], v[194:195], v[156:157], v[32:33]
    v_pk_fma_f32 v[34:35], v[196:197], v[156:157], v[34:35]
    v_pk_fma_f32 v[36:37], v[198:199], v[156:157], v[36:37]
    v_pk_fma_f32 v[38:39], v[200:201], v[156:157], v[38:39]
    v_lshlrev_b32 v180, 16, v101
    v_and_b32 v181, 0xffff0000, v101
    v_lshlrev_b32 v182, 16, v105
    v_and_b32 v183, 0xffff0000, v105
    v_lshlrev_b32 v184, 16, v109
    v_and_b32 v185, 0xffff0000, v109
    v_lshlrev_b32 v186, 16, v113
    v_and_b32 v187, 0xffff0000, v113
    v_lshlrev_b32 v188, 16, v117
    v_and_b32 v189, 0xffff0000, v117
    v_lshlrev_b32 v190, 16, v121
    v_and_b32 v191, 0xffff0000, v121
    v_lshlrev_b32 v192, 16, v125
    v_and_b32 v193, 0xffff0000, v125
    v_lshlrev_b32 v194, 16, v129
    v_and_b32 v195, 0xffff0000, v129
    v_pk_mul_f32 v[24:25], v[24:25], v[180:181]
    v_pk_mul_f32 v[26:27], v[26:27], v[182:183]
    v_pk_mul_f32 v[28:29], v[28:29], v[184:185]
    v_pk_mul_f32 v[30:31], v[30:31], v[186:187]
    v_pk_mul_f32 v[32:33], v[32:33], v[188:189]
    v_pk_mul_f32 v[34:35], v[34:35], v[190:191]
    v_pk_mul_f32 v[36:37], v[36:37], v[192:193]
    v_pk_mul_f32 v[38:39], v[38:39], v[194:195]
    v_cvt_pk_bf16_f32 v48, v38, v36
    v_cvt_pk_bf16_f32 v49, v34, v32
    v_cvt_pk_bf16_f32 v50, v30, v28
    v_cvt_pk_bf16_f32 v51, v26, v24
    ds_write_b128 v208, v[48:51] offset:33536
    v_cvt_pk_bf16_f32 v52, v39, v37
    v_cvt_pk_bf16_f32 v53, v35, v33
    v_cvt_pk_bf16_f32 v54, v31, v29
    v_cvt_pk_bf16_f32 v55, v27, v25
    ds_write_b128 v208, v[52:55] offset:33664
    v_xor_b32 v3, 0, v1
    ds_read_b128 v[210:213], v3 offset:0
    v_xor_b32 v3, 32, v1
    ds_read_b128 v[214:217], v3 offset:1024
    v_xor_b32 v3, 64, v1
    ds_read_b128 v[218:221], v3 offset:2048
    v_xor_b32 v3, 96, v1
    ds_read_b128 v[222:225], v3 offset:3072
    s_add_u32 s24, s26, 0
    v_lshlrev_b32 v180, 16, v58
    v_and_b32 v181, 0xffff0000, v58
    v_lshlrev_b32 v182, 16, v62
    v_and_b32 v183, 0xffff0000, v62
    v_lshlrev_b32 v184, 16, v66
    v_and_b32 v185, 0xffff0000, v66
    v_lshlrev_b32 v186, 16, v70
    v_and_b32 v187, 0xffff0000, v70
    v_lshlrev_b32 v188, 16, v74
    v_and_b32 v189, 0xffff0000, v74
    v_lshlrev_b32 v190, 16, v78
    v_and_b32 v191, 0xffff0000, v78
    v_lshlrev_b32 v192, 16, v82
    v_and_b32 v193, 0xffff0000, v82
    v_lshlrev_b32 v194, 16, v86
    v_and_b32 v195, 0xffff0000, v86
    v_lshlrev_b32 v196, 16, v90
    v_and_b32 v197, 0xffff0000, v90
    v_lshlrev_b32 v198, 16, v94
    v_and_b32 v199, 0xffff0000, v94
    v_lshlrev_b32 v200, 16, v98
    v_and_b32 v201, 0xffff0000, v98
    s_waitcnt lgkmcnt(3)
    buffer_store_dwordx4 v[210:213], v2, s[16:19], s24 offen sc1
    s_add_u32 s24, s24, 65536
    s_waitcnt lgkmcnt(2)
    buffer_store_dwordx4 v[214:217], v2, s[16:19], s24 offen sc1
    s_add_u32 s24, s24, 65536
    s_waitcnt lgkmcnt(1)
    buffer_store_dwordx4 v[218:221], v2, s[16:19], s24 offen sc1
    s_add_u32 s24, s24, 65536
    s_waitcnt lgkmcnt(0)
    buffer_store_dwordx4 v[222:225], v2, s[16:19], s24 offen sc1
    v_pk_mul_f32 v[24:25], v[180:181], v[170:171]
    v_pk_mul_f32 v[26:27], v[182:183], v[170:171]
    v_pk_mul_f32 v[28:29], v[184:185], v[170:171]
    v_pk_mul_f32 v[30:31], v[186:187], v[170:171]
    v_pk_mul_f32 v[32:33], v[188:189], v[170:171]
    v_pk_mul_f32 v[34:35], v[190:191], v[170:171]
    v_pk_mul_f32 v[36:37], v[192:193], v[170:171]
    v_pk_mul_f32 v[38:39], v[194:195], v[170:171]
    v_pk_fma_f32 v[24:25], v[182:183], v[168:169], v[24:25]
    v_pk_fma_f32 v[26:27], v[184:185], v[168:169], v[26:27]
    v_pk_fma_f32 v[28:29], v[186:187], v[168:169], v[28:29]
    v_pk_fma_f32 v[30:31], v[188:189], v[168:169], v[30:31]
    v_pk_fma_f32 v[32:33], v[190:191], v[168:169], v[32:33]
    v_pk_fma_f32 v[34:35], v[192:193], v[168:169], v[34:35]
    v_pk_fma_f32 v[36:37], v[194:195], v[168:169], v[36:37]
    v_pk_fma_f32 v[38:39], v[196:197], v[168:169], v[38:39]
    v_pk_fma_f32 v[24:25], v[184:185], v[166:167], v[24:25]
    v_pk_fma_f32 v[26:27], v[186:187], v[166:167], v[26:27]
    v_pk_fma_f32 v[28:29], v[188:189], v[166:167], v[28:29]
    v_pk_fma_f32 v[30:31], v[190:191], v[166:167], v[30:31]
    v_pk_fma_f32 v[32:33], v[192:193], v[166:167], v[32:33]
    v_pk_fma_f32 v[34:35], v[194:195], v[166:167], v[34:35]
    v_pk_fma_f32 v[36:37], v[196:197], v[166:167], v[36:37]
    v_pk_fma_f32 v[38:39], v[198:199], v[166:167], v[38:39]
    v_pk_fma_f32 v[24:25], v[186:187], v[164:165], v[24:25]
    v_pk_fma_f32 v[26:27], v[188:189], v[164:165], v[26:27]
    v_pk_fma_f32 v[28:29], v[190:191], v[164:165], v[28:29]
    v_pk_fma_f32 v[30:31], v[192:193], v[164:165], v[30:31]
    v_pk_fma_f32 v[32:33], v[194:195], v[164:165], v[32:33]
    v_pk_fma_f32 v[34:35], v[196:197], v[164:165], v[34:35]
    v_pk_fma_f32 v[36:37], v[198:199], v[164:165], v[36:37]
    v_pk_fma_f32 v[38:39], v[200:201], v[164:165], v[38:39]
    v_lshlrev_b32 v180, 16, v102
    v_and_b32 v181, 0xffff0000, v102
    v_lshlrev_b32 v182, 16, v106
    v_and_b32 v183, 0xffff0000, v106
    v_lshlrev_b32 v184, 16, v110
    v_and_b32 v185, 0xffff0000, v110
    v_lshlrev_b32 v186, 16, v114
    v_and_b32 v187, 0xffff0000, v114
    v_lshlrev_b32 v188, 16, v118
    v_and_b32 v189, 0xffff0000, v118
    v_lshlrev_b32 v190, 16, v122
    v_and_b32 v191, 0xffff0000, v122
    v_lshlrev_b32 v192, 16, v126
    v_and_b32 v193, 0xffff0000, v126
    v_lshlrev_b32 v194, 16, v130
    v_and_b32 v195, 0xffff0000, v130
    v_pk_mul_f32 v[24:25], v[24:25], v[180:181]
    v_pk_mul_f32 v[26:27], v[26:27], v[182:183]
    v_pk_mul_f32 v[28:29], v[28:29], v[184:185]
    v_pk_mul_f32 v[30:31], v[30:31], v[186:187]
    v_pk_mul_f32 v[32:33], v[32:33], v[188:189]
    v_pk_mul_f32 v[34:35], v[34:35], v[190:191]
    v_pk_mul_f32 v[36:37], v[36:37], v[192:193]
    v_pk_mul_f32 v[38:39], v[38:39], v[194:195]
    v_cvt_pk_bf16_f32 v40, v38, v36
    v_cvt_pk_bf16_f32 v41, v34, v32
    v_cvt_pk_bf16_f32 v42, v30, v28
    v_cvt_pk_bf16_f32 v43, v26, v24
    ds_write_b128 v208, v[40:43] offset:33280
    v_cvt_pk_bf16_f32 v44, v39, v37
    v_cvt_pk_bf16_f32 v45, v35, v33
    v_cvt_pk_bf16_f32 v46, v31, v29
    v_cvt_pk_bf16_f32 v47, v27, v25
    ds_write_b128 v208, v[44:47] offset:33408
    v_lshlrev_b32 v180, 16, v59
    v_and_b32 v181, 0xffff0000, v59
    v_lshlrev_b32 v182, 16, v63
    v_and_b32 v183, 0xffff0000, v63
    v_lshlrev_b32 v184, 16, v67
    v_and_b32 v185, 0xffff0000, v67
    v_lshlrev_b32 v186, 16, v71
    v_and_b32 v187, 0xffff0000, v71
    v_lshlrev_b32 v188, 16, v75
    v_and_b32 v189, 0xffff0000, v75
    v_lshlrev_b32 v190, 16, v79
    v_and_b32 v191, 0xffff0000, v79
    v_lshlrev_b32 v192, 16, v83
    v_and_b32 v193, 0xffff0000, v83
    v_lshlrev_b32 v194, 16, v87
    v_and_b32 v195, 0xffff0000, v87
    v_lshlrev_b32 v196, 16, v91
    v_and_b32 v197, 0xffff0000, v91
    v_lshlrev_b32 v198, 16, v95
    v_and_b32 v199, 0xffff0000, v95
    v_lshlrev_b32 v200, 16, v99
    v_and_b32 v201, 0xffff0000, v99
    v_pk_mul_f32 v[24:25], v[180:181], v[178:179]
    v_pk_mul_f32 v[26:27], v[182:183], v[178:179]
    v_pk_mul_f32 v[28:29], v[184:185], v[178:179]
    v_pk_mul_f32 v[30:31], v[186:187], v[178:179]
    v_pk_mul_f32 v[32:33], v[188:189], v[178:179]
    v_pk_mul_f32 v[34:35], v[190:191], v[178:179]
    v_pk_mul_f32 v[36:37], v[192:193], v[178:179]
    v_pk_mul_f32 v[38:39], v[194:195], v[178:179]
    v_pk_fma_f32 v[24:25], v[182:183], v[176:177], v[24:25]
    v_pk_fma_f32 v[26:27], v[184:185], v[176:177], v[26:27]
    v_pk_fma_f32 v[28:29], v[186:187], v[176:177], v[28:29]
    v_pk_fma_f32 v[30:31], v[188:189], v[176:177], v[30:31]
    v_pk_fma_f32 v[32:33], v[190:191], v[176:177], v[32:33]
    v_pk_fma_f32 v[34:35], v[192:193], v[176:177], v[34:35]
    v_pk_fma_f32 v[36:37], v[194:195], v[176:177], v[36:37]
    v_pk_fma_f32 v[38:39], v[196:197], v[176:177], v[38:39]
    v_pk_fma_f32 v[24:25], v[184:185], v[174:175], v[24:25]
    v_pk_fma_f32 v[26:27], v[186:187], v[174:175], v[26:27]
    v_pk_fma_f32 v[28:29], v[188:189], v[174:175], v[28:29]
    v_pk_fma_f32 v[30:31], v[190:191], v[174:175], v[30:31]
    v_pk_fma_f32 v[32:33], v[192:193], v[174:175], v[32:33]
    v_pk_fma_f32 v[34:35], v[194:195], v[174:175], v[34:35]
    v_pk_fma_f32 v[36:37], v[196:197], v[174:175], v[36:37]
    v_pk_fma_f32 v[38:39], v[198:199], v[174:175], v[38:39]
    v_pk_fma_f32 v[24:25], v[186:187], v[172:173], v[24:25]
    v_pk_fma_f32 v[26:27], v[188:189], v[172:173], v[26:27]
    v_pk_fma_f32 v[28:29], v[190:191], v[172:173], v[28:29]
    v_pk_fma_f32 v[30:31], v[192:193], v[172:173], v[30:31]
    v_pk_fma_f32 v[32:33], v[194:195], v[172:173], v[32:33]
    v_pk_fma_f32 v[34:35], v[196:197], v[172:173], v[34:35]
    v_pk_fma_f32 v[36:37], v[198:199], v[172:173], v[36:37]
    v_pk_fma_f32 v[38:39], v[200:201], v[172:173], v[38:39]
    v_lshlrev_b32 v180, 16, v103
    v_and_b32 v181, 0xffff0000, v103
    v_lshlrev_b32 v182, 16, v107
    v_and_b32 v183, 0xffff0000, v107
    v_lshlrev_b32 v184, 16, v111
    v_and_b32 v185, 0xffff0000, v111
    v_lshlrev_b32 v186, 16, v115
    v_and_b32 v187, 0xffff0000, v115
    v_lshlrev_b32 v188, 16, v119
    v_and_b32 v189, 0xffff0000, v119
    v_lshlrev_b32 v190, 16, v123
    v_and_b32 v191, 0xffff0000, v123
    v_lshlrev_b32 v192, 16, v127
    v_and_b32 v193, 0xffff0000, v127
    v_lshlrev_b32 v194, 16, v131
    v_and_b32 v195, 0xffff0000, v131
    v_pk_mul_f32 v[24:25], v[24:25], v[180:181]
    v_pk_mul_f32 v[26:27], v[26:27], v[182:183]
    v_pk_mul_f32 v[28:29], v[28:29], v[184:185]
    v_pk_mul_f32 v[30:31], v[30:31], v[186:187]
    v_pk_mul_f32 v[32:33], v[32:33], v[188:189]
    v_pk_mul_f32 v[34:35], v[34:35], v[190:191]
    v_pk_mul_f32 v[36:37], v[36:37], v[192:193]
    v_pk_mul_f32 v[38:39], v[38:39], v[194:195]
    v_cvt_pk_bf16_f32 v48, v38, v36
    v_cvt_pk_bf16_f32 v49, v34, v32
    v_cvt_pk_bf16_f32 v50, v30, v28
    v_cvt_pk_bf16_f32 v51, v26, v24
    ds_write_b128 v208, v[48:51] offset:33536
    v_cvt_pk_bf16_f32 v52, v39, v37
    v_cvt_pk_bf16_f32 v53, v35, v33
    v_cvt_pk_bf16_f32 v54, v31, v29
    v_cvt_pk_bf16_f32 v55, v27, v25
    ds_write_b128 v208, v[52:55] offset:33664
    v_xor_b32 v3, 0, v1
    ds_read_b128 v[226:229], v3 offset:0
    v_xor_b32 v3, 32, v1
    ds_read_b128 v[230:233], v3 offset:1024
    v_xor_b32 v3, 64, v1
    ds_read_b128 v[234:237], v3 offset:2048
    v_xor_b32 v3, 96, v1
    ds_read_b128 v[238:241], v3 offset:3072
    s_add_u32 s24, s26, 16384
    s_waitcnt lgkmcnt(3)
    buffer_store_dwordx4 v[226:229], v2, s[16:19], s24 offen sc1
    s_add_u32 s24, s24, 65536
    s_waitcnt lgkmcnt(2)
    buffer_store_dwordx4 v[230:233], v2, s[16:19], s24 offen sc1
    s_add_u32 s24, s24, 65536
    s_waitcnt lgkmcnt(1)
    buffer_store_dwordx4 v[234:237], v2, s[16:19], s24 offen sc1
    s_add_u32 s24, s24, 65536
    s_waitcnt lgkmcnt(0)
    buffer_store_dwordx4 v[238:241], v2, s[16:19], s24 offen sc1
    s_mov_b32 s3, 0
SP_29:
    s_waitcnt lgkmcnt(0)
    s_cmp_ge_u32 s4, 4
    s_cbranch_scc1 OK_30
    s_add_u32 s3, s3, 1
    s_cmp_gt_u32 s3, 200000
    s_cbranch_scc1 OK_30
    s_sleep 4
    v_mov_b32 v254, 0
    global_load_dword v255, v254, s[100:101] sc1
    s_waitcnt vmcnt(0)
    v_readfirstlane_b32 s4, v255
    s_nop 0
    s_branch SP_29
OK_30:
    s_waitcnt vmcnt(0)
    s_barrier
    s_cmp_lg_u32 s23, 0
    s_cbranch_scc1 KS_31
    s_atomic_add s34, s[28:29], s44
    s_cmp_eq_u32 s37, 0
    s_cbranch_scc1 KS_31
    s_add_u32 s40, s44, 4352
    s_atomic_add s37, s[28:29], s40
KS_31:
    s_branch S1J_28
NOKV_27:
    s_mov_b32 s3, 0
SP_32:
    s_waitcnt lgkmcnt(0)
    s_cmp_ge_u32 s4, 4
    s_cbranch_scc1 OK_33
    s_add_u32 s3, s3, 1
    s_cmp_gt_u32 s3, 200000
    s_cbranch_scc1 OK_33
    s_sleep 4
    v_mov_b32 v254, 0
    global_load_dword v255, v254, s[100:101] sc1
    s_waitcnt vmcnt(0)
    v_readfirstlane_b32 s4, v255
    s_nop 0
    s_branch SP_32
OK_33:
    s_mov_b32 s31, s21
    s_mul_i32 s25, s31, 911
    s_lshr_b32 s25, s25, 16
    s_mul_i32 s24, s25, 72
    s_sub_u32 s26, s31, s24
    s_mul_i32 s24, s26, 57
    s_lshr_b32 s24, s24, 9
    s_mul_i32 s27, s24, 9
    s_sub_u32 s26, s26, s27
    s_mul_i32 s38, s24, 4352
    s_add_u32 s38, s38, 29616128
    s_cmp_lt_u32 s25, 3
    s_cselect_b32 s24, 0, 34816
    s_add_u32 s38, s38, s24
    s_cmp_eq_u32 s25, 0
    s_cselect_b32 s25, 9, s25
    s_sub_u32 s25, s25, 1
    s_add_u32 s35, s27, s25
    s_lshl_b32 s41, s35, 8
    s_add_u32 s41, s41, 28475392
    s_lshl_b32 s32, s35, 7
    s_mul_i32 s24, s26, 589824
    s_add_u32 s32, s32, s24
    s_mul_i32 s35, s35, 73728
    s_lshl_b32 s24, s26, 11
    s_add_u32 s35, s35, s24
    s_add_u32 s35, s35, 33030144
    s_add_u32 s31, s31, 160
    s_mul_i32 s25, s31, 911
    s_lshr_b32 s25, s25, 16
    s_mul_i32 s24, s25, 72
    s_sub_u32 s26, s31, s24
    s_mul_i32 s24, s26, 57
    s_lshr_b32 s24, s24, 9
    s_mul_i32 s27, s24, 9
    s_sub_u32 s26, s26, s27
    s_mul_i32 s39, s24, 4352
    s_add_u32 s39, s39, 29616128
    s_cmp_lt_u32 s25, 3
    s_cselect_b32 s24, 0, 34816
    s_add_u32 s39, s39, s24
    s_cmp_eq_u32 s25, 0
    s_cselect_b32 s25, 9, s25
    s_sub_u32 s25, s25, 1
    s_add_u32 s36, s27, s25
    s_lshl_b32 s42, s36, 8
    s_add_u32 s42, s42, 28475392
    s_lshl_b32 s33, s36, 7
    s_mul_i32 s24, s26, 589824
    s_add_u32 s33, s33, s24
    s_mul_i32 s36, s36, 73728
    s_lshl_b32 s24, s26, 11
    s_add_u32 s36, s36, s24
    s_add_u32 s36, s36, 33030144
    s_add_u32 s31, s31, 160
    buffer_load_dwordx4 v[136:139], v250, s[12:15], s32 offen nt
    s_add_u32 s32, s32, 73728
    buffer_load_dwordx4 v[140:143], v250, s[12:15], s32 offen nt
    s_add_u32 s32, s32, 73728
    buffer_load_dwordx4 v[144:147], v250, s[12:15], s32 offen nt
    s_add_u32 s32, s32, 73728
    buffer_load_dwordx4 v[148:151], v250, s[12:15], s32 offen nt
    s_add_u32 s32, s32, 73728
    buffer_load_dwordx4 v[152:155], v250, s[12:15], s32 offen nt
    s_add_u32 s32, s32, 73728
    buffer_load_dwordx4 v[156:159], v250, s[12:15], s32 offen nt
    s_add_u32 s32, s32, 73728
    buffer_load_dwordx4 v[160:163], v250, s[12:15], s32 offen nt
    s_add_u32 s32, s32, 73728
    buffer_load_dwordx4 v[164:167], v250, s[12:15], s32 offen nt
    buffer_load_dwordx4 v[168:171], v250, s[12:15], s33 offen nt
    s_add_u32 s33, s33, 73728
    buffer_load_dwordx4 v[172:175], v250, s[12:15], s33 offen nt
    s_add_u32 s33, s33, 73728
    buffer_load_dwordx4 v[176:179], v250, s[12:15], s33 offen nt
    s_add_u32 s33, s33, 73728
    buffer_load_dwordx4 v[180:183], v250, s[12:15], s33 offen nt
    s_add_u32 s33, s33, 73728
    buffer_load_dwordx4 v[184:187], v250, s[12:15], s33 offen nt
    s_add_u32 s33, s33, 73728
    buffer_load_dwordx4 v[188:191], v250, s[12:15], s33 offen nt
    s_add_u32 s33, s33, 73728
    buffer_load_dwordx4 v[192:195], v250, s[12:15], s33 offen nt
    s_add_u32 s33, s33, 73728
    buffer_load_dwordx4 v[196:199], v250, s[12:15], s33 offen nt
    s_barrier
    s_waitcnt vmcnt(8)
    ds_write_b128 v202, v[136:139] offset:33280
    ds_write_b128 v202, v[140:143] offset:34304
    ds_write_b128 v202, v[144:147] offset:35328
    ds_write_b128 v202, v[148:151] offset:36352
    ds_read_b64_tr_b16 v[72:73], v244 offset:33280
    ds_read_b64_tr_b16 v[74:75], v244 offset:35328
    ds_read_b64_tr_b16 v[76:77], v245 offset:33280
    ds_read_b64_tr_b16 v[78:79], v245 offset:35328
    ds_read_b64_tr_b16 v[80:81], v246 offset:33280
    ds_read_b64_tr_b16 v[82:83], v246 offset:35328
    ds_read_b64_tr_b16 v[84:85], v247 offset:33280
    ds_read_b64_tr_b16 v[86:87], v247 offset:35328
    s_add_u32 s24, s35, 0
    s_waitcnt lgkmcnt(6)
    buffer_store_dwordx4 v[72:75], v252, s[16:19], s24 offen offset:0 sc1
    v_mfma_f32_16x16x32_bf16 v[88:91], v[4:7], v[72:75], 0
    s_add_u32 s24, s35, 18432
    s_waitcnt lgkmcnt(4)
    buffer_store_dwordx4 v[76:79], v252, s[16:19], s24 offen offset:0 sc1
    v_mfma_f32_16x16x32_bf16 v[92:95], v[4:7], v[76:79], 0
    s_add_u32 s24, s35, 36864
    s_waitcnt lgkmcnt(2)
    buffer_store_dwordx4 v[80:83], v252, s[16:19], s24 offen offset:0 sc1
    v_mfma_f32_16x16x32_bf16 v[96:99], v[4:7], v[80:83], 0
    s_add_u32 s24, s35, 55296
    s_waitcnt lgkmcnt(0)
    buffer_store_dwordx4 v[84:87], v252, s[16:19], s24 offen offset:0 sc1
    v_mfma_f32_16x16x32_bf16 v[100:103], v[4:7], v[84:87], 0
    ds_write_b128 v202, v[152:155] offset:33280
    ds_write_b128 v202, v[156:159] offset:34304
    ds_write_b128 v202, v[160:163] offset:35328
    ds_write_b128 v202, v[164:167] offset:36352
    ds_read_b64_tr_b16 v[104:105], v244 offset:33280
    ds_read_b64_tr_b16 v[106:107], v244 offset:35328
    ds_read_b64_tr_b16 v[108:109], v245 offset:33280
    ds_read_b64_tr_b16 v[110:111], v245 offset:35328
    ds_read_b64_tr_b16 v[112:113], v246 offset:33280
    ds_read_b64_tr_b16 v[114:115], v246 offset:35328
    ds_read_b64_tr_b16 v[116:117], v247 offset:33280
    ds_read_b64_tr_b16 v[118:119], v247 offset:35328
    s_add_u32 s24, s35, 0
    s_waitcnt lgkmcnt(6)
    buffer_store_dwordx4 v[104:107], v252, s[16:19], s24 offen offset:1024 sc1
    v_mfma_f32_16x16x32_bf16 v[88:91], v[4:7], v[104:107], v[88:91]
    s_add_u32 s24, s35, 18432
    s_waitcnt lgkmcnt(4)
    buffer_store_dwordx4 v[108:111], v252, s[16:19], s24 offen offset:1024 sc1
    v_mfma_f32_16x16x32_bf16 v[92:95], v[4:7], v[108:111], v[92:95]
    s_add_u32 s24, s35, 36864
    s_waitcnt lgkmcnt(2)
    buffer_store_dwordx4 v[112:115], v252, s[16:19], s24 offen offset:1024 sc1
    v_mfma_f32_16x16x32_bf16 v[96:99], v[4:7], v[112:115], v[96:99]
    s_add_u32 s24, s35, 55296
    s_waitcnt lgkmcnt(0)
    buffer_store_dwordx4 v[116:119], v252, s[16:19], s24 offen offset:1024 sc1
    v_mfma_f32_16x16x32_bf16 v[100:103], v[4:7], v[116:119], v[100:103]
    v_lshrrev_b32 v1, 4, v0
    v_cmp_eq_u32 vcc, 1, v1
    v_cmp_eq_u32 s[50:51], 2, v1
    v_cmp_eq_u32 s[52:53], 3, v1
    v_lshlrev_b32 v2, 2, v0
    v_cndmask_b32 v3, v88, v92, vcc
    v_cndmask_b32 v3, v3, v96, s[50:51]
    s_nop 0
    v_cndmask_b32 v248, v3, v100, s[52:53]
    buffer_atomic_add_f32 v248, v2, s[16:19], s41 offen
    s_waitcnt vmcnt(9)
    ds_write_b128 v202, v[168:171] offset:33280
    ds_write_b128 v202, v[172:175] offset:34304
    ds_write_b128 v202, v[176:179] offset:35328
    ds_write_b128 v202, v[180:183] offset:36352
    ds_read_b64_tr_b16 v[72:73], v244 offset:33280
    ds_read_b64_tr_b16 v[74:75], v244 offset:35328
    ds_read_b64_tr_b16 v[76:77], v245 offset:33280
    ds_read_b64_tr_b16 v[78:79], v245 offset:35328
    ds_read_b64_tr_b16 v[80:81], v246 offset:33280
    ds_read_b64_tr_b16 v[82:83], v246 offset:35328
    ds_read_b64_tr_b16 v[84:85], v247 offset:33280
    ds_read_b64_tr_b16 v[86:87], v247 offset:35328
    s_add_u32 s24, s36, 0
    s_waitcnt lgkmcnt(6)
    buffer_store_dwordx4 v[72:75], v252, s[16:19], s24 offen offset:0 sc1
    v_mfma_f32_16x16x32_bf16 v[88:91], v[4:7], v[72:75], 0
    s_add_u32 s24, s36, 18432
    s_waitcnt lgkmcnt(4)
    buffer_store_dwordx4 v[76:79], v252, s[16:19], s24 offen offset:0 sc1
    v_mfma_f32_16x16x32_bf16 v[92:95], v[4:7], v[76:79], 0
    s_add_u32 s24, s36, 36864
    s_waitcnt lgkmcnt(2)
    buffer_store_dwordx4 v[80:83], v252, s[16:19], s24 offen offset:0 sc1
    v_mfma_f32_16x16x32_bf16 v[96:99], v[4:7], v[80:83], 0
    s_add_u32 s24, s36, 55296
    s_waitcnt lgkmcnt(0)
    buffer_store_dwordx4 v[84:87], v252, s[16:19], s24 offen offset:0 sc1
    v_mfma_f32_16x16x32_bf16 v[100:103], v[4:7], v[84:87], 0
    ds_write_b128 v202, v[184:187] offset:33280
    ds_write_b128 v202, v[188:191] offset:34304
    ds_write_b128 v202, v[192:195] offset:35328
    ds_write_b128 v202, v[196:199] offset:36352
    ds_read_b64_tr_b16 v[104:105], v244 offset:33280
    ds_read_b64_tr_b16 v[106:107], v244 offset:35328
    ds_read_b64_tr_b16 v[108:109], v245 offset:33280
    ds_read_b64_tr_b16 v[110:111], v245 offset:35328
    ds_read_b64_tr_b16 v[112:113], v246 offset:33280
    ds_read_b64_tr_b16 v[114:115], v246 offset:35328
    ds_read_b64_tr_b16 v[116:117], v247 offset:33280
    ds_read_b64_tr_b16 v[118:119], v247 offset:35328
    s_add_u32 s24, s36, 0
    s_waitcnt lgkmcnt(6)
    buffer_store_dwordx4 v[104:107], v252, s[16:19], s24 offen offset:1024 sc1
    v_mfma_f32_16x16x32_bf16 v[88:91], v[4:7], v[104:107], v[88:91]
    s_add_u32 s24, s36, 18432
    s_waitcnt lgkmcnt(4)
    buffer_store_dwordx4 v[108:111], v252, s[16:19], s24 offen offset:1024 sc1
    v_mfma_f32_16x16x32_bf16 v[92:95], v[4:7], v[108:111], v[92:95]
    s_add_u32 s24, s36, 36864
    s_waitcnt lgkmcnt(2)
    buffer_store_dwordx4 v[112:115], v252, s[16:19], s24 offen offset:1024 sc1
    v_mfma_f32_16x16x32_bf16 v[96:99], v[4:7], v[112:115], v[96:99]
    s_add_u32 s24, s36, 55296
    s_waitcnt lgkmcnt(0)
    buffer_store_dwordx4 v[116:119], v252, s[16:19], s24 offen offset:1024 sc1
    v_mfma_f32_16x16x32_bf16 v[100:103], v[4:7], v[116:119], v[100:103]
    v_lshrrev_b32 v1, 4, v0
    v_cmp_eq_u32 vcc, 1, v1
    v_cmp_eq_u32 s[50:51], 2, v1
    v_cmp_eq_u32 s[52:53], 3, v1
    v_lshlrev_b32 v2, 2, v0
    v_cndmask_b32 v3, v88, v92, vcc
    v_cndmask_b32 v3, v3, v96, s[50:51]
    s_nop 0
    v_cndmask_b32 v249, v3, v100, s[52:53]
    buffer_atomic_add_f32 v249, v2, s[16:19], s42 offen
S1J_28:
    s_mov_b32 s58, s54
    s_mov_b32 s59, s55
    v_and_b32 v3, 7, v0
    v_mul_u32_u24 v3, 4160, v3
    v_bfe_u32 v1, v0, 3, 1
    v_lshrrev_b32 v201, 4, v0
    v_add_u32 v1, v1, v201
    v_lshl_add_u32 v200, v1, 4, v3
    v_add_u32 v200, s45, v200
    v_and_b32 v1, 15, v0
    v_lshlrev_b32 v1, 5, v1
    v_lshlrev_b32 v203, 4, v201
    v_sub_u32 v203, v203, v1
    s_add_u32 s24, s45, 33760
    v_add_u32 v203, s24, v203
    v_lshl_add_u32 v201, v201, 3, v1
    s_add_u32 s24, s45, 33784
    v_sub_u32 v243, s24, v201
    v_add_u32 v201, s45, v201
    v_lshlrev_b32 v253, 16, v253
    s_mov_b32 s27, 29724928
    s_mov_b32 s54, 0
    s_cmp_ge_u32 s20, 432
    s_cbranch_scc1 NOCV_34
    s_lshr_b32 s24, s43, 6
    s_mul_i32 s24, s24, 4352
    s_add_u32 s44, s24, 29685760
    s_cmp_ge_u32 s23, 1
    s_cbranch_scc1 OK_36
    s_load_dword s4, s[28:29], s44 glc
    s_mov_b32 s3, 0
SP_35:
    s_waitcnt lgkmcnt(0)
    s_cmp_ge_u32 s4, 32
    s_cbranch_scc1 OK_36
    s_add_u32 s3, s3, 1
    s_cmp_gt_u32 s3, 200000
    s_cbranch_scc1 OK_36
    s_sleep 2
    s_load_dword s4, s[28:29], s44 glc
    s_branch SP_35
OK_36:
    s_waitcnt lgkmcnt(0)
    s_barrier
    s_lshl_b32 s24, s43, 12
    s_add_u32 m0, s45, 33280
    s_add_u32 s24, s24, 4718592
    buffer_load_dwordx4 v252, s[16:19], s24 offen offset:0 sc1 lds
    buffer_load_dwordx4 v252, s[16:19], s24 offen offset:1024 sc1 lds
    buffer_load_dwordx4 v252, s[16:19], s24 offen offset:2048 sc1 lds
    buffer_load_dwordx4 v252, s[16:19], s24 offen offset:3072 sc1 lds
    ds_read_b128 v[40:43], v200 offset:0
    ds_read_b128 v[44:47], v200 offset:64
    ds_read_b128 v[48:51], v200 offset:128
    s_waitcnt vmcnt(0)
    ds_read_b128 a[252:255], v203 offset:0
    ds_read_b128 a[220:223], v203 offset:512
    ds_read_b128 a[188:191], v203 offset:1024
    ds_read_b128 a[156:159], v203 offset:1536
    ds_read_b128 a[124:127], v203 offset:2048
    ds_read_b128 a[92:95], v203 offset:2560
    ds_read_b128 a[60:63], v203 offset:3072
    ds_read_b128 a[28:31], v203 offset:3584
    buffer_load_dwordx4 v[210:213], v250, s[12:15], s88 offen nt
    s_add_u32 s88, s88, 73728
    buffer_load_dwordx4 v[214:217], v250, s[12:15], s88 offen nt
    s_add_u32 s88, s88, 73728
    buffer_load_dwordx4 v[218:221], v250, s[12:15], s88 offen nt
    s_add_u32 s88, s88, 73728
    buffer_load_dwordx4 v[222:225], v250, s[12:15], s88 offen nt
    s_add_u32 s88, s88, 73728
    buffer_load_dwordx4 v[226:229], v250, s[12:15], s88 offen nt
    s_add_u32 s88, s88, 73728
    buffer_load_dwordx4 v[230:233], v250, s[12:15], s88 offen nt
    s_add_u32 s88, s88, 73728
    buffer_load_dwordx4 v[234:237], v250, s[12:15], s88 offen nt
    s_add_u32 s88, s88, 73728
    buffer_load_dwordx4 v[238:241], v250, s[12:15], s88 offen nt
    s_cmp_lg_u32 s47, 0
    s_cbranch_scc1 SE_37
    s_mov_b32 s5, 1
    s_atomic_add s5, s[28:29], s38
    s_atomic_add s5, s[28:29], s39
SE_37:
    s_waitcnt lgkmcnt(7)
    v_mfma_f32_16x16x32_bf16 v[36:39], v[40:43], a[252:255], 0
    ds_read_b128 a[248:251], v203 offset:64
    ds_read_b128 a[216:219], v203 offset:576
    s_waitcnt lgkmcnt(8)
    v_mfma_f32_16x16x32_bf16 v[32:35], v[40:43], a[220:223], 0
    ds_read_b128 a[184:187], v203 offset:1088
    ds_read_b128 a[152:155], v203 offset:1600
    s_waitcnt lgkmcnt(9)
    v_mfma_f32_16x16x32_bf16 v[28:31], v[40:43], a[188:191], 0
    ds_read_b128 a[120:123], v203 offset:2112
    ds_read_b128 a[88:91], v203 offset:2624
    s_waitcnt lgkmcnt(10)
    v_mfma_f32_16x16x32_bf16 v[24:27], v[40:43], a[156:159], 0
    ds_read_b128 a[56:59], v203 offset:3136
    ds_read_b128 a[24:27], v203 offset:3648
    s_waitcnt lgkmcnt(11)
    v_mfma_f32_16x16x32_bf16 v[20:23], v[40:43], a[124:127], 0
    ds_read_b128 v[52:55], v200 offset:192
    s_waitcnt lgkmcnt(11)
    v_mfma_f32_16x16x32_bf16 v[16:19], v[40:43], a[92:95], 0
    s_waitcnt lgkmcnt(10)
    v_mfma_f32_16x16x32_bf16 v[12:15], v[40:43], a[60:63], 0
    s_waitcnt lgkmcnt(9)
    v_mfma_f32_16x16x32_bf16 v[8:11], v[40:43], a[28:31], 0
    s_waitcnt lgkmcnt(5)
    v_mfma_f32_16x16x32_bf16 v[36:39], v[44:47], a[248:251], v[36:39]
    ds_read_b128 a[244:247], v203 offset:128
    ds_read_b128 a[212:215], v203 offset:640
    v_mfma_f32_16x16x32_bf16 v[32:35], v[44:47], a[216:219], v[32:35]
    ds_read_b128 a[180:183], v203 offset:1152
    ds_read_b128 a[148:151], v203 offset:1664
    v_mfma_f32_16x16x32_bf16 v[28:31], v[44:47], a[184:187], v[28:31]
    ds_read_b128 a[116:119], v203 offset:2176
    ds_read_b128 a[84:87], v203 offset:2688
    v_mfma_f32_16x16x32_bf16 v[24:27], v[44:47], a[152:155], v[24:27]
    ds_read_b128 a[52:55], v203 offset:3200
    ds_read_b128 a[20:23], v203 offset:3712
    s_waitcnt lgkmcnt(9)
    v_mfma_f32_16x16x32_bf16 v[20:23], v[44:47], a[120:123], v[20:23]
    ds_read_b128 v[56:59], v200 offset:256
    v_mfma_f32_16x16x32_bf16 v[16:19], v[44:47], a[88:91], v[16:19]
    v_mfma_f32_16x16x32_bf16 v[12:15], v[44:47], a[56:59], v[12:15]
    v_mfma_f32_16x16x32_bf16 v[8:11], v[44:47], a[24:27], v[8:11]
    s_waitcnt lgkmcnt(5)
    v_mfma_f32_16x16x32_bf16 v[36:39], v[48:51], a[244:247], v[36:39]
    ds_read_b128 a[240:243], v203 offset:192
    ds_read_b128 a[208:211], v203 offset:704
    v_mfma_f32_16x16x32_bf16 v[32:35], v[48:51], a[212:215], v[32:35]
    ds_read_b128 a[176:179], v203 offset:1216
    ds_read_b128 a[144:147], v203 offset:1728
    v_mfma_f32_16x16x32_bf16 v[28:31], v[48:51], a[180:183], v[28:31]
    ds_read_b128 a[112:115], v203 offset:2240
    ds_read_b128 a[80:83], v203 offset:2752
    v_mfma_f32_16x16x32_bf16 v[24:27], v[48:51], a[148:151], v[24:27]
    ds_read_b128 a[48:51], v203 offset:3264
    ds_read_b128 a[16:19], v203 offset:3776
    s_waitcnt lgkmcnt(9)
    v_mfma_f32_16x16x32_bf16 v[20:23], v[48:51], a[116:119], v[20:23]
    ds_read_b128 v[60:63], v200 offset:320
    v_mfma_f32_16x16x32_bf16 v[16:19], v[48:51], a[84:87], v[16:19]
    v_mfma_f32_16x16x32_bf16 v[12:15], v[48:51], a[52:55], v[12:15]
    v_mfma_f32_16x16x32_bf16 v[8:11], v[48:51], a[20:23], v[8:11]
    s_waitcnt lgkmcnt(5)
    v_mfma_f32_16x16x32_bf16 v[36:39], v[52:55], a[240:243], v[36:39]
    ds_read_b128 a[236:239], v203 offset:256
    ds_read_b128 a[204:207], v203 offset:768
    v_mfma_f32_16x16x32_bf16 v[32:35], v[52:55], a[208:211], v[32:35]
    ds_read_b128 a[172:175], v203 offset:1280
    ds_read_b128 a[140:143], v203 offset:1792
    v_mfma_f32_16x16x32_bf16 v[28:31], v[52:55], a[176:179], v[28:31]
    ds_read_b128 a[108:111], v203 offset:2304
    ds_read_b128 a[76:79], v203 offset:2816
    v_mfma_f32_16x16x32_bf16 v[24:27], v[52:55], a[144:147], v[24:27]
    ds_read_b128 a[44:47], v203 offset:3328
    ds_read_b128 a[12:15], v203 offset:3840
    s_waitcnt lgkmcnt(9)
    v_mfma_f32_16x16x32_bf16 v[20:23], v[52:55], a[112:115], v[20:23]
    ds_read_b128 v[64:67], v200 offset:384
    v_mfma_f32_16x16x32_bf16 v[16:19], v[52:55], a[80:83], v[16:19]
    v_mfma_f32_16x16x32_bf16 v[12:15], v[52:55], a[48:51], v[12:15]
    v_mfma_f32_16x16x32_bf16 v[8:11], v[52:55], a[16:19], v[8:11]
    s_waitcnt lgkmcnt(5)
    v_mfma_f32_16x16x32_bf16 v[36:39], v[56:59], a[236:239], v[36:39]
    ds_read_b128 a[232:235], v203 offset:320
    ds_read_b128 a[200:203], v203 offset:832
    v_mfma_f32_16x16x32_bf16 v[32:35], v[56:59], a[204:207], v[32:35]
    ds_read_b128 a[168:171], v203 offset:1344
    ds_read_b128 a[136:139], v203 offset:1856
    v_mfma_f32_16x16x32_bf16 v[28:31], v[56:59], a[172:175], v[28:31]
    ds_read_b128 a[104:107], v203 offset:2368
    ds_read_b128 a[72:75], v203 offset:2880
    v_mfma_f32_16x16x32_bf16 v[24:27], v[56:59], a[140:143], v[24:27]
    ds_read_b128 a[40:43], v203 offset:3392
    ds_read_b128 a[8:11], v203 offset:3904
    s_waitcnt lgkmcnt(9)
    v_mfma_f32_16x16x32_bf16 v[20:23], v[56:59], a[108:111], v[20:23]
    ds_read_b128 v[68:71], v200 offset:448
    v_mfma_f32_16x16x32_bf16 v[16:19], v[56:59], a[76:79], v[16:19]
    v_mfma_f32_16x16x32_bf16 v[12:15], v[56:59], a[44:47], v[12:15]
    v_mfma_f32_16x16x32_bf16 v[8:11], v[56:59], a[12:15], v[8:11]
    s_waitcnt lgkmcnt(5)
    v_mfma_f32_16x16x32_bf16 v[36:39], v[60:63], a[232:235], v[36:39]
    ds_read_b128 a[228:231], v203 offset:384
    ds_read_b128 a[196:199], v203 offset:896
    v_mfma_f32_16x16x32_bf16 v[32:35], v[60:63], a[200:203], v[32:35]
    ds_read_b128 a[164:167], v203 offset:1408
    ds_read_b128 a[132:135], v203 offset:1920
    v_mfma_f32_16x16x32_bf16 v[28:31], v[60:63], a[168:171], v[28:31]
    ds_read_b128 a[100:103], v203 offset:2432
    ds_read_b128 a[68:71], v203 offset:2944
    v_mfma_f32_16x16x32_bf16 v[24:27], v[60:63], a[136:139], v[24:27]
    ds_read_b128 a[36:39], v203 offset:3456
    ds_read_b128 a[4:7], v203 offset:3968
    s_waitcnt lgkmcnt(9)
    v_mfma_f32_16x16x32_bf16 v[20:23], v[60:63], a[104:107], v[20:23]
    ds_read_b128 v[40:43], v200 offset:512
    v_mfma_f32_16x16x32_bf16 v[16:19], v[60:63], a[72:75], v[16:19]
    v_mfma_f32_16x16x32_bf16 v[12:15], v[60:63], a[40:43], v[12:15]
    v_mfma_f32_16x16x32_bf16 v[8:11], v[60:63], a[8:11], v[8:11]
    s_waitcnt lgkmcnt(5)
    v_mfma_f32_16x16x32_bf16 v[36:39], v[64:67], a[228:231], v[36:39]
    ds_read_b128 a[224:227], v203 offset:448
    ds_read_b128 a[192:195], v203 offset:960
    v_mfma_f32_16x16x32_bf16 v[32:35], v[64:67], a[196:199], v[32:35]
    ds_read_b128 a[160:163], v203 offset:1472
    ds_read_b128 a[128:131], v203 offset:1984
    v_mfma_f32_16x16x32_bf16 v[28:31], v[64:67], a[164:167], v[28:31]
    ds_read_b128 a[96:99], v203 offset:2496
    ds_read_b128 a[64:67], v203 offset:3008
    v_mfma_f32_16x16x32_bf16 v[24:27], v[64:67], a[132:135], v[24:27]
    ds_read_b128 a[32:35], v203 offset:3520
    ds_read_b128 a[0:3], v203 offset:4032
    s_waitcnt lgkmcnt(9)
    v_mfma_f32_16x16x32_bf16 v[20:23], v[64:67], a[100:103], v[20:23]
    ds_read_b128 v[44:47], v200 offset:4032
    ds_read_b128 v[48:51], v200 offset:576
    v_mfma_f32_16x16x32_bf16 v[16:19], v[64:67], a[68:71], v[16:19]
    ds_read_b128 v[52:55], v200 offset:3968
    ds_read_b128 v[56:59], v200 offset:640
    v_mfma_f32_16x16x32_bf16 v[12:15], v[64:67], a[36:39], v[12:15]
    v_mfma_f32_16x16x32_bf16 v[8:11], v[64:67], a[4:7], v[8:11]
    s_waitcnt lgkmcnt(8)
    v_mfma_f32_16x16x32_bf16 v[36:39], v[68:71], a[224:227], v[36:39]
    ds_read_b128 v[60:63], v200 offset:3904
    ds_read_b64 v[184:185], v243 offset:3584
    v_mfma_f32_16x16x32_bf16 v[32:35], v[68:71], a[192:195], v[32:35]
    ds_read_b64 v[186:187], v243 offset:3072
    ds_read_b64 v[188:189], v243 offset:2560
    v_mfma_f32_16x16x32_bf16 v[28:31], v[68:71], a[160:163], v[28:31]
    ds_read_b64 v[190:191], v243 offset:2048
    ds_read_b64 v[192:193], v243 offset:1536
    v_mfma_f32_16x16x32_bf16 v[24:27], v[68:71], a[128:131], v[24:27]
    ds_read_b64 v[194:195], v243 offset:1024
    ds_read_b64 v[196:197], v243 offset:512
    s_waitcnt lgkmcnt(12)
    v_mfma_f32_16x16x32_bf16 v[20:23], v[68:71], a[96:99], v[20:23]
    ds_read_b64 v[198:199], v243 offset:0
    v_mfma_f32_16x16x32_bf16 v[16:19], v[68:71], a[64:67], v[16:19]
    v_mfma_f32_16x16x32_bf16 v[12:15], v[68:71], a[32:35], v[12:15]
    v_mfma_f32_16x16x32_bf16 v[8:11], v[68:71], a[0:3], v[8:11]
    s_waitcnt lgkmcnt(12)
    v_mfma_f32_16x16x32_bf16 v[36:39], v[40:43], a[220:223], v[36:39]
    ds_read_b128 v[64:67], v200 offset:704
    v_mfma_f32_16x16x32_bf16 v[32:35], v[40:43], a[188:191], v[32:35]
    v_mfma_f32_16x16x32_bf16 v[28:31], v[40:43], a[156:159], v[28:31]
    v_mfma_f32_16x16x32_bf16 v[24:27], v[40:43], a[124:127], v[24:27]
    v_mfma_f32_16x16x32_bf16 v[20:23], v[40:43], a[92:95], v[20:23]
    v_mfma_f32_16x16x32_bf16 v[16:19], v[40:43], a[60:63], v[16:19]
    v_mfma_f32_16x16x32_bf16 v[12:15], v[40:43], a[28:31], v[12:15]
    v_mfma_f32_16x16x32_bf16 v[36:39], v[44:47], a[0:3], v[36:39]
    ds_read_b128 v[68:71], v200 offset:3840
    s_waitcnt lgkmcnt(12)
    v_mfma_f32_16x16x32_bf16 v[36:39], v[48:51], a[216:219], v[36:39]
    ds_read_b128 v[40:43], v200 offset:768
    s_waitcnt lgkmcnt(10)
    v_and_b32 v204, 0xffff0000, v185
    v_mfma_f32_16x16x32_bf16 v[32:35], v[48:51], a[184:187], v[32:35]
    v_lshlrev_b32 v205, 16, v185
    v_and_b32 v206, 0xffff0000, v184
    v_mfma_f32_16x16x32_bf16 v[28:31], v[48:51], a[152:155], v[28:31]
    v_lshlrev_b32 v207, 16, v184
    v_fmac_f32 v8, v204, v253
    v_mfma_f32_16x16x32_bf16 v[24:27], v[48:51], a[120:123], v[24:27]
    v_fmac_f32 v9, v205, v253
    v_fmac_f32 v10, v206, v253
    v_mfma_f32_16x16x32_bf16 v[20:23], v[48:51], a[88:91], v[20:23]
    v_fmac_f32 v11, v207, v253
    v_cvt_pk_bf16_f32 v184, v8, v9
    v_mfma_f32_16x16x32_bf16 v[16:19], v[48:51], a[56:59], v[16:19]
    v_cvt_pk_bf16_f32 v185, v10, v11
    v_mfma_f32_16x16x32_bf16 v[12:15], v[48:51], a[24:27], v[12:15]
    v_mfma_f32_16x16x32_bf16 v[36:39], v[52:55], a[4:7], v[36:39]
    ds_read_b128 v[44:47], v200 offset:3776
    v_mfma_f32_16x16x32_bf16 v[36:39], v[56:59], a[212:215], v[36:39]
    ds_read_b128 v[48:51], v200 offset:832
    v_mfma_f32_16x16x32_bf16 v[32:35], v[56:59], a[180:183], v[32:35]
    v_mfma_f32_16x16x32_bf16 v[28:31], v[56:59], a[148:151], v[28:31]
    v_mfma_f32_16x16x32_bf16 v[24:27], v[56:59], a[116:119], v[24:27]
    v_mfma_f32_16x16x32_bf16 v[20:23], v[56:59], a[84:87], v[20:23]
    v_mfma_f32_16x16x32_bf16 v[16:19], v[56:59], a[52:55], v[16:19]
    v_mfma_f32_16x16x32_bf16 v[12:15], v[56:59], a[20:23], v[12:15]
    v_mfma_f32_16x16x32_bf16 v[36:39], v[60:63], a[8:11], v[36:39]
    ds_read_b128 v[52:55], v200 offset:3712
    s_waitcnt lgkmcnt(4)
    v_mfma_f32_16x16x32_bf16 v[36:39], v[64:67], a[208:211], v[36:39]
    ds_read_b128 v[56:59], v200 offset:896
    v_mfma_f32_16x16x32_bf16 v[32:35], v[64:67], a[176:179], v[32:35]
    v_mfma_f32_16x16x32_bf16 v[28:31], v[64:67], a[144:147], v[28:31]
    v_mfma_f32_16x16x32_bf16 v[24:27], v[64:67], a[112:115], v[24:27]
    v_mfma_f32_16x16x32_bf16 v[20:23], v[64:67], a[80:83], v[20:23]
    v_mfma_f32_16x16x32_bf16 v[16:19], v[64:67], a[48:51], v[16:19]
    v_mfma_f32_16x16x32_bf16 v[12:15], v[64:67], a[16:19], v[12:15]
    v_mfma_f32_16x16x32_bf16 v[36:39], v[68:71], a[12:15], v[36:39]
    ds_read_b128 v[60:63], v200 offset:3648
    s_waitcnt lgkmcnt(4)
    v_mfma_f32_16x16x32_bf16 v[36:39], v[40:43], a[204:207], v[36:39]
    ds_read_b128 v[64:67], v200 offset:960
    s_waitcnt vmcnt(0)
    ds_write_b128 v202, v[210:213] offset:33280
    v_mfma_f32_16x16x32_bf16 v[32:35], v[40:43], a[172:175], v[32:35]
    ds_write_b128 v202, v[214:217] offset:34304
    ds_write_b128 v202, v[218:221] offset:35328
    v_mfma_f32_16x16x32_bf16 v[28:31], v[40:43], a[140:143], v[28:31]
    ds_write_b128 v202, v[222:225] offset:36352
    ds_read_b64_tr_b16 v[72:73], v244 offset:33280
    v_mfma_f32_16x16x32_bf16 v[24:27], v[40:43], a[108:111], v[24:27]
    ds_read_b64_tr_b16 v[74:75], v244 offset:35328
    ds_read_b64_tr_b16 v[76:77], v245 offset:33280
    v_mfma_f32_16x16x32_bf16 v[20:23], v[40:43], a[76:79], v[20:23]
    ds_read_b64_tr_b16 v[78:79], v245 offset:35328
    ds_read_b64_tr_b16 v[80:81], v246 offset:33280
    v_mfma_f32_16x16x32_bf16 v[16:19], v[40:43], a[44:47], v[16:19]
    ds_read_b64_tr_b16 v[82:83], v246 offset:35328
    ds_read_b64_tr_b16 v[84:85], v247 offset:33280
    v_mfma_f32_16x16x32_bf16 v[12:15], v[40:43], a[12:15], v[12:15]
    ds_read_b64_tr_b16 v[86:87], v247 offset:35328
    v_mfma_f32_16x16x32_bf16 v[36:39], v[44:47], a[16:19], v[36:39]
    ds_read_b128 v[68:71], v200 offset:3584
    s_waitcnt lgkmcnt(15)
    v_mfma_f32_16x16x32_bf16 v[36:39], v[48:51], a[200:203], v[36:39]
    ds_read_b128 v[40:43], v200 offset:1024
    v_mfma_f32_16x16x32_bf16 v[32:35], v[48:51], a[168:171], v[32:35]
    v_mfma_f32_16x16x32_bf16 v[28:31], v[48:51], a[136:139], v[28:31]
    v_mfma_f32_16x16x32_bf16 v[24:27], v[48:51], a[104:107], v[24:27]
    v_mfma_f32_16x16x32_bf16 v[20:23], v[48:51], a[72:75], v[20:23]
    v_mfma_f32_16x16x32_bf16 v[16:19], v[48:51], a[40:43], v[16:19]
    v_mfma_f32_16x16x32_bf16 v[12:15], v[48:51], a[8:11], v[12:15]
    v_mfma_f32_16x16x32_bf16 v[36:39], v[52:55], a[20:23], v[36:39]
    ds_read_b128 v[44:47], v200 offset:3520
    ds_write_b128 v202, v[226:229] offset:33280
    s_waitcnt lgkmcnt(15)
    v_mfma_f32_16x16x32_bf16 v[36:39], v[56:59], a[196:199], v[36:39]
    ds_read_b128 v[48:51], v200 offset:1088
    ds_write_b128 v202, v[230:233] offset:34304
    v_mfma_f32_16x16x32_bf16 v[32:35], v[56:59], a[164:167], v[32:35]
    ds_write_b128 v202, v[234:237] offset:35328
    ds_write_b128 v202, v[238:241] offset:36352
    v_mfma_f32_16x16x32_bf16 v[28:31], v[56:59], a[132:135], v[28:31]
    ds_read_b64_tr_b16 v[104:105], v244 offset:33280
    ds_read_b64_tr_b16 v[106:107], v244 offset:35328
    v_mfma_f32_16x16x32_bf16 v[24:27], v[56:59], a[100:103], v[24:27]
    ds_read_b64_tr_b16 v[108:109], v245 offset:33280
    ds_read_b64_tr_b16 v[110:111], v245 offset:35328
    v_mfma_f32_16x16x32_bf16 v[20:23], v[56:59], a[68:71], v[20:23]
    ds_read_b64_tr_b16 v[112:113], v246 offset:33280
    ds_read_b64_tr_b16 v[114:115], v246 offset:35328
    v_mfma_f32_16x16x32_bf16 v[16:19], v[56:59], a[36:39], v[16:19]
    ds_read_b64_tr_b16 v[116:117], v247 offset:33280
    ds_read_b64_tr_b16 v[118:119], v247 offset:35328
    v_mfma_f32_16x16x32_bf16 v[12:15], v[56:59], a[4:7], v[12:15]
    s_add_u32 s24, s89, 0
    s_waitcnt lgkmcnt(15)
    buffer_store_dwordx4 v[72:75], v252, s[16:19], s24 offen offset:0 sc1
    v_mfma_f32_16x16x32_bf16 v[36:39], v[60:63], a[24:27], v[36:39]
    ds_read_b128 v[52:55], v200 offset:3456
    v_mfma_f32_16x16x32_bf16 v[88:91], v[4:7], v[72:75], 0
    v_mfma_f32_16x16x32_bf16 v[36:39], v[64:67], a[192:195], v[36:39]
    ds_read_b128 v[56:59], v200 offset:1152
    s_add_u32 s24, s89, 18432
    v_mfma_f32_16x16x32_bf16 v[32:35], v[64:67], a[160:163], v[32:35]
    buffer_store_dwordx4 v[76:79], v252, s[16:19], s24 offen offset:0 sc1
    v_mfma_f32_16x16x32_bf16 v[28:31], v[64:67], a[128:131], v[28:31]
    v_mfma_f32_16x16x32_bf16 v[92:95], v[4:7], v[76:79], 0
    v_mfma_f32_16x16x32_bf16 v[24:27], v[64:67], a[96:99], v[24:27]
    v_mfma_f32_16x16x32_bf16 v[20:23], v[64:67], a[64:67], v[20:23]
    v_mfma_f32_16x16x32_bf16 v[16:19], v[64:67], a[32:35], v[16:19]
    v_mfma_f32_16x16x32_bf16 v[12:15], v[64:67], a[0:3], v[12:15]
    v_mfma_f32_16x16x32_bf16 v[36:39], v[68:71], a[28:31], v[36:39]
    ds_read_b128 v[60:63], v200 offset:3392
    s_add_u32 s24, s89, 36864
    s_waitcnt lgkmcnt(15)
    v_mfma_f32_16x16x32_bf16 v[36:39], v[40:43], a[188:191], v[36:39]
    ds_read_b128 v[64:67], v200 offset:1216
    buffer_store_dwordx4 v[80:83], v252, s[16:19], s24 offen offset:0 sc1
    v_mfma_f32_16x16x32_bf16 v[32:35], v[40:43], a[156:159], v[32:35]
    v_mfma_f32_16x16x32_bf16 v[96:99], v[4:7], v[80:83], 0
    v_mfma_f32_16x16x32_bf16 v[28:31], v[40:43], a[124:127], v[28:31]
    v_mfma_f32_16x16x32_bf16 v[24:27], v[40:43], a[92:95], v[24:27]
    v_mfma_f32_16x16x32_bf16 v[20:23], v[40:43], a[60:63], v[20:23]
    v_mfma_f32_16x16x32_bf16 v[16:19], v[40:43], a[28:31], v[16:19]
    v_mfma_f32_16x16x32_bf16 v[36:39], v[44:47], a[32:35], v[36:39]
    ds_read_b128 v[68:71], v200 offset:3328
    v_mfma_f32_16x16x32_bf16 v[32:35], v[44:47], a[0:3], v[32:35]
    s_add_u32 s24, s89, 55296
    buffer_store_dwordx4 v[84:87], v252, s[16:19], s24 offen offset:0 sc1
    s_waitcnt lgkmcnt(4)
    v_mfma_f32_16x16x32_bf16 v[36:39], v[48:51], a[184:187], v[36:39]
    ds_read_b128 v[40:43], v200 offset:1280
    v_mfma_f32_16x16x32_bf16 v[100:103], v[4:7], v[84:87], 0
    v_mfma_f32_16x16x32_bf16 v[32:35], v[48:51], a[152:155], v[32:35]
    s_and_b32 s7, s2, 3
    s_lshl_b32 s7, s7, 1
    s_lshr_b32 s6, s2, 7
    s_add_u32 s7, s7, s6
    s_mul_i32 s7, s7, 4352
    s_add_u32 s7, s7, 29616128
    s_cmp_lg_u32 s23, 0
    s_cbranch_scc1 S_e1
    s_load_dword s4, s[28:29], s7 glc
S_e1:
    v_and_b32 v204, 0xffff0000, v187
    v_mfma_f32_16x16x32_bf16 v[28:31], v[48:51], a[120:123], v[28:31]
    v_lshlrev_b32 v205, 16, v187
    v_and_b32 v206, 0xffff0000, v186
    v_mfma_f32_16x16x32_bf16 v[24:27], v[48:51], a[88:91], v[24:27]
    v_lshlrev_b32 v207, 16, v186
    v_fmac_f32 v12, v204, v253
    v_mfma_f32_16x16x32_bf16 v[20:23], v[48:51], a[56:59], v[20:23]
    v_fmac_f32 v13, v205, v253
    v_fmac_f32 v14, v206, v253
    v_mfma_f32_16x16x32_bf16 v[16:19], v[48:51], a[24:27], v[16:19]
    v_fmac_f32 v15, v207, v253
    v_cvt_pk_bf16_f32 v186, v12, v13
    v_mfma_f32_16x16x32_bf16 v[36:39], v[52:55], a[36:39], v[36:39]
    ds_read_b128 v[44:47], v200 offset:3264
    v_cvt_pk_bf16_f32 v187, v14, v15
    v_mfma_f32_16x16x32_bf16 v[32:35], v[52:55], a[4:7], v[32:35]
    s_add_u32 s24, s89, 0
    buffer_store_dwordx4 v[104:107], v252, s[16:19], s24 offen offset:1024 sc1
    s_waitcnt lgkmcnt(4)
    v_mfma_f32_16x16x32_bf16 v[36:39], v[56:59], a[180:183], v[36:39]
    ds_read_b128 v[48:51], v200 offset:1344
    v_mfma_f32_16x16x32_bf16 v[88:91], v[4:7], v[104:107], v[88:91]
    v_mfma_f32_16x16x32_bf16 v[32:35], v[56:59], a[148:151], v[32:35]
    v_mfma_f32_16x16x32_bf16 v[28:31], v[56:59], a[116:119], v[28:31]
    v_mfma_f32_16x16x32_bf16 v[24:27], v[56:59], a[84:87], v[24:27]
    v_mfma_f32_16x16x32_bf16 v[20:23], v[56:59], a[52:55], v[20:23]
    v_mfma_f32_16x16x32_bf16 v[16:19], v[56:59], a[20:23], v[16:19]
    v_mfma_f32_16x16x32_bf16 v[36:39], v[60:63], a[40:43], v[36:39]
    ds_read_b128 v[52:55], v200 offset:3200
    v_mfma_f32_16x16x32_bf16 v[32:35], v[60:63], a[8:11], v[32:35]
    s_add_u32 s24, s89, 18432
    buffer_store_dwordx4 v[108:111], v252, s[16:19], s24 offen offset:1024 sc1
    s_waitcnt lgkmcnt(4)
    v_mfma_f32_16x16x32_bf16 v[36:39], v[64:67], a[176:179], v[36:39]
    ds_read_b128 v[56:59], v200 offset:1408
    v_mfma_f32_16x16x32_bf16 v[92:95], v[4:7], v[108:111], v[92:95]
    v_mfma_f32_16x16x32_bf16 v[32:35], v[64:67], a[144:147], v[32:35]
    v_mfma_f32_16x16x32_bf16 v[28:31], v[64:67], a[112:115], v[28:31]
    v_mfma_f32_16x16x32_bf16 v[24:27], v[64:67], a[80:83], v[24:27]
    v_mfma_f32_16x16x32_bf16 v[20:23], v[64:67], a[48:51], v[20:23]
    v_mfma_f32_16x16x32_bf16 v[16:19], v[64:67], a[16:19], v[16:19]
    v_mfma_f32_16x16x32_bf16 v[36:39], v[68:71], a[44:47], v[36:39]
    ds_read_b128 v[60:63], v200 offset:3136
    v_mfma_f32_16x16x32_bf16 v[32:35], v[68:71], a[12:15], v[32:35]
    s_add_u32 s24, s89, 36864
    buffer_store_dwordx4 v[112:115], v252, s[16:19], s24 offen offset:1024 sc1
    s_waitcnt lgkmcnt(4)
    v_mfma_f32_16x16x32_bf16 v[36:39], v[40:43], a[172:175], v[36:39]
    ds_read_b128 v[64:67], v200 offset:1472
    v_mfma_f32_16x16x32_bf16 v[96:99], v[4:7], v[112:115], v[96:99]
    v_mfma_f32_16x16x32_bf16 v[32:35], v[40:43], a[140:143], v[32:35]
    v_mfma_f32_16x16x32_bf16 v[28:31], v[40:43], a[108:111], v[28:31]
    v_mfma_f32_16x16x32_bf16 v[24:27], v[40:43], a[76:79], v[24:27]
    v_mfma_f32_16x16x32_bf16 v[20:23], v[40:43], a[44:47], v[20:23]
    v_mfma_f32_16x16x32_bf16 v[16:19], v[40:43], a[12:15], v[16:19]
    v_mfma_f32_16x16x32_bf16 v[36:39], v[44:47], a[48:51], v[36:39]
    ds_read_b128 v[68:71], v200 offset:3072
    v_mfma_f32_16x16x32_bf16 v[32:35], v[44:47], a[16:19], v[32:35]
    s_add_u32 s24, s89, 55296
    buffer_store_dwordx4 v[116:119], v252, s[16:19], s24 offen offset:1024 sc1
    s_waitcnt lgkmcnt(4)
    v_mfma_f32_16x16x32_bf16 v[36:39], v[48:51], a[168:171], v[36:39]
    ds_read_b128 v[40:43], v200 offset:1536
    v_mfma_f32_16x16x32_bf16 v[100:103], v[4:7], v[116:119], v[100:103]
    v_mfma_f32_16x16x32_bf16 v[32:35], v[48:51], a[136:139], v[32:35]
    v_mfma_f32_16x16x32_bf16 v[28:31], v[48:51], a[104:107], v[28:31]
    v_mfma_f32_16x16x32_bf16 v[24:27], v[48:51], a[72:75], v[24:27]
    v_mfma_f32_16x16x32_bf16 v[20:23], v[48:51], a[40:43], v[20:23]
    v_mfma_f32_16x16x32_bf16 v[16:19], v[48:51], a[8:11], v[16:19]
    v_mfma_f32_16x16x32_bf16 v[36:39], v[52:55], a[52:55], v[36:39]
    ds_read_b128 v[44:47], v200 offset:3008
    v_mfma_f32_16x16x32_bf16 v[32:35], v[52:55], a[20:23], v[32:35]
    v_lshrrev_b32 v1, 4, v0
    v_cmp_eq_u32 vcc, 1, v1
    s_waitcnt lgkmcnt(4)
    v_mfma_f32_16x16x32_bf16 v[36:39], v[56:59], a[164:167], v[36:39]
    ds_read_b128 v[48:51], v200 offset:1600
    v_cmp_eq_u32 s[50:51], 2, v1
    v_mfma_f32_16x16x32_bf16 v[32:35], v[56:59], a[132:135], v[32:35]
    v_cmp_eq_u32 s[52:53], 3, v1
    v_lshlrev_b32 v2, 2, v0
    v_mfma_f32_16x16x32_bf16 v[28:31], v[56:59], a[100:103], v[28:31]
    v_cndmask_b32 v3, v88, v92, vcc
    v_cndmask_b32 v3, v3, v96, s[50:51]
    v_mfma_f32_16x16x32_bf16 v[24:27], v[56:59], a[68:71], v[24:27]
    v_cndmask_b32 v248, v3, v100, s[52:53]
    buffer_atomic_add_f32 v248, v2, s[16:19], s91 offen
    v_mfma_f32_16x16x32_bf16 v[20:23], v[56:59], a[36:39], v[20:23]
    v_mfma_f32_16x16x32_bf16 v[16:19], v[56:59], a[4:7], v[16:19]
    v_mfma_f32_16x16x32_bf16 v[36:39], v[60:63], a[56:59], v[36:39]
    ds_read_b128 v[52:55], v200 offset:2944
    v_mfma_f32_16x16x32_bf16 v[32:35], v[60:63], a[24:27], v[32:35]
    s_waitcnt lgkmcnt(4)
    v_mfma_f32_16x16x32_bf16 v[36:39], v[64:67], a[160:163], v[36:39]
    ds_read_b128 v[56:59], v200 offset:1664
    v_mfma_f32_16x16x32_bf16 v[32:35], v[64:67], a[128:131], v[32:35]
    v_mfma_f32_16x16x32_bf16 v[28:31], v[64:67], a[96:99], v[28:31]
    v_mfma_f32_16x16x32_bf16 v[24:27], v[64:67], a[64:67], v[24:27]
    v_mfma_f32_16x16x32_bf16 v[20:23], v[64:67], a[32:35], v[20:23]
    v_mfma_f32_16x16x32_bf16 v[16:19], v[64:67], a[0:3], v[16:19]
    v_mfma_f32_16x16x32_bf16 v[36:39], v[68:71], a[60:63], v[36:39]
    ds_read_b128 v[60:63], v200 offset:2880
    s_and_b32 s20, s2, 3
    s_lshl_b32 s20, s20, 1
    s_lshr_b32 s64, s2, 7
    s_add_u32 s20, s20, s64
    s_mul_i32 s7, s20, 4352
    s_add_u32 s7, s7, 29616128
    s_mul_i32 s64, s20, 663552
    s_add_u32 s64, s64, 33030144
    s_mul_i32 s65, s23, 36864
    s_add_u32 s88, s64, s65
    s_lshr_b32 s65, s23, 1
    s_mul_i32 s65, s65, 36864
    s_add_u32 s59, s64, s65
    s_add_u32 s59, s59, 589824
    v_and_b32 v3, 15, v0
    v_lshrrev_b32 v1, 5, v0
    v_lshlrev_b32 v1, 8, v1
    v_lshl_add_u32 v1, v3, 4, v1
    v_bfe_u32 v2, v0, 4, 1
    v_mul_u32_u24 v241, 18432, v2
    s_and_b32 s65, s23, 1
    s_lshl_b32 s65, s65, 9
    v_add3_u32 v241, s65, v241, v1
    v_xor_b32 v242, 512, v241
    v_mfma_f32_16x16x32_bf16 v[32:35], v[68:71], a[28:31], v[32:35]
    s_waitcnt lgkmcnt(4)
    v_mfma_f32_16x16x32_bf16 v[36:39], v[40:43], a[156:159], v[36:39]
    ds_read_b128 v[64:67], v200 offset:1728
    s_cmp_ge_u32 s23, 1
    s_cbranch_scc1 OK_39
    s_mov_b32 s3, 0
SP_38:
    s_waitcnt lgkmcnt(0)
    s_cmp_ge_u32 s4, 27
    s_cbranch_scc1 OK_39
    s_add_u32 s3, s3, 1
    s_cmp_gt_u32 s3, 200000
    s_cbranch_scc1 OK_39
    s_sleep 4
    s_load_dword s4, s[28:29], s7 glc
    s_branch SP_38
OK_39:
    s_waitcnt lgkmcnt(0)
    s_barrier
    v_mfma_f32_16x16x32_bf16 v[32:35], v[40:43], a[124:127], v[32:35]
    v_mfma_f32_16x16x32_bf16 v[28:31], v[40:43], a[92:95], v[28:31]
    v_mfma_f32_16x16x32_bf16 v[24:27], v[40:43], a[60:63], v[24:27]
    s_add_u32 s64, s59, 0
    buffer_load_dwordx4 v[100:103], v241, s[16:19], s64 offen offset:0 sc1
    v_mfma_f32_16x16x32_bf16 v[20:23], v[40:43], a[28:31], v[20:23]
    v_mfma_f32_16x16x32_bf16 v[36:39], v[44:47], a[64:67], v[36:39]
    ds_read_b128 v[68:71], v200 offset:2816
    v_mfma_f32_16x16x32_bf16 v[32:35], v[44:47], a[32:35], v[32:35]
    v_mfma_f32_16x16x32_bf16 v[28:31], v[44:47], a[0:3], v[28:31]
    buffer_load_dwordx4 v[104:107], v241, s[16:19], s64 offen offset:1024 sc1
    v_mfma_f32_16x16x32_bf16 v[36:39], v[48:51], a[152:155], v[36:39]
    ds_read_b128 v[40:43], v200 offset:1792
    v_and_b32 v204, 0xffff0000, v189
    v_mfma_f32_16x16x32_bf16 v[32:35], v[48:51], a[120:123], v[32:35]
    v_lshlrev_b32 v205, 16, v189
    v_and_b32 v206, 0xffff0000, v188
    v_mfma_f32_16x16x32_bf16 v[28:31], v[48:51], a[88:91], v[28:31]
    v_lshlrev_b32 v207, 16, v188
    v_fmac_f32 v16, v204, v253
    v_mfma_f32_16x16x32_bf16 v[24:27], v[48:51], a[56:59], v[24:27]
    buffer_load_dwordx4 v[108:111], v241, s[16:19], s64 offen offset:2048 sc1
    v_mfma_f32_16x16x32_bf16 v[20:23], v[48:51], a[24:27], v[20:23]
    v_fmac_f32 v17, v205, v253
    v_fmac_f32 v18, v206, v253
    v_mfma_f32_16x16x32_bf16 v[36:39], v[52:55], a[68:71], v[36:39]
    ds_read_b128 v[44:47], v200 offset:2752
    v_fmac_f32 v19, v207, v253
    v_mfma_f32_16x16x32_bf16 v[32:35], v[52:55], a[36:39], v[32:35]
    v_cvt_pk_bf16_f32 v188, v16, v17
    v_cvt_pk_bf16_f32 v189, v18, v19
    v_mfma_f32_16x16x32_bf16 v[28:31], v[52:55], a[4:7], v[28:31]
    buffer_load_dwordx4 v[112:115], v241, s[16:19], s64 offen offset:3072 sc1
    v_mfma_f32_16x16x32_bf16 v[36:39], v[56:59], a[148:151], v[36:39]
    ds_read_b128 v[48:51], v200 offset:1856
    v_mfma_f32_16x16x32_bf16 v[32:35], v[56:59], a[116:119], v[32:35]
    v_mfma_f32_16x16x32_bf16 v[28:31], v[56:59], a[84:87], v[28:31]
    v_mfma_f32_16x16x32_bf16 v[24:27], v[56:59], a[52:55], v[24:27]
    s_add_u32 s64, s59, 4096
    buffer_load_dwordx4 v[116:119], v241, s[16:19], s64 offen offset:0 sc1
    v_mfma_f32_16x16x32_bf16 v[20:23], v[56:59], a[20:23], v[20:23]
    v_mfma_f32_16x16x32_bf16 v[36:39], v[60:63], a[72:75], v[36:39]
    ds_read_b128 v[52:55], v200 offset:2688
    v_mfma_f32_16x16x32_bf16 v[32:35], v[60:63], a[40:43], v[32:35]
    v_mfma_f32_16x16x32_bf16 v[28:31], v[60:63], a[8:11], v[28:31]
    buffer_load_dwordx4 v[120:123], v241, s[16:19], s64 offen offset:1024 sc1
    s_waitcnt lgkmcnt(4)
    v_mfma_f32_16x16x32_bf16 v[36:39], v[64:67], a[144:147], v[36:39]
    ds_read_b128 v[56:59], v200 offset:1920
    v_mfma_f32_16x16x32_bf16 v[32:35], v[64:67], a[112:115], v[32:35]
    v_mfma_f32_16x16x32_bf16 v[28:31], v[64:67], a[80:83], v[28:31]
    v_mfma_f32_16x16x32_bf16 v[24:27], v[64:67], a[48:51], v[24:27]
    buffer_load_dwordx4 v[124:127], v241, s[16:19], s64 offen offset:2048 sc1
    v_mfma_f32_16x16x32_bf16 v[20:23], v[64:67], a[16:19], v[20:23]
    v_mfma_f32_16x16x32_bf16 v[36:39], v[68:71], a[76:79], v[36:39]
    ds_read_b128 v[60:63], v200 offset:2624
    v_mfma_f32_16x16x32_bf16 v[32:35], v[68:71], a[44:47], v[32:35]
    v_mfma_f32_16x16x32_bf16 v[28:31], v[68:71], a[12:15], v[28:31]
    buffer_load_dwordx4 v[128:131], v241, s[16:19], s64 offen offset:3072 sc1
    s_waitcnt lgkmcnt(4)
    v_mfma_f32_16x16x32_bf16 v[36:39], v[40:43], a[140:143], v[36:39]
    ds_read_b128 v[64:67], v200 offset:1984
    v_mfma_f32_16x16x32_bf16 v[32:35], v[40:43], a[108:111], v[32:35]
    v_mfma_f32_16x16x32_bf16 v[28:31], v[40:43], a[76:79], v[28:31]
    v_mfma_f32_16x16x32_bf16 v[24:27], v[40:43], a[44:47], v[24:27]
    s_add_u32 s64, s59, 8192
    buffer_load_dwordx4 v[132:135], v241, s[16:19], s64 offen offset:0 sc1
    v_mfma_f32_16x16x32_bf16 v[20:23], v[40:43], a[12:15], v[20:23]
    v_mfma_f32_16x16x32_bf16 v[36:39], v[44:47], a[80:83], v[36:39]
    ds_read_b128 v[68:71], v200 offset:2560
    v_mfma_f32_16x16x32_bf16 v[32:35], v[44:47], a[48:51], v[32:35]
    v_mfma_f32_16x16x32_bf16 v[28:31], v[44:47], a[16:19], v[28:31]
    buffer_load_dwordx4 v[136:139], v241, s[16:19], s64 offen offset:1024 sc1
    s_waitcnt lgkmcnt(4)
    v_mfma_f32_16x16x32_bf16 v[36:39], v[48:51], a[136:139], v[36:39]
    ds_read_b128 v[40:43], v200 offset:2048
    v_mfma_f32_16x16x32_bf16 v[32:35], v[48:51], a[104:107], v[32:35]
    v_mfma_f32_16x16x32_bf16 v[28:31], v[48:51], a[72:75], v[28:31]
    v_mfma_f32_16x16x32_bf16 v[24:27], v[48:51], a[40:43], v[24:27]
    buffer_load_dwordx4 v[140:143], v241, s[16:19], s64 offen offset:2048 sc1
    v_mfma_f32_16x16x32_bf16 v[20:23], v[48:51], a[8:11], v[20:23]
    v_mfma_f32_16x16x32_bf16 v[36:39], v[52:55], a[84:87], v[36:39]
    ds_read_b128 v[44:47], v200 offset:2496
    v_mfma_f32_16x16x32_bf16 v[32:35], v[52:55], a[52:55], v[32:35]
    v_mfma_f32_16x16x32_bf16 v[28:31], v[52:55], a[20:23], v[28:31]
    buffer_load_dwordx4 v[144:147], v241, s[16:19], s64 offen offset:3072 sc1
    s_waitcnt lgkmcnt(4)
    v_mfma_f32_16x16x32_bf16 v[36:39], v[56:59], a[132:135], v[36:39]
    ds_read_b128 v[48:51], v200 offset:2112
    v_mfma_f32_16x16x32_bf16 v[32:35], v[56:59], a[100:103], v[32:35]
    v_mfma_f32_16x16x32_bf16 v[28:31], v[56:59], a[68:71], v[28:31]
    v_mfma_f32_16x16x32_bf16 v[24:27], v[56:59], a[36:39], v[24:27]
    s_add_u32 s64, s59, 12288
    buffer_load_dwordx4 v[148:151], v241, s[16:19], s64 offen offset:0 sc1
    v_mfma_f32_16x16x32_bf16 v[20:23], v[56:59], a[4:7], v[20:23]
    v_mfma_f32_16x16x32_bf16 v[36:39], v[60:63], a[88:91], v[36:39]
    ds_read_b128 v[52:55], v200 offset:2432
    v_mfma_f32_16x16x32_bf16 v[32:35], v[60:63], a[56:59], v[32:35]
    v_mfma_f32_16x16x32_bf16 v[28:31], v[60:63], a[24:27], v[28:31]
    buffer_load_dwordx4 v[152:155], v241, s[16:19], s64 offen offset:1024 sc1
    s_waitcnt lgkmcnt(4)
    v_mfma_f32_16x16x32_bf16 v[36:39], v[64:67], a[128:131], v[36:39]
    ds_read_b128 v[56:59], v200 offset:2176
    v_mfma_f32_16x16x32_bf16 v[32:35], v[64:67], a[96:99], v[32:35]
    v_mfma_f32_16x16x32_bf16 v[28:31], v[64:67], a[64:67], v[28:31]
    v_mfma_f32_16x16x32_bf16 v[24:27], v[64:67], a[32:35], v[24:27]
    buffer_load_dwordx4 v[156:159], v241, s[16:19], s64 offen offset:2048 sc1
    v_mfma_f32_16x16x32_bf16 v[20:23], v[64:67], a[0:3], v[20:23]
    v_mfma_f32_16x16x32_bf16 v[36:39], v[68:71], a[92:95], v[36:39]
    ds_read_b128 v[60:63], v200 offset:2368
    v_mfma_f32_16x16x32_bf16 v[32:35], v[68:71], a[60:63], v[32:35]
    v_mfma_f32_16x16x32_bf16 v[28:31], v[68:71], a[28:31], v[28:31]
    buffer_load_dwordx4 v[160:163], v241, s[16:19], s64 offen offset:3072 sc1
    s_waitcnt lgkmcnt(4)
    v_mfma_f32_16x16x32_bf16 v[36:39], v[40:43], a[124:127], v[36:39]
    ds_read_b128 v[64:67], v200 offset:2240
    v_mfma_f32_16x16x32_bf16 v[32:35], v[40:43], a[92:95], v[32:35]
    v_mfma_f32_16x16x32_bf16 v[28:31], v[40:43], a[60:63], v[28:31]
    v_mfma_f32_16x16x32_bf16 v[24:27], v[40:43], a[28:31], v[24:27]
    s_add_u32 s64, s59, 16384
    buffer_load_dwordx4 v[164:167], v241, s[16:19], s64 offen offset:0 sc1
    v_mfma_f32_16x16x32_bf16 v[36:39], v[44:47], a[96:99], v[36:39]
    ds_read_b128 v[68:71], v200 offset:2304
    v_mfma_f32_16x16x32_bf16 v[32:35], v[44:47], a[64:67], v[32:35]
    v_mfma_f32_16x16x32_bf16 v[28:31], v[44:47], a[32:35], v[28:31]
    v_mfma_f32_16x16x32_bf16 v[24:27], v[44:47], a[0:3], v[24:27]
    buffer_load_dwordx4 v[168:171], v241, s[16:19], s64 offen offset:1024 sc1
    s_waitcnt lgkmcnt(4)
    v_mfma_f32_16x16x32_bf16 v[36:39], v[48:51], a[120:123], v[36:39]
    v_and_b32 v204, 0xffff0000, v191
    v_lshlrev_b32 v205, 16, v191
    v_mfma_f32_16x16x32_bf16 v[32:35], v[48:51], a[88:91], v[32:35]
    v_and_b32 v206, 0xffff0000, v190
    v_lshlrev_b32 v207, 16, v190
    v_mfma_f32_16x16x32_bf16 v[28:31], v[48:51], a[56:59], v[28:31]
    v_fmac_f32 v20, v204, v253
    v_fmac_f32 v21, v205, v253
    v_mfma_f32_16x16x32_bf16 v[24:27], v[48:51], a[24:27], v[24:27]
    s_add_u32 s64, s88, 0
    buffer_load_dwordx4 v[172:175], v241, s[16:19], s64 offen offset:0 sc1
    v_mfma_f32_16x16x32_bf16 v[36:39], v[52:55], a[100:103], v[36:39]
    v_fmac_f32 v22, v206, v253
    v_fmac_f32 v23, v207, v253
    v_mfma_f32_16x16x32_bf16 v[32:35], v[52:55], a[68:71], v[32:35]
    v_cvt_pk_bf16_f32 v190, v20, v21
    v_cvt_pk_bf16_f32 v191, v22, v23
    v_mfma_f32_16x16x32_bf16 v[28:31], v[52:55], a[36:39], v[28:31]
    v_mfma_f32_16x16x32_bf16 v[24:27], v[52:55], a[4:7], v[24:27]
    s_waitcnt lgkmcnt(2)
    v_mfma_f32_16x16x32_bf16 v[36:39], v[56:59], a[116:119], v[36:39]
    s_waitcnt vmcnt(19)
    s_cmp_eq_u32 s49, 0
    s_cbranch_scc1 SL_40
    s_atomic_add s49, s[28:29], s90
SL_40:
    v_mfma_f32_16x16x32_bf16 v[32:35], v[56:59], a[84:87], v[32:35]
    v_mfma_f32_16x16x32_bf16 v[28:31], v[56:59], a[52:55], v[28:31]
    v_mfma_f32_16x16x32_bf16 v[24:27], v[56:59], a[20:23], v[24:27]
    v_mfma_f32_16x16x32_bf16 v[36:39], v[60:63], a[104:107], v[36:39]
    v_mfma_f32_16x16x32_bf16 v[32:35], v[60:63], a[72:75], v[32:35]
    v_mfma_f32_16x16x32_bf16 v[28:31], v[60:63], a[40:43], v[28:31]
    v_mfma_f32_16x16x32_bf16 v[24:27], v[60:63], a[8:11], v[24:27]
    s_waitcnt lgkmcnt(0)
    v_mfma_f32_16x16x32_bf16 v[24:27], v[64:67], a[16:19], v[24:27]
    v_mfma_f32_16x16x32_bf16 v[28:31], v[64:67], a[48:51], v[28:31]
    v_mfma_f32_16x16x32_bf16 v[32:35], v[64:67], a[80:83], v[32:35]
    v_mfma_f32_16x16x32_bf16 v[36:39], v[64:67], a[112:115], v[36:39]
    v_mfma_f32_16x16x32_bf16 v[24:27], v[68:71], a[12:15], v[24:27]
    v_mfma_f32_16x16x32_bf16 v[28:31], v[68:71], a[44:47], v[28:31]
    v_mfma_f32_16x16x32_bf16 v[32:35], v[68:71], a[76:79], v[32:35]
    v_mfma_f32_16x16x32_bf16 v[36:39], v[68:71], a[108:111], v[36:39]
    v_and_b32 v204, 0xffff0000, v193
    v_lshlrev_b32 v205, 16, v193
    v_and_b32 v206, 0xffff0000, v192
    v_lshlrev_b32 v207, 16, v192
    s_nop 0
    v_fmac_f32 v24, v204, v253
    v_fmac_f32 v25, v205, v253
    v_fmac_f32 v26, v206, v253
    v_fmac_f32 v27, v207, v253
    v_cvt_pk_bf16_f32 v192, v24, v25
    v_cvt_pk_bf16_f32 v193, v26, v27
    v_and_b32 v204, 0xffff0000, v195
    v_lshlrev_b32 v205, 16, v195
    v_and_b32 v206, 0xffff0000, v194
    v_lshlrev_b32 v207, 16, v194
    v_fmac_f32 v28, v204, v253
    v_fmac_f32 v29, v205, v253
    v_fmac_f32 v30, v206, v253
    v_fmac_f32 v31, v207, v253
    v_cvt_pk_bf16_f32 v194, v28, v29
    v_cvt_pk_bf16_f32 v195, v30, v31
    v_and_b32 v204, 0xffff0000, v197
    v_lshlrev_b32 v205, 16, v197
    v_and_b32 v206, 0xffff0000, v196
    v_lshlrev_b32 v207, 16, v196
    v_fmac_f32 v32, v204, v253
    v_fmac_f32 v33, v205, v253
    v_fmac_f32 v34, v206, v253
    v_fmac_f32 v35, v207, v253
    v_cvt_pk_bf16_f32 v196, v32, v33
    v_cvt_pk_bf16_f32 v197, v34, v35
    v_and_b32 v204, 0xffff0000, v199
    v_lshlrev_b32 v205, 16, v199
    v_and_b32 v206, 0xffff0000, v198
    v_lshlrev_b32 v207, 16, v198
    v_fmac_f32 v36, v204, v253
    v_fmac_f32 v37, v205, v253
    v_fmac_f32 v38, v206, v253
    v_fmac_f32 v39, v207, v253
    v_cvt_pk_bf16_f32 v198, v36, v37
    v_cvt_pk_bf16_f32 v199, v38, v39
    ds_write_b64 v201, v[184:185] offset:0
    ds_write_b64 v201, v[186:187] offset:512
    ds_write_b64 v201, v[188:189] offset:1024
    ds_write_b64 v201, v[190:191] offset:1536
    ds_write_b64 v201, v[192:193] offset:2048
    ds_write_b64 v201, v[194:195] offset:2560
    ds_write_b64 v201, v[196:197] offset:3072
    ds_write_b64 v201, v[198:199] offset:3584
    ds_read_b128 v[40:43], v202 offset:0
    ds_read_b128 v[44:47], v202 offset:1024
    ds_read_b128 v[48:51], v202 offset:2048
    ds_read_b128 v[52:55], v202 offset:3072
    s_lshr_b32 s24, s43, 4
    s_lshl_b32 s24, s24, 16
    s_and_b32 s5, s43, 15
    s_lshl_b32 s5, s5, 6
    s_add_u32 s24, s24, s5
    s_add_u32 s24, s24, 7077888
    v_lshrrev_b32 v1, 2, v0
    v_and_b32 v3, 3, v0
    v_lshlrev_b32 v3, 4, v3
    v_lshl_add_u32 v1, v1, 10, v3
    s_waitcnt lgkmcnt(3)
    buffer_store_dwordx4 v[40:43], v1, s[16:19], s24 offen sc1
    s_add_u32 s24, s24, 16384
    s_waitcnt lgkmcnt(2)
    buffer_store_dwordx4 v[44:47], v1, s[16:19], s24 offen sc1
    s_add_u32 s24, s24, 16384
    s_waitcnt lgkmcnt(1)
    buffer_store_dwordx4 v[48:51], v1, s[16:19], s24 offen sc1
    s_add_u32 s24, s24, 16384
    s_waitcnt lgkmcnt(0)
    buffer_store_dwordx4 v[52:55], v1, s[16:19], s24 offen sc1
    s_bfe_u32 s24, s43, 0x20004
    s_mul_i32 s24, s24, 4352
    s_add_u32 s27, s24, 29724928
    s_mov_b32 s54, 16
    s_branch CVJ_41
NOCV_34:
    buffer_load_dwordx4 v[210:213], v250, s[12:15], s88 offen nt
    s_add_u32 s88, s88, 73728
    buffer_load_dwordx4 v[214:217], v250, s[12:15], s88 offen nt
    s_add_u32 s88, s88, 73728
    buffer_load_dwordx4 v[218:221], v250, s[12:15], s88 offen nt
    s_add_u32 s88, s88, 73728
    buffer_load_dwordx4 v[222:225], v250, s[12:15], s88 offen nt
    s_add_u32 s88, s88, 73728
    buffer_load_dwordx4 v[226:229], v250, s[12:15], s88 offen nt
    s_add_u32 s88, s88, 73728
    buffer_load_dwordx4 v[230:233], v250, s[12:15], s88 offen nt
    s_add_u32 s88, s88, 73728
    buffer_load_dwordx4 v[234:237], v250, s[12:15], s88 offen nt
    s_add_u32 s88, s88, 73728
    buffer_load_dwordx4 v[238:241], v250, s[12:15], s88 offen nt
    s_waitcnt vmcnt(0)
    s_cmp_lg_u32 s47, 0
    s_cbranch_scc1 SE_42
    s_mov_b32 s5, 1
    s_atomic_add s5, s[28:29], s38
    s_atomic_add s5, s[28:29], s39
SE_42:
    ds_write_b128 v202, v[210:213] offset:33280
    ds_write_b128 v202, v[214:217] offset:34304
    ds_write_b128 v202, v[218:221] offset:35328
    ds_write_b128 v202, v[222:225] offset:36352
    ds_read_b64_tr_b16 v[72:73], v244 offset:33280
    ds_read_b64_tr_b16 v[74:75], v244 offset:35328
    ds_read_b64_tr_b16 v[76:77], v245 offset:33280
    ds_read_b64_tr_b16 v[78:79], v245 offset:35328
    ds_read_b64_tr_b16 v[80:81], v246 offset:33280
    ds_read_b64_tr_b16 v[82:83], v246 offset:35328
    ds_read_b64_tr_b16 v[84:85], v247 offset:33280
    ds_read_b64_tr_b16 v[86:87], v247 offset:35328
    s_add_u32 s24, s89, 0
    s_waitcnt lgkmcnt(6)
    buffer_store_dwordx4 v[72:75], v252, s[16:19], s24 offen offset:0 sc1
    v_mfma_f32_16x16x32_bf16 v[88:91], v[4:7], v[72:75], 0
    s_add_u32 s24, s89, 18432
    s_waitcnt lgkmcnt(4)
    buffer_store_dwordx4 v[76:79], v252, s[16:19], s24 offen offset:0 sc1
    v_mfma_f32_16x16x32_bf16 v[92:95], v[4:7], v[76:79], 0
    s_add_u32 s24, s89, 36864
    s_waitcnt lgkmcnt(2)
    buffer_store_dwordx4 v[80:83], v252, s[16:19], s24 offen offset:0 sc1
    v_mfma_f32_16x16x32_bf16 v[96:99], v[4:7], v[80:83], 0
    s_add_u32 s24, s89, 55296
    s_waitcnt lgkmcnt(0)
    buffer_store_dwordx4 v[84:87], v252, s[16:19], s24 offen offset:0 sc1
    v_mfma_f32_16x16x32_bf16 v[100:103], v[4:7], v[84:87], 0
    ds_write_b128 v202, v[226:229] offset:33280
    ds_write_b128 v202, v[230:233] offset:34304
    ds_write_b128 v202, v[234:237] offset:35328
    ds_write_b128 v202, v[238:241] offset:36352
    ds_read_b64_tr_b16 v[104:105], v244 offset:33280
    ds_read_b64_tr_b16 v[106:107], v244 offset:35328
    ds_read_b64_tr_b16 v[108:109], v245 offset:33280
    ds_read_b64_tr_b16 v[110:111], v245 offset:35328
    ds_read_b64_tr_b16 v[112:113], v246 offset:33280
    ds_read_b64_tr_b16 v[114:115], v246 offset:35328
    ds_read_b64_tr_b16 v[116:117], v247 offset:33280
    ds_read_b64_tr_b16 v[118:119], v247 offset:35328
    s_add_u32 s24, s89, 0
    s_waitcnt lgkmcnt(6)
    buffer_store_dwordx4 v[104:107], v252, s[16:19], s24 offen offset:1024 sc1
    v_mfma_f32_16x16x32_bf16 v[88:91], v[4:7], v[104:107], v[88:91]
    s_add_u32 s24, s89, 18432
    s_waitcnt lgkmcnt(4)
    buffer_store_dwordx4 v[108:111], v252, s[16:19], s24 offen offset:1024 sc1
    v_mfma_f32_16x16x32_bf16 v[92:95], v[4:7], v[108:111], v[92:95]
    s_add_u32 s24, s89, 36864
    s_waitcnt lgkmcnt(2)
    buffer_store_dwordx4 v[112:115], v252, s[16:19], s24 offen offset:1024 sc1
    v_mfma_f32_16x16x32_bf16 v[96:99], v[4:7], v[112:115], v[96:99]
    s_add_u32 s24, s89, 55296
    s_waitcnt lgkmcnt(0)
    buffer_store_dwordx4 v[116:119], v252, s[16:19], s24 offen offset:1024 sc1
    v_mfma_f32_16x16x32_bf16 v[100:103], v[4:7], v[116:119], v[100:103]
    v_lshrrev_b32 v1, 4, v0
    v_cmp_eq_u32 vcc, 1, v1
    v_cmp_eq_u32 s[50:51], 2, v1
    v_cmp_eq_u32 s[52:53], 3, v1
    v_lshlrev_b32 v2, 2, v0
    v_cndmask_b32 v3, v88, v92, vcc
    v_cndmask_b32 v3, v3, v96, s[50:51]
    s_nop 0
    v_cndmask_b32 v248, v3, v100, s[52:53]
    buffer_atomic_add_f32 v248, v2, s[16:19], s91 offen
    s_waitcnt vmcnt(0)
    s_cmp_eq_u32 s49, 0
    s_cbranch_scc1 SL_43
    s_atomic_add s49, s[28:29], s90
SL_43:
    s_waitcnt lgkmcnt(0)
    s_and_b32 s20, s2, 3
    s_lshl_b32 s20, s20, 1
    s_lshr_b32 s64, s2, 7
    s_add_u32 s20, s20, s64
    s_mul_i32 s7, s20, 4352
    s_add_u32 s7, s7, 29616128
    s_mul_i32 s64, s20, 663552
    s_add_u32 s64, s64, 33030144
    s_mul_i32 s65, s23, 36864
    s_add_u32 s88, s64, s65
    s_lshr_b32 s65, s23, 1
    s_mul_i32 s65, s65, 36864
    s_add_u32 s59, s64, s65
    s_add_u32 s59, s59, 589824
    v_and_b32 v3, 15, v0
    v_lshrrev_b32 v1, 5, v0
    v_lshlrev_b32 v1, 8, v1
    v_lshl_add_u32 v1, v3, 4, v1
    v_bfe_u32 v2, v0, 4, 1
    v_mul_u32_u24 v241, 18432, v2
    s_and_b32 s65, s23, 1
    s_lshl_b32 s65, s65, 9
    v_add3_u32 v241, s65, v241, v1
    v_xor_b32 v242, 512, v241
    s_cmp_ge_u32 s23, 1
    s_cbranch_scc1 OK_45
    s_load_dword s4, s[28:29], s7 glc
    s_mov_b32 s3, 0
SP_44:
    s_waitcnt lgkmcnt(0)
    s_cmp_ge_u32 s4, 27
    s_cbranch_scc1 OK_45
    s_add_u32 s3, s3, 1
    s_cmp_gt_u32 s3, 200000
    s_cbranch_scc1 OK_45
    s_sleep 8
    s_load_dword s4, s[28:29], s7 glc
    s_branch SP_44
OK_45:
    s_waitcnt lgkmcnt(0)
    s_barrier
    s_add_u32 s64, s59, 0
    buffer_load_dwordx4 v[100:103], v241, s[16:19], s64 offen offset:0 sc1
    buffer_load_dwordx4 v[104:107], v241, s[16:19], s64 offen offset:1024 sc1
    buffer_load_dwordx4 v[108:111], v241, s[16:19], s64 offen offset:2048 sc1
    buffer_load_dwordx4 v[112:115], v241, s[16:19], s64 offen offset:3072 sc1
    s_add_u32 s64, s59, 4096
    buffer_load_dwordx4 v[116:119], v241, s[16:19], s64 offen offset:0 sc1
    buffer_load_dwordx4 v[120:123], v241, s[16:19], s64 offen offset:1024 sc1
    buffer_load_dwordx4 v[124:127], v241, s[16:19], s64 offen offset:2048 sc1
    buffer_load_dwordx4 v[128:131], v241, s[16:19], s64 offen offset:3072 sc1
    s_add_u32 s64, s59, 8192
    buffer_load_dwordx4 v[132:135], v241, s[16:19], s64 offen offset:0 sc1
    buffer_load_dwordx4 v[136:139], v241, s[16:19], s64 offen offset:1024 sc1
    buffer_load_dwordx4 v[140:143], v241, s[16:19], s64 offen offset:2048 sc1
    buffer_load_dwordx4 v[144:147], v241, s[16:19], s64 offen offset:3072 sc1
    s_add_u32 s64, s59, 12288
    buffer_load_dwordx4 v[148:151], v241, s[16:19], s64 offen offset:0 sc1
    buffer_load_dwordx4 v[152:155], v241, s[16:19], s64 offen offset:1024 sc1
    buffer_load_dwordx4 v[156:159], v241, s[16:19], s64 offen offset:2048 sc1
    buffer_load_dwordx4 v[160:163], v241, s[16:19], s64 offen offset:3072 sc1
    s_add_u32 s64, s59, 16384
    buffer_load_dwordx4 v[164:167], v241, s[16:19], s64 offen offset:0 sc1
    buffer_load_dwordx4 v[168:171], v241, s[16:19], s64 offen offset:1024 sc1
    s_add_u32 s64, s88, 0
    buffer_load_dwordx4 v[172:175], v241, s[16:19], s64 offen offset:0 sc1
CVJ_41:
    s_load_dwordx2 s[8:9], s[0:1], 88
    s_load_dwordx2 s[12:13], s[0:1], 80
    s_bfe_u32 s21, s2, 262147
    s_bfe_u32 s65, s2, 65538
    s_lshl_b32 s65, s65, 4
    s_add_u32 s21, s21, s65
    v_lshlrev_b32 v240, 4, v0
    s_mov_b32 s10, 2359296
    s_mov_b32 s11, 0x20000
    s_mov_b32 s14, 5308416
    s_mov_b32 s15, 0x20000
    v_lshlrev_b32 v249, 2, v0
    s_mul_i32 s7, s21, 4352
    s_add_u32 s7, s7, 29476864
    s_cmp_lg_u32 s23, 0
    s_cbranch_scc1 XP_46
    s_load_dword s4, s[28:29], s7 glc
XP_46:
K_x:
    s_mul_i32 s65, s23, 18432
    s_mul_i32 s66, s21, 73728
    s_add_u32 s66, s66, s65
    s_add_u32 m0, s65, 90112
    s_add_u32 s66, s66, 2359296
    s_lshl_b32 s65, s21, 6
    v_add_u32 v248, s65, v0
    v_lshlrev_b32 v248, 3, v248
    s_cmp_ge_u32 s23, 1
    s_cbranch_scc1 OK_48
    s_mov_b32 s3, 0
SP_47:
    s_waitcnt lgkmcnt(0)
    s_cmp_ge_u32 s4, 9
    s_cbranch_scc1 OK_48
    s_add_u32 s3, s3, 1
    s_cmp_gt_u32 s3, 200000
    s_cbranch_scc1 OK_48
    s_load_dword s4, s[28:29], s7 glc
    s_branch SP_47
OK_48:
    s_waitcnt lgkmcnt(0)
    s_barrier
    buffer_load_dwordx4 v240, s[16:19], s66 offen offset:0 sc1 lds
    buffer_load_dwordx4 v240, s[16:19], s66 offen offset:1024 sc1 lds
    buffer_load_dwordx4 v240, s[16:19], s66 offen offset:2048 sc1 lds
    buffer_load_dwordx4 v240, s[16:19], s66 offen offset:3072 sc1 lds
    s_add_u32 m0, m0, 4096
    s_add_u32 s66, s66, 4096
    buffer_load_dwordx4 v240, s[16:19], s66 offen offset:0 sc1 lds
    buffer_load_dwordx4 v240, s[16:19], s66 offen offset:1024 sc1 lds
    s_barrier
    buffer_load_dwordx4 v240, s[16:19], s66 offen offset:2048 sc1 lds
    buffer_load_dwordx4 v240, s[16:19], s66 offen offset:3072 sc1 lds
    s_add_u32 m0, m0, 4096
    s_add_u32 s66, s66, 4096
    buffer_load_dwordx4 v240, s[16:19], s66 offen offset:0 sc1 lds
    buffer_load_dwordx4 v240, s[16:19], s66 offen offset:1024 sc1 lds
    buffer_load_dwordx4 v240, s[16:19], s66 offen offset:2048 sc1 lds
    buffer_load_dwordx4 v240, s[16:19], s66 offen offset:3072 sc1 lds
K_p3:
    v_and_b32 v3, 15, v0
    v_lshrrev_b32 v1, 5, v0
    v_lshlrev_b32 v1, 8, v1
    v_lshl_add_u32 v244, v3, 4, v1
    v_bfe_u32 v2, v0, 4, 1
    v_lshl_add_u32 v244, v2, 10, v244
    s_mul_i32 s6, s21, 57
    s_lshr_b32 s6, s6, 9
    s_mul_i32 s6, s6, 9
    s_sub_u32 s22, s21, s6
    s_mul_i32 s6, s20, 663552
    s_mul_i32 s65, s23, 9216
    s_add_u32 s6, s6, s65
    s_mov_b32 s65, s22
    s_lshl_b32 s30, s65, 7
    s_add_u32 s30, s30, s6
    s_lshl_b32 s40, s65, 13
    s_add_u32 s65, s65, 1
    s_cmp_eq_u32 s65, 9
    s_cselect_b32 s65, 0, s65
    s_lshl_b32 s31, s65, 7
    s_add_u32 s31, s31, s6
    s_lshl_b32 s41, s65, 13
    s_add_u32 s65, s65, 1
    s_cmp_eq_u32 s65, 9
    s_cselect_b32 s65, 0, s65
    s_lshl_b32 s32, s65, 7
    s_add_u32 s32, s32, s6
    s_lshl_b32 s42, s65, 13
    s_add_u32 s65, s65, 1
    s_cmp_eq_u32 s65, 9
    s_cselect_b32 s65, 0, s65
    s_lshl_b32 s33, s65, 7
    s_add_u32 s33, s33, s6
    s_lshl_b32 s43, s65, 13
    s_add_u32 s65, s65, 1
    s_cmp_eq_u32 s65, 9
    s_cselect_b32 s65, 0, s65
    s_lshl_b32 s34, s65, 7
    s_add_u32 s34, s34, s6
    s_lshl_b32 s44, s65, 13
    s_add_u32 s65, s65, 1
    s_cmp_eq_u32 s65, 9
    s_cselect_b32 s65, 0, s65
    s_lshl_b32 s35, s65, 7
    s_add_u32 s35, s35, s6
    s_lshl_b32 s45, s65, 13
    s_add_u32 s65, s65, 1
    s_cmp_eq_u32 s65, 9
    s_cselect_b32 s65, 0, s65
    s_lshl_b32 s36, s65, 7
    s_add_u32 s36, s36, s6
    s_lshl_b32 s46, s65, 13
    s_add_u32 s65, s65, 1
    s_cmp_eq_u32 s65, 9
    s_cselect_b32 s65, 0, s65
    s_lshl_b32 s37, s65, 7
    s_add_u32 s37, s37, s6
    s_lshl_b32 s47, s65, 13
    s_add_u32 s65, s65, 1
    s_cmp_eq_u32 s65, 9
    s_cselect_b32 s65, 0, s65
    s_lshl_b32 s38, s65, 7
    s_add_u32 s38, s38, s6
    s_lshl_b32 s48, s65, 13
    s_add_u32 s50, s22, 0
    s_add_u32 s50, s50, s23
    s_cmp_ge_u32 s50, 9
    s_cselect_b32 s65, 9, 0
    s_sub_u32 s50, s50, s65
    s_add_u32 s51, s22, 4
    s_add_u32 s51, s51, s23
    s_cmp_ge_u32 s51, 9
    s_cselect_b32 s65, 9, 0
    s_sub_u32 s51, s51, s65
    s_add_u32 s52, s22, 8
    s_cmp_ge_u32 s52, 9
    s_cselect_b32 s65, 9, 0
    s_sub_u32 s52, s52, s65
    s_lshl_b32 s61, s23, 10
    s_add_u32 s61, s61, 75008
    s_add_u32 s62, s61, 4096
    s_mov_b32 s63, 83200
    s_and_b32 s65, s23, 1
    s_mul_i32 s6, s65, 36864
    s_add_u32 s6, s6, 90112
    v_add_u32 v196, s6, v241
    s_sub_u32 s6, 217088, s6
    v_add_u32 v197, s6, v241
    v_xor_b32 v198, 512, v196
    v_xor_b32 v199, 512, v197
    v_add_u32 v243, 0x10000, v240
    s_lshl_b32 s65, s65, 11
    s_lshl_b32 s6, s23, 12
    s_add_u32 s6, s6, s65
    v_add_u32 v244, s6, v244
    v_xor_b32 v245, 2048, v244
    s_lshl_b32 s6, s23, 7
    s_add_u32 s6, s6, 73728
    v_lshrrev_b32 v1, 5, v0
    v_lshl_add_u32 v246, v1, 4, s6
    s_mul_i32 s6, s21, 73728
    s_add_u32 s57, s6, 9437184
    s_mul_i32 s60, s20, 2359296
    s_add_u32 s60, s60, s57
    s_lshl_b32 s89, s23, 10
    s_add_u32 s60, s60, s89
    s_lshl_b32 s6, s20, 10
    s_add_u32 s57, s57, s6
    s_lshr_b32 s24, s20, 2
    s_and_b32 s25, s20, 3
    s_cmp_eq_u32 s23, s25
    s_cselect_b32 s91, s24, 2
    s_lshl_b32 s26, s21, 6
    s_lshl_b32 s6, s24, 5
    s_add_u32 s26, s26, s6
    s_mul_i32 s6, s21, 17408
    s_add_u32 s6, s6, 28641280
    s_mul_i32 s55, s23, 4352
    s_add_u32 s55, s55, s6
    s_mul_i32 s56, s25, 4352
    s_add_u32 s56, s56, s6
    s_cmp_eq_u32 s23, 3
    s_cselect_b32 s53, 8, 4
    s_add_u32 s53, s53, s56
    v_lshrrev_b32 v1, 3, v0
    v_and_b32 v2, 6, v1
    v_and_b32 v3, 7, v0
    v_xor_b32 v2, v2, v3
    v_mul_u32_u24 v250, 1152, v1
    v_lshl_add_u32 v250, v2, 4, v250
    v_lshrrev_b32 v1, 2, v0
    v_bfe_u32 v2, v1, 1, 2
    v_xor_b32 v2, s23, v2
    v_lshlrev_b32 v2, 5, v2
    v_lshl_add_u32 v2, v1, 7, v2
    v_and_b32 v3, 3, v0
    v_lshl_add_u32 v251, v3, 3, v2
    v_add_u32 v252, 0xf000, v251
    v_add_u32 v253, 0x1e000, v251
    s_waitcnt vmcnt(6) lgkmcnt(0)
    s_barrier
    ds_read_b128 a[0:3], v196 offset:0
    ds_read_b128 a[4:7], v197 offset:0
    ds_read_b128 a[16:19], v196 offset:1024
    ds_read_b128 a[20:23], v197 offset:1024
    ds_read_b128 a[32:35], v196 offset:2048
    ds_read_b128 a[36:39], v197 offset:2048
    s_waitcnt lgkmcnt(4)
    v_mfma_f32_32x32x16_bf16 v[68:83], v[100:103], a[0:3], 0
    s_add_u32 m0, m0, 4096
    s_add_u32 s66, s66, 4096
    buffer_load_dwordx4 v240, s[16:19], s66 offen offset:0 sc1 lds
    ds_read_b128 a[48:51], v196 offset:3072
    v_mfma_f32_32x32x16_bf16 v[84:99], v[100:103], a[4:7], 0
    buffer_load_dwordx4 v240, s[16:19], s66 offen offset:1024 sc1 lds
    ds_read_b128 a[52:55], v197 offset:3072
    s_waitcnt lgkmcnt(4)
    v_mfma_f32_32x32x16_bf16 v[68:83], v[104:107], a[16:19], v[68:83]
    buffer_load_dwordx4 v240, s[16:19], s66 offen offset:2048 sc1 lds
    ds_read_b128 a[64:67], v196 offset:4096
    v_mfma_f32_32x32x16_bf16 v[84:99], v[104:107], a[20:23], v[84:99]
    buffer_load_dwordx4 v240, s[16:19], s66 offen offset:3072 sc1 lds
    ds_read_b128 a[68:71], v197 offset:4096
    s_waitcnt lgkmcnt(4)
    v_mfma_f32_32x32x16_bf16 v[68:83], v[108:111], a[32:35], v[68:83]
    s_add_u32 m0, m0, 4096
    s_add_u32 s66, s66, 4096
    buffer_load_dwordx4 v240, s[16:19], s66 offen offset:0 sc1 lds
    ds_read_b128 a[80:83], v196 offset:5120
    ds_read_b128 a[8:11], v198 offset:0
    v_mfma_f32_32x32x16_bf16 v[84:99], v[108:111], a[36:39], v[84:99]
    buffer_load_dwordx4 v240, s[16:19], s66 offen offset:1024 sc1 lds
    ds_read_b128 a[84:87], v197 offset:5120
    ds_read_b128 a[12:15], v199 offset:0
    s_waitcnt lgkmcnt(6)
    v_mfma_f32_32x32x16_bf16 v[68:83], v[112:115], a[48:51], v[68:83]
    s_waitcnt vmcnt(6)
    s_barrier
    s_mov_b32 s65, 28327936
    buffer_load_dwordx2 v[36:37], v248, s[16:19], s65 offen sc1
    s_mov_b32 s65, 28344320
    buffer_load_dwordx2 v[38:39], v248, s[16:19], s65 offen sc1
    ds_read_b128 a[96:99], v196 offset:6144
    ds_read_b128 a[24:27], v198 offset:1024
    v_mfma_f32_32x32x16_bf16 v[84:99], v[112:115], a[52:55], v[84:99]
    s_mov_b32 s65, 28360704
    buffer_load_dwordx2 v[40:41], v248, s[16:19], s65 offen sc1
    s_mov_b32 s65, 28377088
    buffer_load_dwordx2 v[42:43], v248, s[16:19], s65 offen sc1
    ds_read_b128 a[100:103], v197 offset:6144
    ds_read_b128 a[28:31], v199 offset:1024
    s_waitcnt lgkmcnt(8)
    v_mfma_f32_32x32x16_bf16 v[68:83], v[116:119], a[64:67], v[68:83]
    s_mov_b32 s65, 28393472
    buffer_load_dwordx2 v[44:45], v248, s[16:19], s65 offen sc1
    s_mov_b32 s65, 28409856
    buffer_load_dwordx2 v[46:47], v248, s[16:19], s65 offen sc1
    ds_read_b128 a[112:115], v196 offset:7168
    ds_read_b128 a[40:43], v198 offset:2048
    v_mfma_f32_32x32x16_bf16 v[84:99], v[116:119], a[68:71], v[84:99]
    s_mov_b32 s65, 28426240
    buffer_load_dwordx2 v[48:49], v248, s[16:19], s65 offen sc1
    s_mov_b32 s65, 28442624
    buffer_load_dwordx2 v[50:51], v248, s[16:19], s65 offen sc1
    ds_read_b128 a[116:119], v197 offset:7168
    ds_read_b128 a[44:47], v199 offset:2048
    s_waitcnt lgkmcnt(9)
    v_mfma_f32_32x32x16_bf16 v[68:83], v[120:123], a[80:83], v[68:83]
    s_mov_b32 s65, 28459008
    buffer_load_dwordx2 v[52:53], v248, s[16:19], s65 offen sc1
    ds_read_b128 a[128:131], v196 offset:8192
    ds_read_b128 a[56:59], v198 offset:3072
    s_mul_i32 s7, s20, 4352
    s_add_u32 s7, s7, 29650944
    s_cmp_lg_u32 s23, 0
    s_cbranch_scc1 P3_cl
    s_load_dword s4, s[28:29], s7 glc
P3_cl:
    v_mfma_f32_32x32x16_bf16 v[84:99], v[120:123], a[84:87], v[84:99]
    ds_read_b128 a[132:135], v197 offset:8192
    ds_read_b128 a[60:63], v199 offset:3072
    buffer_load_dwordx4 v[176:179], v242, s[16:19], s64 offen offset:0 sc1
    buffer_load_dwordx4 v[180:183], v241, s[16:19], s64 offen offset:1024 sc1
    s_waitcnt lgkmcnt(9)
    v_mfma_f32_32x32x16_bf16 v[68:83], v[124:127], a[96:99], v[68:83]
    ds_read_b128 a[144:147], v196 offset:9216
    ds_read_b128 a[72:75], v198 offset:4096
    s_mul_i32 s66, s20, 2304
    s_lshr_b32 s6, s23, 1
    s_lshl_b32 s6, s6, 8
    s_mov_b32 s6, 0
    s_add_u32 m0, s6, 75776
    s_add_u32 s66, s66, s6
    s_add_u32 s66, s66, 28477440
    buffer_load_dword v249, s[16:19], s66 offen sc1 lds
    v_mfma_f32_32x32x16_bf16 v[84:99], v[124:127], a[100:103], v[84:99]
    ds_read_b128 a[148:151], v197 offset:9216
    ds_read_b128 a[76:79], v199 offset:4096
    buffer_load_dwordx4 v[100:103], v242, s[16:19], s64 offen offset:1024 sc1
    buffer_load_dwordx4 v[104:107], v241, s[16:19], s64 offen offset:2048 sc1
    s_waitcnt lgkmcnt(9)
    v_mfma_f32_32x32x16_bf16 v[68:83], v[128:131], a[112:115], v[68:83]
    ds_read_b128 a[160:163], v196 offset:10240
    ds_read_b128 a[88:91], v198 offset:5120
    s_mul_i32 s66, s20, 2304
    s_lshr_b32 s6, s23, 1
    s_lshl_b32 s6, s6, 8
    s_add_u32 m0, s6, 73728
    s_add_u32 s66, s66, s6
    s_add_u32 s66, s66, 28475392
    buffer_load_dword v249, s[16:19], s66 offen sc1 lds
    v_mfma_f32_32x32x16_bf16 v[84:99], v[128:131], a[116:119], v[84:99]
    ds_read_b128 a[164:167], v197 offset:10240
    ds_read_b128 a[92:95], v199 offset:5120
    buffer_load_dwordx4 v[108:111], v242, s[16:19], s64 offen offset:2048 sc1
    buffer_load_dwordx4 v[112:115], v241, s[16:19], s64 offen offset:3072 sc1
    s_waitcnt lgkmcnt(9)
    v_mfma_f32_32x32x16_bf16 v[68:83], v[132:135], a[128:131], v[68:83]
    ds_read_b128 a[176:179], v196 offset:11264
    ds_read_b128 a[104:107], v198 offset:6144
    v_mfma_f32_32x32x16_bf16 v[84:99], v[132:135], a[132:135], v[84:99]
    ds_read_b128 a[180:183], v197 offset:11264
    ds_read_b128 a[108:111], v199 offset:6144
    buffer_load_dwordx4 v[116:119], v242, s[16:19], s64 offen offset:3072 sc1
    s_add_u32 s64, s88, 4096
    buffer_load_dwordx4 v[120:123], v241, s[16:19], s64 offen offset:0 sc1
    s_waitcnt lgkmcnt(9)
    v_mfma_f32_32x32x16_bf16 v[68:83], v[136:139], a[144:147], v[68:83]
    s_waitcnt vmcnt(19)
    s_barrier
    ds_read_b128 a[192:195], v196 offset:12288
    ds_read_b128 a[120:123], v198 offset:7168
    v_mfma_f32_32x32x16_bf16 v[84:99], v[136:139], a[148:151], v[84:99]
    ds_read_b128 a[196:199], v197 offset:12288
    ds_read_b128 a[124:127], v199 offset:7168
    buffer_load_dwordx4 v[124:127], v242, s[16:19], s64 offen offset:0 sc1
    buffer_load_dwordx4 v[128:131], v241, s[16:19], s64 offen offset:1024 sc1
    s_waitcnt lgkmcnt(9)
    v_mfma_f32_32x32x16_bf16 v[68:83], v[140:143], a[160:163], v[68:83]
    ds_read_b128 a[208:211], v196 offset:13312
    ds_read_b128 a[136:139], v198 offset:8192
    v_mfma_f32_32x32x16_bf16 v[84:99], v[140:143], a[164:167], v[84:99]
    ds_read_b128 a[212:215], v197 offset:13312
    ds_read_b128 a[140:143], v199 offset:8192
    buffer_load_dwordx4 v[132:135], v242, s[16:19], s64 offen offset:1024 sc1
    buffer_load_dwordx4 v[136:139], v241, s[16:19], s64 offen offset:2048 sc1
    s_waitcnt lgkmcnt(9)
    v_mfma_f32_32x32x16_bf16 v[68:83], v[144:147], a[176:179], v[68:83]
    ds_read_b128 a[224:227], v196 offset:14336
    ds_read_b128 a[152:155], v198 offset:9216
    v_mfma_f32_32x32x16_bf16 v[84:99], v[144:147], a[180:183], v[84:99]
    ds_read_b128 a[228:231], v197 offset:14336
    ds_read_b128 a[156:159], v199 offset:9216
    buffer_load_dwordx4 v[140:143], v242, s[16:19], s64 offen offset:2048 sc1
    s_waitcnt lgkmcnt(9)
    v_mfma_f32_32x32x16_bf16 v[68:83], v[148:151], a[192:195], v[68:83]
    ds_read_b128 a[240:243], v196 offset:15360
    ds_read_b128 a[168:171], v198 offset:10240
    v_and_b32 v209, 15, v0
    v_lshlrev_b32 v209, 2, v209
    v_and_b32 v208, 31, v0
    s_and_b32 s65, s23, 1
    s_lshl_b32 s65, s65, 7
    v_lshl_add_u32 v208, v208, 2, s65
    v_mfma_f32_32x32x16_bf16 v[84:99], v[148:151], a[196:199], v[84:99]
    ds_read_b128 a[244:247], v197 offset:15360
    ds_read_b128 a[172:175], v199 offset:10240
    v_xor_b32 v210, 128, v208
    s_waitcnt vmcnt(15)
    v_add_f32 v36, v36, v38
    buffer_load_dwordx4 v[144:147], v241, s[16:19], s64 offen offset:3072 sc1
    s_waitcnt lgkmcnt(9)
    v_mfma_f32_32x32x16_bf16 v[68:83], v[152:155], a[208:211], v[68:83]
    ds_read_b128 v[4:7], v196 offset:16384
    ds_read_b128 a[184:187], v198 offset:11264
    v_add_f32 v37, v37, v39
    v_add_f32 v36, v36, v40
    v_add_f32 v37, v37, v41
    v_add_f32 v36, v36, v42
    v_add_f32 v37, v37, v43
    v_add_f32 v36, v36, v44
    v_mfma_f32_32x32x16_bf16 v[84:99], v[152:155], a[212:215], v[84:99]
    ds_read_b128 v[8:11], v197 offset:16384
    ds_read_b128 a[188:191], v199 offset:11264
    v_add_f32 v37, v37, v45
    v_add_f32 v36, v36, v46
    buffer_load_dwordx4 v[148:151], v242, s[16:19], s64 offen offset:3072 sc1
    s_waitcnt lgkmcnt(9)
    v_mfma_f32_32x32x16_bf16 v[68:83], v[156:159], a[224:227], v[68:83]
    ds_read_b128 v[20:23], v196 offset:17408
    ds_read_b128 a[200:203], v198 offset:12288
    v_add_f32 v37, v37, v47
    v_add_f32 v36, v36, v48
    v_add_f32 v37, v37, v49
    v_add_f32 v36, v36, v50
    v_add_f32 v37, v37, v51
    v_add_f32 v36, v36, v52
    v_mfma_f32_32x32x16_bf16 v[84:99], v[156:159], a[228:231], v[84:99]
    ds_read_b128 v[24:27], v197 offset:17408
    ds_read_b128 a[204:207], v199 offset:12288
    v_add_f32 v37, v37, v53
    v_mul_f32 v36, 0x3ae38e39, v36
    s_add_u32 s64, s88, 8192
    buffer_load_dwordx4 v[152:155], v241, s[16:19], s64 offen offset:0 sc1
    s_waitcnt lgkmcnt(9)
    v_mfma_f32_32x32x16_bf16 v[68:83], v[160:163], a[240:243], v[68:83]
    ds_read_b128 a[216:219], v198 offset:13312
    v_mul_f32 v37, 0x3ae38e39, v37
    v_fma_f32 v37, -v36, v36, v37
    v_max_f32 v37, 0, v37
    v_cvt_pk_bf16_f32 v38, v36, v37
    v_and_b32 v37, 0xffff0000, v38
    v_lshlrev_b32 v36, 16, v38
    v_add_f32 v37, 0x3727c5ac, v37
    v_cvt_pk_bf16_f32 v37, v37, v37
    v_mfma_f32_32x32x16_bf16 v[84:99], v[160:163], a[244:247], v[84:99]
    ds_read_b128 a[220:223], v199 offset:13312
    v_lshlrev_b32 v37, 16, v37
    v_sqrt_f32 v37, v37
    v_sub_f32 v201, 0, v36
    buffer_load_dwordx4 v[156:159], v242, s[16:19], s64 offen offset:0 sc1
    s_waitcnt lgkmcnt(7)
    v_mfma_f32_32x32x16_bf16 v[68:83], v[164:167], v[4:7], v[68:83]
    ds_read_b128 a[232:235], v198 offset:14336
    v_cvt_pk_bf16_f32 v37, v37, v37
    v_lshlrev_b32 v37, 16, v37
    v_rcp_f32 v200, v37
    s_nop 0
    v_mul_f32 v202, 0xc0135761, v200
    v_mul_f32 v203, v200, v200
    v_mul_f32 v203, v203, v202
    v_mul_f32 v203, 0x3d372713, v203
    v_mfma_f32_32x32x16_bf16 v[84:99], v[164:167], v[8:11], v[84:99]
    ds_read_b128 a[236:239], v199 offset:14336
    ds_bpermute_b32 v234, v208, v201
    ds_bpermute_b32 v235, v208, v202
    ds_bpermute_b32 v236, v208, v203
    buffer_load_dwordx4 v[160:163], v241, s[16:19], s64 offen offset:1024 sc1
    s_waitcnt lgkmcnt(8)
    v_mfma_f32_32x32x16_bf16 v[68:83], v[168:171], v[20:23], v[68:83]
    ds_read_b128 a[248:251], v198 offset:15360
    ds_bpermute_b32 v237, v210, v201
    ds_bpermute_b32 v238, v210, v202
    ds_bpermute_b32 v239, v210, v203
    s_lshl_b32 s65, s24, 7
    v_add_u32 v209, s65, v209
    ds_bpermute_b32 v220, v209, v200 offset:0
    ds_bpermute_b32 v221, v209, v200 offset:64
    v_mfma_f32_32x32x16_bf16 v[84:99], v[168:171], v[24:27], v[84:99]
    ds_read_b128 a[252:255], v199 offset:15360
    s_lshr_b32 s65, s23, 1
    s_lshl_b32 s65, s65, 6
    v_add_u32 v209, s65, v209
    ds_bpermute_b32 v222, v209, v200
    buffer_load_dwordx4 v[164:167], v242, s[16:19], s64 offen offset:1024 sc1
    v_mfma_f32_32x32x16_bf16 v[36:51], v[172:175], a[0:3], 0
    ds_read_b128 v[12:15], v198 offset:16384
    s_mul_i32 s58, s24, 36864
    s_lshr_b32 s66, s25, 1
    s_lshl_b32 s66, s66, 10
    s_add_u32 s58, s58, s66
    v_mfma_f32_32x32x16_bf16 v[52:67], v[172:175], a[4:7], 0
    ds_read_b128 v[16:19], v199 offset:16384
    s_and_b32 s66, s25, 1
    s_lshl_b32 s66, s66, 3
    s_add_u32 s58, s58, s66
    s_add_u32 s58, s58, 90112
    buffer_load_dwordx4 v[168:171], v241, s[16:19], s64 offen offset:2048 sc1
    s_waitcnt vmcnt(21)
    v_mfma_f32_32x32x16_bf16 v[36:51], v[176:179], a[8:11], v[36:51]
    ds_read_b128 v[28:31], v198 offset:17408
    s_lshl_b32 s66, s50, 11
    s_add_u32 s66, s66, s58
    v_add_u32 v248, s66, v240
    ds_read_b64 v[224:225], v248
    v_mfma_f32_32x32x16_bf16 v[52:67], v[176:179], a[12:15], v[52:67]
    ds_read_b128 v[32:35], v199 offset:17408
    s_lshl_b32 s65, s23, 12
    v_add_u32 v212, s65, v240
    v_xor_b32 v213, 4096, v212
    ds_read_b64 v[226:227], v248 offset:18432
    buffer_load_dwordx4 v[172:175], v242, s[16:19], s64 offen offset:2048 sc1
    s_waitcnt vmcnt(21)
    v_mfma_f32_32x32x16_bf16 v[36:51], v[180:183], a[16:19], v[36:51]
    ds_write_b128 v212, v[84:87] offset:57344
    s_lshl_b32 s66, s51, 11
    s_add_u32 s66, s66, s58
    v_mfma_f32_32x32x16_bf16 v[52:67], v[180:183], a[20:23], v[52:67]
    ds_write_b128 v212, v[88:91] offset:58368
    buffer_load_dwordx4 v[176:179], v241, s[16:19], s64 offen offset:3072 sc1
    s_waitcnt vmcnt(20)
    v_mfma_f32_32x32x16_bf16 v[36:51], v[100:103], a[24:27], v[36:51]
    ds_write_b128 v212, v[92:95] offset:59392
    v_add_u32 v248, s66, v240
    ds_read_b64 v[228:229], v248
    v_mfma_f32_32x32x16_bf16 v[52:67], v[100:103], a[28:31], v[52:67]
    ds_write_b128 v212, v[96:99] offset:60416
    buffer_load_dwordx4 v[180:183], v242, s[16:19], s64 offen offset:3072 sc1
    s_waitcnt vmcnt(20)
    v_mfma_f32_32x32x16_bf16 v[36:51], v[104:107], a[32:35], v[36:51]
    ds_read_b64 v[230:231], v248 offset:18432
    s_lshl_b32 s66, s52, 11
    s_add_u32 s66, s66, s58
    s_lshr_b32 s6, s23, 1
    s_mul_i32 s6, s6, 18432
    s_add_u32 s66, s66, s6
    v_mfma_f32_32x32x16_bf16 v[52:67], v[104:107], a[36:39], v[52:67]
    s_and_b32 s6, s23, 1
    s_lshl_b32 s6, s6, 2
    s_add_u32 s66, s66, s6
    v_add_u32 v248, s66, v240
    s_add_u32 s64, s88, 12288
    buffer_load_dwordx4 v[100:103], v241, s[16:19], s64 offen offset:0 sc1
    s_waitcnt vmcnt(19)
    v_mfma_f32_32x32x16_bf16 v[36:51], v[108:111], a[40:43], v[36:51]
    ds_read_b32 v232, v248
    s_mul_i32 s39, s26, 1152
    s_lshl_b32 s66, s25, 5
    s_add_u32 s39, s39, s66
    s_lshl_b32 s49, s25, 16
    s_lshl_b32 s66, s26, 5
    s_add_u32 s49, s49, s66
    s_add_u32 s49, s49, 7077888
    v_mfma_f32_32x32x16_bf16 v[52:67], v[108:111], a[44:47], v[52:67]
    v_and_b32 v247, 15, v0
    v_lshlrev_b32 v247, 3, v247
    buffer_load_dwordx4 v[104:107], v242, s[16:19], s64 offen offset:0 sc1
    s_waitcnt vmcnt(19)
    v_mfma_f32_32x32x16_bf16 v[36:51], v[112:115], a[48:51], v[36:51]
    v_mfma_f32_32x32x16_bf16 v[52:67], v[112:115], a[52:55], v[52:67]
    s_cmp_ge_u32 s23, 1
    s_cbranch_scc1 OK_84
    s_mov_b32 s3, 0
SP_83:
    s_waitcnt lgkmcnt(0)
    s_cmp_ge_u32 s4, 54
    s_cbranch_scc1 OK_84
    s_add_u32 s3, s3, 1
    s_cmp_gt_u32 s3, 200000
    s_cbranch_scc1 OK_84
    s_sleep 8
    s_load_dword s4, s[28:29], s7 glc
    s_branch SP_83
OK_84:
    s_waitcnt lgkmcnt(0)
    s_barrier
    buffer_load_dwordx4 v[108:111], v241, s[16:19], s64 offen offset:1024 sc1
    s_waitcnt vmcnt(19)
    v_mfma_f32_32x32x16_bf16 v[36:51], v[116:119], a[56:59], v[36:51]
    ds_read_b128 v[84:87], v213 offset:57344
    s_lshr_b32 s65, s23, 1
    s_sub_u32 s65, s65, s23
    s_lshl_b32 s65, s65, 7
    v_add_u32 v211, s65, v246
    v_mfma_f32_32x32x16_bf16 v[52:67], v[116:119], a[60:63], v[52:67]
    ds_read_b128 v[88:91], v213 offset:58368
    ds_read_b128 v[184:187], v211 offset:2048
    ds_read_b128 v[188:191], v211 offset:2080
    buffer_load_dwordx4 v[112:115], v242, s[16:19], s64 offen offset:1024 sc1
    s_waitcnt vmcnt(19)
    v_mfma_f32_32x32x16_bf16 v[36:51], v[120:123], a[64:67], v[36:51]
    s_cmp_lg_u32 s23, 1
    s_cbranch_scc1 P3_nz
    s_atomic_add s54, s[28:29], s27
P3_nz:
    ds_read_b128 v[92:95], v213 offset:59392
    v_mfma_f32_32x32x16_bf16 v[52:67], v[120:123], a[68:71], v[52:67]
    ds_read_b128 v[96:99], v213 offset:60416
    ds_read_b128 v[192:195], v211 offset:2112
    ds_read_b128 v[196:199], v211 offset:2144
    buffer_load_dwordx4 v[116:119], v241, s[16:19], s64 offen offset:2048 sc1
    s_waitcnt vmcnt(19)
    v_mfma_f32_32x32x16_bf16 v[36:51], v[124:127], a[72:75], v[36:51]
    v_mfma_f32_32x32x16_bf16 v[52:67], v[124:127], a[76:79], v[52:67]
    buffer_load_dwordx4 v[120:123], v242, s[16:19], s64 offen offset:2048 sc1
    s_waitcnt vmcnt(19)
    v_mfma_f32_32x32x16_bf16 v[36:51], v[128:131], a[80:83], v[36:51]
    s_mul_i32 s66, s20, 2304
    s_lshr_b32 s6, s23, 1
    s_lshl_b32 s6, s6, 8
    s_add_u32 m0, s6, 74240
    s_add_u32 s66, s66, s6
    s_add_u32 s66, s66, 28475904
    buffer_load_dword v249, s[16:19], s66 offen sc1 lds
    s_waitcnt lgkmcnt(0)
    v_mfma_f32_32x32x16_bf16 v[52:67], v[128:131], a[84:87], v[52:67]
    v_add_f32 v68, v68, v84
    v_add_f32 v69, v69, v85
    v_add_f32 v70, v70, v86
    buffer_load_dwordx4 v[124:127], v241, s[16:19], s64 offen offset:3072 sc1
    s_waitcnt vmcnt(20)
    v_mfma_f32_32x32x16_bf16 v[36:51], v[132:135], a[88:91], v[36:51]
    s_mul_i32 s66, s20, 2304
    s_lshr_b32 s6, s23, 1
    s_lshl_b32 s6, s6, 8
    s_add_u32 m0, s6, 74752
    s_add_u32 s66, s66, s6
    s_add_u32 s66, s66, 28476416
    buffer_load_dword v249, s[16:19], s66 offen sc1 lds
    v_mfma_f32_32x32x16_bf16 v[52:67], v[132:135], a[92:95], v[52:67]
    v_add_f32 v71, v71, v87
    v_add_f32 v72, v72, v88
    v_add_f32 v73, v73, v89
    buffer_load_dwordx4 v[128:131], v242, s[16:19], s64 offen offset:3072 sc1
    s_waitcnt vmcnt(21)
    v_mfma_f32_32x32x16_bf16 v[36:51], v[136:139], a[96:99], v[36:51]
    s_mul_i32 s66, s20, 2304
    s_lshr_b32 s6, s23, 1
    s_lshl_b32 s6, s6, 8
    s_add_u32 m0, s6, 75264
    s_add_u32 s66, s66, s6
    s_add_u32 s66, s66, 28476928
    buffer_load_dword v249, s[16:19], s66 offen sc1 lds
    v_mfma_f32_32x32x16_bf16 v[52:67], v[136:139], a[100:103], v[52:67]
    v_add_f32 v74, v74, v90
    v_add_f32 v75, v75, v91
    v_add_f32 v76, v76, v92
    s_add_u32 s64, s88, 16384
    buffer_load_dwordx4 v[132:135], v241, s[16:19], s64 offen offset:0 sc1
    s_waitcnt vmcnt(22)
    v_mfma_f32_32x32x16_bf16 v[36:51], v[140:143], a[104:107], v[36:51]
    v_add_f32 v77, v77, v93
    v_add_f32 v78, v78, v94
    v_add_f32 v79, v79, v95
    v_add_f32 v80, v80, v96
    v_add_f32 v81, v81, v97
    v_add_f32 v82, v82, v98
    v_mfma_f32_32x32x16_bf16 v[52:67], v[140:143], a[108:111], v[52:67]
    v_add_f32 v83, v83, v99
    v_fmac_f32 v68, v184, v234
    v_fmac_f32 v69, v185, v234
    buffer_load_dwordx4 v[136:139], v242, s[16:19], s64 offen offset:0 sc1
    s_waitcnt vmcnt(22)
    v_mfma_f32_32x32x16_bf16 v[36:51], v[144:147], a[112:115], v[36:51]
    v_fmac_f32 v70, v186, v234
    v_fmac_f32 v71, v187, v234
    v_fmac_f32 v72, v188, v234
    v_fmac_f32 v73, v189, v234
    v_fmac_f32 v74, v190, v234
    v_mfma_f32_32x32x16_bf16 v[52:67], v[144:147], a[116:119], v[52:67]
    v_fmac_f32 v75, v191, v234
    v_fmac_f32 v76, v192, v234
    v_fmac_f32 v77, v193, v234
    buffer_load_dwordx4 v[140:143], v241, s[16:19], s64 offen offset:1024 sc1
    s_waitcnt vmcnt(22)
    v_mfma_f32_32x32x16_bf16 v[36:51], v[148:151], a[120:123], v[36:51]
    v_fmac_f32 v78, v194, v234
    v_fmac_f32 v79, v195, v234
    v_fmac_f32 v80, v196, v234
    v_fmac_f32 v81, v197, v234
    v_fmac_f32 v82, v198, v234
    v_mfma_f32_32x32x16_bf16 v[52:67], v[148:151], a[124:127], v[52:67]
    v_fmac_f32 v83, v199, v234
    ds_read_b128 v[184:187], v246 offset:0
    ds_read_b128 v[188:191], v246 offset:32
    buffer_load_dwordx4 v[144:147], v242, s[16:19], s64 offen offset:1024 sc1
    s_waitcnt vmcnt(22)
    v_mfma_f32_32x32x16_bf16 v[36:51], v[152:155], a[128:131], v[36:51]
    ds_read_b128 v[192:195], v246 offset:64
    ds_read_b128 v[196:199], v246 offset:96
    s_lshr_b32 s65, s23, 1
    s_sub_u32 s65, s65, s23
    s_lshl_b32 s65, s65, 12
    v_mfma_f32_32x32x16_bf16 v[52:67], v[152:155], a[132:135], v[52:67]
    v_add_u32 v84, s65, v244
    v_mul_f32 v200, v68, v68
    s_add_u32 s64, s88, 147456
    buffer_load_dwordx4 v[148:151], v241, s[16:19], s64 offen offset:0 sc1
    s_waitcnt vmcnt(22)
    v_mfma_f32_32x32x16_bf16 v[36:51], v[156:159], a[136:139], v[36:51]
    v_mul_f32 v201, v69, v69
    v_mul_f32 v202, v70, v70
    v_mul_f32 v203, v71, v71
    v_fma_f32 v200, v200, v236, v235
    v_fma_f32 v201, v201, v236, v235
    v_fma_f32 v202, v202, v236, v235
    v_mfma_f32_32x32x16_bf16 v[52:67], v[156:159], a[140:143], v[52:67]
    v_fma_f32 v203, v203, v236, v235
    v_mul_f32 v200, v200, v68
    v_mul_f32 v201, v201, v69
    buffer_load_dwordx4 v[152:155], v242, s[16:19], s64 offen offset:0 sc1
    s_waitcnt vmcnt(21)
    v_mfma_f32_32x32x16_bf16 v[36:51], v[160:163], a[144:147], v[36:51]
    v_mul_f32 v202, v202, v70
    v_mul_f32 v203, v203, v71
    v_exp_f32 v200, v200
    v_exp_f32 v201, v201
    v_mfma_f32_32x32x16_bf16 v[52:67], v[160:163], a[148:151], v[52:67]
    v_exp_f32 v202, v202
    buffer_load_dwordx4 v[156:159], v241, s[16:19], s64 offen offset:1024 sc1
    v_mfma_f32_32x32x16_bf16 v[36:51], v[164:167], a[152:155], v[36:51]
    v_exp_f32 v203, v203
    v_add_f32 v200, 1.0, v200
    v_add_f32 v201, 1.0, v201
    v_add_f32 v202, 1.0, v202
    v_mfma_f32_32x32x16_bf16 v[52:67], v[164:167], a[156:159], v[52:67]
    v_add_f32 v203, 1.0, v203
    v_rcp_f32 v200, v200
    buffer_load_dwordx4 v[160:163], v242, s[16:19], s64 offen offset:1024 sc1
    s_waitcnt vmcnt(21)
    v_mfma_f32_32x32x16_bf16 v[36:51], v[168:171], a[160:163], v[36:51]
    v_rcp_f32 v201, v201
    v_rcp_f32 v202, v202
    v_rcp_f32 v203, v203
    v_mfma_f32_32x32x16_bf16 v[52:67], v[168:171], a[164:167], v[52:67]
    v_mul_f32 v68, v68, v200
    v_mul_f32 v69, v69, v201
    v_mul_f32 v70, v70, v202
    buffer_load_dwordx4 v[164:167], v241, s[16:19], s64 offen offset:2048 sc1
    v_mfma_f32_32x32x16_bf16 v[36:51], v[172:175], a[168:171], v[36:51]
    v_mul_f32 v71, v71, v203
    v_cvt_pk_bf16_f32 v208, v68, v69
    v_cvt_pk_bf16_f32 v209, v70, v71
    v_mul_f32 v204, v76, v76
    v_mul_f32 v205, v77, v77
    v_mfma_f32_32x32x16_bf16 v[52:67], v[172:175], a[172:175], v[52:67]
    v_mul_f32 v206, v78, v78
    v_mul_f32 v207, v79, v79
    v_fma_f32 v204, v204, v236, v235
    buffer_load_dwordx4 v[168:171], v242, s[16:19], s64 offen offset:2048 sc1
    s_waitcnt vmcnt(21)
    v_mfma_f32_32x32x16_bf16 v[36:51], v[176:179], a[176:179], v[36:51]
    v_fma_f32 v205, v205, v236, v235
    v_fma_f32 v206, v206, v236, v235
    v_fma_f32 v207, v207, v236, v235
    v_mul_f32 v204, v204, v76
    v_mul_f32 v205, v205, v77
    v_mfma_f32_32x32x16_bf16 v[52:67], v[176:179], a[180:183], v[52:67]
    v_mul_f32 v206, v206, v78
    v_mul_f32 v207, v207, v79
    v_exp_f32 v204, v204
    buffer_load_dwordx4 v[172:175], v241, s[16:19], s64 offen offset:3072 sc1
    v_mfma_f32_32x32x16_bf16 v[36:51], v[180:183], a[184:187], v[36:51]
    v_exp_f32 v205, v205
    v_exp_f32 v206, v206
    v_mfma_f32_32x32x16_bf16 v[52:67], v[180:183], a[188:191], v[52:67]
    v_exp_f32 v207, v207
    v_add_f32 v204, 1.0, v204
    v_add_f32 v205, 1.0, v205
    buffer_load_dwordx4 v[176:179], v242, s[16:19], s64 offen offset:3072 sc1
    s_waitcnt vmcnt(21)
    v_mfma_f32_32x32x16_bf16 v[36:51], v[100:103], a[192:195], v[36:51]
    v_add_f32 v206, 1.0, v206
    v_add_f32 v207, 1.0, v207
    v_rcp_f32 v204, v204
    v_rcp_f32 v205, v205
    v_mfma_f32_32x32x16_bf16 v[52:67], v[100:103], a[196:199], v[52:67]
    v_rcp_f32 v206, v206
    s_add_u32 s64, s88, 151552
    buffer_load_dwordx4 v[180:183], v241, s[16:19], s64 offen offset:0 sc1
    v_mfma_f32_32x32x16_bf16 v[36:51], v[104:107], a[200:203], v[36:51]
    v_rcp_f32 v207, v207
    v_mul_f32 v76, v76, v204
    v_mul_f32 v77, v77, v205
    v_mul_f32 v78, v78, v206
    v_mul_f32 v79, v79, v207
    v_mfma_f32_32x32x16_bf16 v[52:67], v[104:107], a[204:207], v[52:67]
    v_cvt_pk_bf16_f32 v210, v76, v77
    v_cvt_pk_bf16_f32 v211, v78, v79
    buffer_load_dwordx4 v[100:103], v242, s[16:19], s64 offen offset:0 sc1
    s_waitcnt vmcnt(21)
    v_mfma_f32_32x32x16_bf16 v[36:51], v[108:111], a[208:211], v[36:51]
    ds_write_b128 v84, v[208:211] offset:0
    v_mul_f32 v200, v72, v72
    v_mul_f32 v201, v73, v73
    v_mfma_f32_32x32x16_bf16 v[52:67], v[108:111], a[212:215], v[52:67]
    v_mul_f32 v202, v74, v74
    v_mul_f32 v203, v75, v75
    v_fma_f32 v200, v200, v236, v235
    buffer_load_dwordx4 v[104:107], v241, s[16:19], s64 offen offset:1024 sc1
    v_mfma_f32_32x32x16_bf16 v[36:51], v[112:115], a[216:219], v[36:51]
    v_fma_f32 v201, v201, v236, v235
    v_fma_f32 v202, v202, v236, v235
    v_fma_f32 v203, v203, v236, v235
    v_mul_f32 v200, v200, v72
    v_mul_f32 v201, v201, v73
    v_mfma_f32_32x32x16_bf16 v[52:67], v[112:115], a[220:223], v[52:67]
    v_mul_f32 v202, v202, v74
    v_mul_f32 v203, v203, v75
    v_exp_f32 v200, v200
    buffer_load_dwordx4 v[108:111], v242, s[16:19], s64 offen offset:1024 sc1
    s_waitcnt vmcnt(21)
    v_mfma_f32_32x32x16_bf16 v[36:51], v[116:119], a[224:227], v[36:51]
    v_exp_f32 v201, v201
    v_exp_f32 v202, v202
    v_mfma_f32_32x32x16_bf16 v[52:67], v[116:119], a[228:231], v[52:67]
    v_exp_f32 v203, v203
    v_add_f32 v200, 1.0, v200
    v_add_f32 v201, 1.0, v201
    buffer_load_dwordx4 v[112:115], v241, s[16:19], s64 offen offset:2048 sc1
    v_mfma_f32_32x32x16_bf16 v[36:51], v[120:123], a[232:235], v[36:51]
    v_add_f32 v202, 1.0, v202
    v_add_f32 v203, 1.0, v203
    v_rcp_f32 v200, v200
    v_mfma_f32_32x32x16_bf16 v[52:67], v[120:123], a[236:239], v[52:67]
    v_rcp_f32 v201, v201
    v_rcp_f32 v202, v202
    buffer_load_dwordx4 v[116:119], v242, s[16:19], s64 offen offset:2048 sc1
    s_waitcnt vmcnt(19)
    v_mfma_f32_32x32x16_bf16 v[36:51], v[124:127], a[240:243], v[36:51]
    v_rcp_f32 v203, v203
    v_mul_f32 v72, v72, v200
    v_mul_f32 v73, v73, v201
    v_mul_f32 v74, v74, v202
    v_mfma_f32_32x32x16_bf16 v[52:67], v[124:127], a[244:247], v[52:67]
    v_mul_f32 v75, v75, v203
    v_cvt_pk_bf16_f32 v212, v72, v73
    v_cvt_pk_bf16_f32 v213, v74, v75
    buffer_load_dwordx4 v[120:123], v241, s[16:19], s64 offen offset:3072 sc1
    v_mfma_f32_32x32x16_bf16 v[36:51], v[128:131], a[248:251], v[36:51]
    v_mul_f32 v204, v80, v80
    v_mul_f32 v205, v81, v81
    v_mul_f32 v206, v82, v82
    v_mul_f32 v207, v83, v83
    v_fma_f32 v204, v204, v236, v235
    v_fma_f32 v205, v205, v236, v235
    v_mfma_f32_32x32x16_bf16 v[52:67], v[128:131], a[252:255], v[52:67]
    v_fma_f32 v206, v206, v236, v235
    v_fma_f32 v207, v207, v236, v235
    v_mul_f32 v204, v204, v80
    buffer_load_dwordx4 v[124:127], v242, s[16:19], s64 offen offset:3072 sc1
    s_waitcnt vmcnt(18)
    v_mfma_f32_32x32x16_bf16 v[36:51], v[132:135], v[4:7], v[36:51]
    v_mul_f32 v205, v205, v81
    v_mul_f32 v206, v206, v82
    v_mul_f32 v207, v207, v83
    v_exp_f32 v204, v204
    v_mfma_f32_32x32x16_bf16 v[52:67], v[132:135], v[8:11], v[52:67]
    v_exp_f32 v205, v205
    s_add_u32 s64, s88, 155648
    buffer_load_dwordx4 v[128:131], v241, s[16:19], s64 offen offset:0 sc1
    v_mfma_f32_32x32x16_bf16 v[36:51], v[136:139], v[12:15], v[36:51]
    v_exp_f32 v206, v206
    v_exp_f32 v207, v207
    v_add_f32 v204, 1.0, v204
    v_add_f32 v205, 1.0, v205
    v_mfma_f32_32x32x16_bf16 v[52:67], v[136:139], v[16:19], v[52:67]
    v_add_f32 v206, 1.0, v206
    v_add_f32 v207, 1.0, v207
    v_rcp_f32 v204, v204
    buffer_load_dwordx4 v[132:135], v242, s[16:19], s64 offen offset:0 sc1
    s_waitcnt vmcnt(18)
    v_mfma_f32_32x32x16_bf16 v[36:51], v[140:143], v[20:23], v[36:51]
    v_rcp_f32 v205, v205
    v_rcp_f32 v206, v206
    v_mfma_f32_32x32x16_bf16 v[52:67], v[140:143], v[24:27], v[52:67]
    v_rcp_f32 v207, v207
    v_mul_f32 v80, v80, v204
    v_mul_f32 v81, v81, v205
    buffer_load_dwordx4 v[136:139], v241, s[16:19], s64 offen offset:1024 sc1
    v_mfma_f32_32x32x16_bf16 v[36:51], v[144:147], v[28:31], v[36:51]
    v_mul_f32 v82, v82, v206
    v_mul_f32 v83, v83, v207
    v_cvt_pk_bf16_f32 v214, v80, v81
    v_cvt_pk_bf16_f32 v215, v82, v83
    v_mfma_f32_32x32x16_bf16 v[52:67], v[144:147], v[32:35], v[52:67]
    ds_write_b128 v84, v[212:215] offset:512
    buffer_load_dwordx4 v[140:143], v242, s[16:19], s64 offen offset:1024 sc1
    s_waitcnt vmcnt(18)
    v_mfma_f32_32x32x16_bf16 v[68:83], v[148:151], a[0:3], 0
    v_mfma_f32_32x32x16_bf16 v[84:99], v[148:151], a[4:7], 0
    buffer_load_dwordx4 v[144:147], v241, s[16:19], s64 offen offset:2048 sc1
    v_mfma_f32_32x32x16_bf16 v[68:83], v[152:155], a[8:11], v[68:83]
    v_mfma_f32_32x32x16_bf16 v[84:99], v[152:155], a[12:15], v[84:99]
    s_waitcnt lgkmcnt(2)
    v_fmac_f32 v36, v184, v234
    v_fmac_f32 v37, v185, v234
    v_fmac_f32 v38, v186, v234
    buffer_load_dwordx4 v[148:151], v242, s[16:19], s64 offen offset:2048 sc1
    s_waitcnt vmcnt(18)
    v_mfma_f32_32x32x16_bf16 v[68:83], v[156:159], a[16:19], v[68:83]
    v_fmac_f32 v39, v187, v234
    v_fmac_f32 v40, v188, v234
    v_fmac_f32 v41, v189, v234
    v_fmac_f32 v42, v190, v234
    v_fmac_f32 v43, v191, v234
    v_fmac_f32 v44, v192, v234
    v_fmac_f32 v45, v193, v234
    v_mfma_f32_32x32x16_bf16 v[84:99], v[156:159], a[20:23], v[84:99]
    v_fmac_f32 v46, v194, v234
    v_fmac_f32 v47, v195, v234
    v_fmac_f32 v48, v196, v234
    v_fmac_f32 v49, v197, v234
    buffer_load_dwordx4 v[152:155], v241, s[16:19], s64 offen offset:3072 sc1
    v_mfma_f32_32x32x16_bf16 v[68:83], v[160:163], a[24:27], v[68:83]
    v_fmac_f32 v50, v198, v234
    v_fmac_f32 v51, v199, v234
    v_fmac_f32 v52, v184, v237
    v_fmac_f32 v53, v185, v237
    v_fmac_f32 v54, v186, v237
    v_fmac_f32 v55, v187, v237
    v_mfma_f32_32x32x16_bf16 v[84:99], v[160:163], a[28:31], v[84:99]
    v_fmac_f32 v56, v188, v237
    v_fmac_f32 v57, v189, v237
    v_fmac_f32 v58, v190, v237
    v_fmac_f32 v59, v191, v237
    buffer_load_dwordx4 v[156:159], v242, s[16:19], s64 offen offset:3072 sc1
    s_waitcnt vmcnt(18)
    v_mfma_f32_32x32x16_bf16 v[68:83], v[164:167], a[32:35], v[68:83]
    v_fmac_f32 v60, v192, v237
    v_fmac_f32 v61, v193, v237
    v_fmac_f32 v62, v194, v237
    v_fmac_f32 v63, v195, v237
    v_fmac_f32 v64, v196, v237
    v_fmac_f32 v65, v197, v237
    v_fmac_f32 v66, v198, v237
    v_mfma_f32_32x32x16_bf16 v[84:99], v[164:167], a[36:39], v[84:99]
    v_fmac_f32 v67, v199, v237
    ds_read_b128 v[184:187], v246 offset:512
    ds_read_b128 v[188:191], v246 offset:544
    s_add_u32 s64, s88, 159744
    buffer_load_dwordx4 v[160:163], v241, s[16:19], s64 offen offset:0 sc1
    v_mfma_f32_32x32x16_bf16 v[68:83], v[168:171], a[40:43], v[68:83]
    ds_read_b128 v[192:195], v246 offset:576
    ds_read_b128 v[196:199], v246 offset:608
    v_mul_f32 v200, v36, v36
    v_mul_f32 v201, v37, v37
    v_mul_f32 v202, v38, v38
    v_mul_f32 v203, v39, v39
    v_mfma_f32_32x32x16_bf16 v[84:99], v[168:171], a[44:47], v[84:99]
    v_fma_f32 v200, v200, v236, v235
    v_fma_f32 v201, v201, v236, v235
    v_fma_f32 v202, v202, v236, v235
    v_fma_f32 v203, v203, v236, v235
    buffer_load_dwordx4 v[164:167], v242, s[16:19], s64 offen offset:0 sc1
    s_waitcnt vmcnt(18)
    v_mfma_f32_32x32x16_bf16 v[68:83], v[172:175], a[48:51], v[68:83]
    v_mul_f32 v200, v200, v36
    v_mul_f32 v201, v201, v37
    v_mul_f32 v202, v202, v38
    v_mul_f32 v203, v203, v39
    v_exp_f32 v200, v200
    v_mfma_f32_32x32x16_bf16 v[84:99], v[172:175], a[52:55], v[84:99]
    v_exp_f32 v201, v201
    v_exp_f32 v202, v202
    buffer_load_dwordx4 v[168:171], v241, s[16:19], s64 offen offset:1024 sc1
    v_mfma_f32_32x32x16_bf16 v[68:83], v[176:179], a[56:59], v[68:83]
    v_exp_f32 v203, v203
    v_add_f32 v200, 1.0, v200
    v_add_f32 v201, 1.0, v201
    v_add_f32 v202, 1.0, v202
    v_add_f32 v203, 1.0, v203
    v_mfma_f32_32x32x16_bf16 v[84:99], v[176:179], a[60:63], v[84:99]
    v_rcp_f32 v200, v200
    v_rcp_f32 v201, v201
    buffer_load_dwordx4 v[172:175], v242, s[16:19], s64 offen offset:1024 sc1
    s_waitcnt vmcnt(18)
    v_mfma_f32_32x32x16_bf16 v[68:83], v[180:183], a[64:67], v[68:83]
    v_rcp_f32 v202, v202
    v_rcp_f32 v203, v203
    v_mul_f32 v36, v36, v200
    v_mul_f32 v37, v37, v201
    v_mul_f32 v38, v38, v202
    v_mfma_f32_32x32x16_bf16 v[84:99], v[180:183], a[68:71], v[84:99]
    v_mul_f32 v39, v39, v203
    v_cvt_pk_bf16_f32 v208, v36, v37
    v_cvt_pk_bf16_f32 v209, v38, v39
    v_mul_f32 v204, v44, v44
    buffer_load_dwordx4 v[176:179], v241, s[16:19], s64 offen offset:2048 sc1
    v_mfma_f32_32x32x16_bf16 v[68:83], v[100:103], a[72:75], v[68:83]
    v_mul_f32 v205, v45, v45
    v_mul_f32 v206, v46, v46
    v_mul_f32 v207, v47, v47
    v_fma_f32 v204, v204, v236, v235
    v_fma_f32 v205, v205, v236, v235
    v_fma_f32 v206, v206, v236, v235
    v_fma_f32 v207, v207, v236, v235
    v_mfma_f32_32x32x16_bf16 v[84:99], v[100:103], a[76:79], v[84:99]
    v_mul_f32 v204, v204, v44
    v_mul_f32 v205, v205, v45
    v_mul_f32 v206, v206, v46
    buffer_load_dwordx4 v[180:183], v242, s[16:19], s64 offen offset:2048 sc1
    s_waitcnt vmcnt(18)
    v_mfma_f32_32x32x16_bf16 v[68:83], v[104:107], a[80:83], v[68:83]
    v_mul_f32 v207, v207, v47
    v_exp_f32 v204, v204
    v_exp_f32 v205, v205
    v_exp_f32 v206, v206
    v_mfma_f32_32x32x16_bf16 v[84:99], v[104:107], a[84:87], v[84:99]
    v_exp_f32 v207, v207
    v_add_f32 v204, 1.0, v204
    v_add_f32 v205, 1.0, v205
    buffer_load_dwordx4 v[100:103], v241, s[16:19], s64 offen offset:3072 sc1
    v_mfma_f32_32x32x16_bf16 v[68:83], v[108:111], a[88:91], v[68:83]
    v_add_f32 v206, 1.0, v206
    v_add_f32 v207, 1.0, v207
    v_rcp_f32 v204, v204
    v_rcp_f32 v205, v205
    v_mfma_f32_32x32x16_bf16 v[84:99], v[108:111], a[92:95], v[84:99]
    v_rcp_f32 v206, v206
    v_rcp_f32 v207, v207
    buffer_load_dwordx4 v[104:107], v242, s[16:19], s64 offen offset:3072 sc1
    s_waitcnt vmcnt(18)
    v_mfma_f32_32x32x16_bf16 v[68:83], v[112:115], a[96:99], v[68:83]
    v_mul_f32 v44, v44, v204
    v_mul_f32 v45, v45, v205
    v_mul_f32 v46, v46, v206
    v_mul_f32 v47, v47, v207
    v_cvt_pk_bf16_f32 v210, v44, v45
    v_cvt_pk_bf16_f32 v211, v46, v47
    v_mfma_f32_32x32x16_bf16 v[84:99], v[112:115], a[100:103], v[84:99]
    ds_write_b128 v244, v[208:211] offset:8192
    v_mul_f32 v200, v40, v40
    s_add_u32 s64, s88, 163840
    buffer_load_dwordx4 v[108:111], v241, s[16:19], s64 offen offset:0 sc1
    v_mfma_f32_32x32x16_bf16 v[68:83], v[116:119], a[104:107], v[68:83]
    v_mul_f32 v201, v41, v41
    v_mul_f32 v202, v42, v42
    v_mul_f32 v203, v43, v43
    v_fma_f32 v200, v200, v236, v235
    v_fma_f32 v201, v201, v236, v235
    v_fma_f32 v202, v202, v236, v235
    v_mfma_f32_32x32x16_bf16 v[84:99], v[116:119], a[108:111], v[84:99]
    v_fma_f32 v203, v203, v236, v235
    v_mul_f32 v200, v200, v40
    v_mul_f32 v201, v201, v41
    v_mul_f32 v202, v202, v42
    buffer_load_dwordx4 v[112:115], v242, s[16:19], s64 offen offset:0 sc1
    s_waitcnt vmcnt(18)
    v_mfma_f32_32x32x16_bf16 v[68:83], v[120:123], a[112:115], v[68:83]
    v_mul_f32 v203, v203, v43
    v_exp_f32 v200, v200
    v_exp_f32 v201, v201
    v_exp_f32 v202, v202
    v_mfma_f32_32x32x16_bf16 v[84:99], v[120:123], a[116:119], v[84:99]
    v_exp_f32 v203, v203
    v_add_f32 v200, 1.0, v200
    buffer_load_dwordx4 v[116:119], v241, s[16:19], s64 offen offset:1024 sc1
    v_mfma_f32_32x32x16_bf16 v[68:83], v[124:127], a[120:123], v[68:83]
    v_add_f32 v201, 1.0, v201
    v_add_f32 v202, 1.0, v202
    v_add_f32 v203, 1.0, v203
    v_rcp_f32 v200, v200
    v_rcp_f32 v201, v201
    v_mfma_f32_32x32x16_bf16 v[84:99], v[124:127], a[124:127], v[84:99]
    v_rcp_f32 v202, v202
    v_rcp_f32 v203, v203
    buffer_load_dwordx4 v[120:123], v242, s[16:19], s64 offen offset:1024 sc1
    s_waitcnt vmcnt(18)
    v_mfma_f32_32x32x16_bf16 v[68:83], v[128:131], a[128:131], v[68:83]
    v_mul_f32 v40, v40, v200
    v_mul_f32 v41, v41, v201
    v_mul_f32 v42, v42, v202
    v_mul_f32 v43, v43, v203
    v_cvt_pk_bf16_f32 v212, v40, v41
    v_cvt_pk_bf16_f32 v213, v42, v43
    v_mfma_f32_32x32x16_bf16 v[84:99], v[128:131], a[132:135], v[84:99]
    v_mul_f32 v204, v48, v48
    v_mul_f32 v205, v49, v49
    v_mul_f32 v206, v50, v50
    v_mul_f32 v207, v51, v51
    s_add_u32 s64, s88, 294912
    buffer_load_dwordx4 v[124:127], v241, s[16:19], s64 offen offset:0 sc1
    v_mfma_f32_32x32x16_bf16 v[68:83], v[132:135], a[136:139], v[68:83]
    v_fma_f32 v204, v204, v236, v235
    v_fma_f32 v205, v205, v236, v235
    v_fma_f32 v206, v206, v236, v235
    v_fma_f32 v207, v207, v236, v235
    v_mul_f32 v204, v204, v48
    v_mul_f32 v205, v205, v49
    v_mul_f32 v206, v206, v50
    v_mfma_f32_32x32x16_bf16 v[84:99], v[132:135], a[140:143], v[84:99]
    v_mul_f32 v207, v207, v51
    v_exp_f32 v204, v204
    buffer_load_dwordx4 v[128:131], v242, s[16:19], s64 offen offset:0 sc1
    s_waitcnt vmcnt(18)
    v_mfma_f32_32x32x16_bf16 v[68:83], v[136:139], a[144:147], v[68:83]
    v_exp_f32 v205, v205
    v_exp_f32 v206, v206
    v_exp_f32 v207, v207
    v_add_f32 v204, 1.0, v204
    v_mfma_f32_32x32x16_bf16 v[84:99], v[136:139], a[148:151], v[84:99]
    v_add_f32 v205, 1.0, v205
    v_add_f32 v206, 1.0, v206
    v_add_f32 v207, 1.0, v207
    buffer_load_dwordx4 v[132:135], v241, s[16:19], s64 offen offset:1024 sc1
    v_mfma_f32_32x32x16_bf16 v[68:83], v[140:143], a[152:155], v[68:83]
    v_rcp_f32 v204, v204
    v_rcp_f32 v205, v205
    v_rcp_f32 v206, v206
    v_rcp_f32 v207, v207
    v_mfma_f32_32x32x16_bf16 v[84:99], v[140:143], a[156:159], v[84:99]
    v_mul_f32 v48, v48, v204
    v_mul_f32 v49, v49, v205
    v_mul_f32 v50, v50, v206
    buffer_load_dwordx4 v[136:139], v242, s[16:19], s64 offen offset:1024 sc1
    s_waitcnt vmcnt(18)
    v_mfma_f32_32x32x16_bf16 v[68:83], v[144:147], a[160:163], v[68:83]
    v_mul_f32 v51, v51, v207
    v_cvt_pk_bf16_f32 v214, v48, v49
    v_cvt_pk_bf16_f32 v215, v50, v51
    ds_write_b128 v244, v[212:215] offset:8704
    v_mfma_f32_32x32x16_bf16 v[84:99], v[144:147], a[164:167], v[84:99]
    v_mul_f32 v200, v52, v52
    v_mul_f32 v201, v53, v53
    v_mul_f32 v202, v54, v54
    v_mul_f32 v203, v55, v55
    buffer_load_dwordx4 v[140:143], v241, s[16:19], s64 offen offset:2048 sc1
    v_mfma_f32_32x32x16_bf16 v[68:83], v[148:151], a[168:171], v[68:83]
    v_fma_f32 v200, v200, v239, v238
    v_fma_f32 v201, v201, v239, v238
    v_fma_f32 v202, v202, v239, v238
    v_fma_f32 v203, v203, v239, v238
    v_mul_f32 v200, v200, v52
    v_mul_f32 v201, v201, v53
    v_mfma_f32_32x32x16_bf16 v[84:99], v[148:151], a[172:175], v[84:99]
    v_mul_f32 v202, v202, v54
    v_mul_f32 v203, v203, v55
    v_exp_f32 v200, v200
    buffer_load_dwordx4 v[144:147], v242, s[16:19], s64 offen offset:2048 sc1
    s_waitcnt vmcnt(18)
    v_mfma_f32_32x32x16_bf16 v[68:83], v[152:155], a[176:179], v[68:83]
    v_exp_f32 v201, v201
    v_exp_f32 v202, v202
    v_exp_f32 v203, v203
    v_add_f32 v200, 1.0, v200
    v_mfma_f32_32x32x16_bf16 v[84:99], v[152:155], a[180:183], v[84:99]
    v_add_f32 v201, 1.0, v201
    v_add_f32 v202, 1.0, v202
    v_add_f32 v203, 1.0, v203
    buffer_load_dwordx4 v[148:151], v241, s[16:19], s64 offen offset:3072 sc1
    v_mfma_f32_32x32x16_bf16 v[68:83], v[156:159], a[184:187], v[68:83]
    v_rcp_f32 v200, v200
    v_rcp_f32 v201, v201
    v_rcp_f32 v202, v202
    v_rcp_f32 v203, v203
    v_mfma_f32_32x32x16_bf16 v[84:99], v[156:159], a[188:191], v[84:99]
    v_mul_f32 v52, v52, v200
    v_mul_f32 v53, v53, v201
    v_mul_f32 v54, v54, v202
    buffer_load_dwordx4 v[152:155], v242, s[16:19], s64 offen offset:3072 sc1
    s_waitcnt vmcnt(18)
    v_mfma_f32_32x32x16_bf16 v[68:83], v[160:163], a[192:195], v[68:83]
    v_mul_f32 v55, v55, v203
    v_cvt_pk_bf16_f32 v208, v52, v53
    v_cvt_pk_bf16_f32 v209, v54, v55
    v_mul_f32 v204, v60, v60
    v_mul_f32 v205, v61, v61
    v_mul_f32 v206, v62, v62
    v_mul_f32 v207, v63, v63
    v_mfma_f32_32x32x16_bf16 v[84:99], v[160:163], a[196:199], v[84:99]
    v_fma_f32 v204, v204, v239, v238
    v_fma_f32 v205, v205, v239, v238
    v_fma_f32 v206, v206, v239, v238
    s_add_u32 s64, s88, 299008
    buffer_load_dwordx4 v[156:159], v241, s[16:19], s64 offen offset:0 sc1
    v_mfma_f32_32x32x16_bf16 v[68:83], v[164:167], a[200:203], v[68:83]
    v_fma_f32 v207, v207, v239, v238
    v_mul_f32 v204, v204, v60
    v_mul_f32 v205, v205, v61
    v_mul_f32 v206, v206, v62
    v_mul_f32 v207, v207, v63
    v_exp_f32 v204, v204
    v_mfma_f32_32x32x16_bf16 v[84:99], v[164:167], a[204:207], v[84:99]
    v_exp_f32 v205, v205
    v_exp_f32 v206, v206
    buffer_load_dwordx4 v[160:163], v242, s[16:19], s64 offen offset:0 sc1
    s_waitcnt vmcnt(18)
    v_mfma_f32_32x32x16_bf16 v[68:83], v[168:171], a[208:211], v[68:83]
    v_exp_f32 v207, v207
    v_add_f32 v204, 1.0, v204
    v_add_f32 v205, 1.0, v205
    v_add_f32 v206, 1.0, v206
    v_add_f32 v207, 1.0, v207
    v_mfma_f32_32x32x16_bf16 v[84:99], v[168:171], a[212:215], v[84:99]
    v_rcp_f32 v204, v204
    v_rcp_f32 v205, v205
    buffer_load_dwordx4 v[164:167], v241, s[16:19], s64 offen offset:1024 sc1
    v_mfma_f32_32x32x16_bf16 v[68:83], v[172:175], a[216:219], v[68:83]
    v_rcp_f32 v206, v206
    v_rcp_f32 v207, v207
    v_mul_f32 v60, v60, v204
    v_mul_f32 v61, v61, v205
    v_mul_f32 v62, v62, v206
    v_mfma_f32_32x32x16_bf16 v[84:99], v[172:175], a[220:223], v[84:99]
    v_mul_f32 v63, v63, v207
    v_cvt_pk_bf16_f32 v210, v60, v61
    v_cvt_pk_bf16_f32 v211, v62, v63
    buffer_load_dwordx4 v[168:171], v242, s[16:19], s64 offen offset:1024 sc1
    s_waitcnt vmcnt(18)
    v_mfma_f32_32x32x16_bf16 v[68:83], v[176:179], a[224:227], v[68:83]
    ds_write_b128 v245, v[208:211] offset:8192
    v_mul_f32 v200, v56, v56
    v_mul_f32 v201, v57, v57
    v_mul_f32 v202, v58, v58
    v_mfma_f32_32x32x16_bf16 v[84:99], v[176:179], a[228:231], v[84:99]
    v_mul_f32 v203, v59, v59
    v_fma_f32 v200, v200, v239, v238
    v_fma_f32 v201, v201, v239, v238
    v_fma_f32 v202, v202, v239, v238
    buffer_load_dwordx4 v[172:175], v241, s[16:19], s64 offen offset:2048 sc1
    v_mfma_f32_32x32x16_bf16 v[68:83], v[180:183], a[232:235], v[68:83]
    v_fma_f32 v203, v203, v239, v238
    v_mul_f32 v200, v200, v56
    v_mul_f32 v201, v201, v57
    v_mul_f32 v202, v202, v58
    v_mul_f32 v203, v203, v59
    v_exp_f32 v200, v200
    v_mfma_f32_32x32x16_bf16 v[84:99], v[180:183], a[236:239], v[84:99]
    v_exp_f32 v201, v201
    v_exp_f32 v202, v202
    buffer_load_dwordx4 v[176:179], v242, s[16:19], s64 offen offset:2048 sc1
    s_waitcnt vmcnt(18)
    v_mfma_f32_32x32x16_bf16 v[68:83], v[100:103], a[240:243], v[68:83]
    v_exp_f32 v203, v203
    v_add_f32 v200, 1.0, v200
    v_add_f32 v201, 1.0, v201
    v_add_f32 v202, 1.0, v202
    v_add_f32 v203, 1.0, v203
    v_mfma_f32_32x32x16_bf16 v[84:99], v[100:103], a[244:247], v[84:99]
    v_rcp_f32 v200, v200
    v_rcp_f32 v201, v201
    buffer_load_dwordx4 v[180:183], v241, s[16:19], s64 offen offset:3072 sc1
    v_mfma_f32_32x32x16_bf16 v[68:83], v[104:107], a[248:251], v[68:83]
    v_rcp_f32 v202, v202
    v_rcp_f32 v203, v203
    v_mul_f32 v56, v56, v200
    v_mul_f32 v57, v57, v201
    v_mul_f32 v58, v58, v202
    v_mfma_f32_32x32x16_bf16 v[84:99], v[104:107], a[252:255], v[84:99]
    v_mul_f32 v59, v59, v203
    v_cvt_pk_bf16_f32 v212, v56, v57
    v_cvt_pk_bf16_f32 v213, v58, v59
    buffer_load_dwordx4 v[100:103], v242, s[16:19], s64 offen offset:3072 sc1
    s_waitcnt vmcnt(18)
    v_mfma_f32_32x32x16_bf16 v[68:83], v[108:111], v[4:7], v[68:83]
    v_mul_f32 v204, v64, v64
    v_mul_f32 v205, v65, v65
    v_mul_f32 v206, v66, v66
    v_mul_f32 v207, v67, v67
    v_fma_f32 v204, v204, v239, v238
    v_fma_f32 v205, v205, v239, v238
    v_fma_f32 v206, v206, v239, v238
    v_mfma_f32_32x32x16_bf16 v[84:99], v[108:111], v[8:11], v[84:99]
    v_fma_f32 v207, v207, v239, v238
    v_mul_f32 v204, v204, v64
    v_mul_f32 v205, v205, v65
    v_mul_f32 v206, v206, v66
    s_add_u32 s64, s88, 303104
    buffer_load_dwordx4 v[104:107], v241, s[16:19], s64 offen offset:0 sc1
    v_mfma_f32_32x32x16_bf16 v[68:83], v[112:115], v[12:15], v[68:83]
    v_mul_f32 v207, v207, v67
    v_exp_f32 v204, v204
    v_exp_f32 v205, v205
    v_exp_f32 v206, v206
    v_mfma_f32_32x32x16_bf16 v[84:99], v[112:115], v[16:19], v[84:99]
    v_exp_f32 v207, v207
    v_add_f32 v204, 1.0, v204
    buffer_load_dwordx4 v[108:111], v242, s[16:19], s64 offen offset:0 sc1
    s_waitcnt vmcnt(18)
    v_mfma_f32_32x32x16_bf16 v[68:83], v[116:119], v[20:23], v[68:83]
    v_add_f32 v205, 1.0, v205
    v_add_f32 v206, 1.0, v206
    v_add_f32 v207, 1.0, v207
    v_rcp_f32 v204, v204
    v_rcp_f32 v205, v205
    v_mfma_f32_32x32x16_bf16 v[84:99], v[116:119], v[24:27], v[84:99]
    v_rcp_f32 v206, v206
    v_rcp_f32 v207, v207
    buffer_load_dwordx4 v[112:115], v241, s[16:19], s64 offen offset:1024 sc1
    v_mfma_f32_32x32x16_bf16 v[68:83], v[120:123], v[28:31], v[68:83]
    v_mul_f32 v64, v64, v204
    v_mul_f32 v65, v65, v205
    v_mul_f32 v66, v66, v206
    v_mul_f32 v67, v67, v207
    v_cvt_pk_bf16_f32 v214, v64, v65
    v_cvt_pk_bf16_f32 v215, v66, v67
    v_mfma_f32_32x32x16_bf16 v[84:99], v[120:123], v[32:35], v[84:99]
    ds_write_b128 v245, v[212:215] offset:8704
    buffer_load_dwordx4 v[116:119], v242, s[16:19], s64 offen offset:1024 sc1
    s_waitcnt vmcnt(18)
    v_mfma_f32_32x32x16_bf16 v[36:51], v[124:127], a[0:3], 0
    v_mfma_f32_32x32x16_bf16 v[52:67], v[124:127], a[4:7], 0
    buffer_load_dwordx4 v[120:123], v241, s[16:19], s64 offen offset:2048 sc1
    v_mfma_f32_32x32x16_bf16 v[36:51], v[128:131], a[8:11], v[36:51]
    v_mfma_f32_32x32x16_bf16 v[52:67], v[128:131], a[12:15], v[52:67]
    s_waitcnt lgkmcnt(4)
    v_fmac_f32 v68, v184, v234
    v_fmac_f32 v69, v185, v234
    v_fmac_f32 v70, v186, v234
    buffer_load_dwordx4 v[124:127], v242, s[16:19], s64 offen offset:2048 sc1
    s_waitcnt vmcnt(18)
    v_mfma_f32_32x32x16_bf16 v[36:51], v[132:135], a[16:19], v[36:51]
    v_fmac_f32 v71, v187, v234
    v_fmac_f32 v72, v188, v234
    v_fmac_f32 v73, v189, v234
    v_fmac_f32 v74, v190, v234
    v_fmac_f32 v75, v191, v234
    v_fmac_f32 v76, v192, v234
    v_fmac_f32 v77, v193, v234
    v_mfma_f32_32x32x16_bf16 v[52:67], v[132:135], a[20:23], v[52:67]
    v_fmac_f32 v78, v194, v234
    v_fmac_f32 v79, v195, v234
    v_fmac_f32 v80, v196, v234
    v_fmac_f32 v81, v197, v234
    buffer_load_dwordx4 v[128:131], v241, s[16:19], s64 offen offset:3072 sc1
    v_mfma_f32_32x32x16_bf16 v[36:51], v[136:139], a[24:27], v[36:51]
    v_fmac_f32 v82, v198, v234
    v_fmac_f32 v83, v199, v234
    v_fmac_f32 v84, v184, v237
    v_fmac_f32 v85, v185, v237
    v_fmac_f32 v86, v186, v237
    v_fmac_f32 v87, v187, v237
    v_fmac_f32 v88, v188, v237
    v_mfma_f32_32x32x16_bf16 v[52:67], v[136:139], a[28:31], v[52:67]
    v_fmac_f32 v89, v189, v237
    v_fmac_f32 v90, v190, v237
    v_fmac_f32 v91, v191, v237
    v_fmac_f32 v92, v192, v237
    buffer_load_dwordx4 v[132:135], v242, s[16:19], s64 offen offset:3072 sc1
    s_waitcnt vmcnt(18)
    v_mfma_f32_32x32x16_bf16 v[36:51], v[140:143], a[32:35], v[36:51]
    s_mul_i32 s7, s25, 4352
    s_add_u32 s7, s7, 29724928
    s_cmp_lg_u32 s23, 0
    s_cbranch_scc1 P3_cz
    s_load_dword s4, s[28:29], s7 glc
P3_cz:
    v_mfma_f32_32x32x16_bf16 v[52:67], v[140:143], a[36:39], v[52:67]
    v_fmac_f32 v93, v193, v237
    v_fmac_f32 v94, v194, v237
    v_fmac_f32 v95, v195, v237
    v_fmac_f32 v96, v196, v237
    s_add_u32 s64, s88, 307200
    buffer_load_dwordx4 v[136:139], v241, s[16:19], s64 offen offset:0 sc1
    v_mfma_f32_32x32x16_bf16 v[36:51], v[144:147], a[40:43], v[36:51]
    v_fmac_f32 v97, v197, v237
    v_fmac_f32 v98, v198, v237
    v_fmac_f32 v99, v199, v237
    ds_read_b128 v[184:187], v246 offset:1024
    ds_read_b128 v[188:191], v246 offset:1056
    v_mfma_f32_32x32x16_bf16 v[52:67], v[144:147], a[44:47], v[52:67]
    ds_read_b128 v[192:195], v246 offset:1088
    ds_read_b128 v[196:199], v246 offset:1120
    v_mul_f32 v200, v68, v68
    v_mul_f32 v201, v69, v69
    buffer_load_dwordx4 v[140:143], v242, s[16:19], s64 offen offset:0 sc1
    s_waitcnt vmcnt(18)
    v_mfma_f32_32x32x16_bf16 v[36:51], v[148:151], a[48:51], v[36:51]
    v_mul_f32 v202, v70, v70
    v_mul_f32 v203, v71, v71
    v_fma_f32 v200, v200, v236, v235
    v_fma_f32 v201, v201, v236, v235
    v_fma_f32 v202, v202, v236, v235
    v_fma_f32 v203, v203, v236, v235
    v_mul_f32 v200, v200, v68
    v_mfma_f32_32x32x16_bf16 v[52:67], v[148:151], a[52:55], v[52:67]
    v_mul_f32 v201, v201, v69
    v_mul_f32 v202, v202, v70
    v_mul_f32 v203, v203, v71
    buffer_load_dwordx4 v[144:147], v241, s[16:19], s64 offen offset:1024 sc1
    v_mfma_f32_32x32x16_bf16 v[36:51], v[152:155], a[56:59], v[36:51]
    v_exp_f32 v200, v200
    v_exp_f32 v201, v201
    v_exp_f32 v202, v202
    v_exp_f32 v203, v203
    v_mfma_f32_32x32x16_bf16 v[52:67], v[152:155], a[60:63], v[52:67]
    v_add_f32 v200, 1.0, v200
    v_add_f32 v201, 1.0, v201
    v_add_f32 v202, 1.0, v202
    buffer_load_dwordx4 v[148:151], v242, s[16:19], s64 offen offset:1024 sc1
    s_waitcnt vmcnt(18)
    v_mfma_f32_32x32x16_bf16 v[36:51], v[156:159], a[64:67], v[36:51]
    v_add_f32 v203, 1.0, v203
    v_rcp_f32 v200, v200
    v_rcp_f32 v201, v201
    v_rcp_f32 v202, v202
    v_mfma_f32_32x32x16_bf16 v[52:67], v[156:159], a[68:71], v[52:67]
    v_rcp_f32 v203, v203
    v_mul_f32 v68, v68, v200
    v_mul_f32 v69, v69, v201
    buffer_load_dwordx4 v[152:155], v241, s[16:19], s64 offen offset:2048 sc1
    v_mfma_f32_32x32x16_bf16 v[36:51], v[160:163], a[72:75], v[36:51]
    v_mul_f32 v70, v70, v202
    v_mul_f32 v71, v71, v203
    v_cvt_pk_bf16_f32 v208, v68, v69
    v_cvt_pk_bf16_f32 v209, v70, v71
    v_mul_f32 v204, v76, v76
    v_mul_f32 v205, v77, v77
    v_mul_f32 v206, v78, v78
    v_mfma_f32_32x32x16_bf16 v[52:67], v[160:163], a[76:79], v[52:67]
    v_mul_f32 v207, v79, v79
    v_fma_f32 v204, v204, v236, v235
    v_fma_f32 v205, v205, v236, v235
    buffer_load_dwordx4 v[156:159], v242, s[16:19], s64 offen offset:2048 sc1
    s_waitcnt vmcnt(18)
    v_mfma_f32_32x32x16_bf16 v[36:51], v[164:167], a[80:83], v[36:51]
    v_fma_f32 v206, v206, v236, v235
    v_fma_f32 v207, v207, v236, v235
    v_mul_f32 v204, v204, v76
    v_mul_f32 v205, v205, v77
    v_mul_f32 v206, v206, v78
    v_mul_f32 v207, v207, v79
    v_exp_f32 v204, v204
    v_mfma_f32_32x32x16_bf16 v[52:67], v[164:167], a[84:87], v[52:67]
    v_exp_f32 v205, v205
    v_exp_f32 v206, v206
    buffer_load_dwordx4 v[160:163], v241, s[16:19], s64 offen offset:3072 sc1
    v_mfma_f32_32x32x16_bf16 v[36:51], v[168:171], a[88:91], v[36:51]
    v_exp_f32 v207, v207
    v_add_f32 v204, 1.0, v204
    v_add_f32 v205, 1.0, v205
    v_add_f32 v206, 1.0, v206
    v_add_f32 v207, 1.0, v207
    v_mfma_f32_32x32x16_bf16 v[52:67], v[168:171], a[92:95], v[52:67]
    v_rcp_f32 v204, v204
    v_rcp_f32 v205, v205
    buffer_load_dwordx4 v[164:167], v242, s[16:19], s64 offen offset:3072 sc1
    s_waitcnt vmcnt(18)
    v_mfma_f32_32x32x16_bf16 v[36:51], v[172:175], a[96:99], v[36:51]
    v_rcp_f32 v206, v206
    v_rcp_f32 v207, v207
    v_mul_f32 v76, v76, v204
    v_mul_f32 v77, v77, v205
    v_mfma_f32_32x32x16_bf16 v[52:67], v[172:175], a[100:103], v[52:67]
    v_mul_f32 v78, v78, v206
    v_mul_f32 v79, v79, v207
    v_cvt_pk_bf16_f32 v210, v76, v77
    v_cvt_pk_bf16_f32 v211, v78, v79
    s_add_u32 s64, s88, 311296
    buffer_load_dwordx4 v[168:171], v241, s[16:19], s64 offen offset:0 sc1
    v_mfma_f32_32x32x16_bf16 v[36:51], v[176:179], a[104:107], v[36:51]
    ds_write_b128 v244, v[208:211] offset:24576
    v_mul_f32 v200, v72, v72
    v_mul_f32 v201, v73, v73
    v_mul_f32 v202, v74, v74
    v_mfma_f32_32x32x16_bf16 v[52:67], v[176:179], a[108:111], v[52:67]
    v_mul_f32 v203, v75, v75
    v_fma_f32 v200, v200, v236, v235
    v_fma_f32 v201, v201, v236, v235
    v_fma_f32 v202, v202, v236, v235
    buffer_load_dwordx4 v[172:175], v242, s[16:19], s64 offen offset:0 sc1
    s_waitcnt vmcnt(18)
    v_mfma_f32_32x32x16_bf16 v[36:51], v[180:183], a[112:115], v[36:51]
    v_fma_f32 v203, v203, v236, v235
    v_mul_f32 v200, v200, v72
    v_mul_f32 v201, v201, v73
    v_mul_f32 v202, v202, v74
    v_mul_f32 v203, v203, v75
    v_exp_f32 v200, v200
    v_mfma_f32_32x32x16_bf16 v[52:67], v[180:183], a[116:119], v[52:67]
    v_exp_f32 v201, v201
    v_exp_f32 v202, v202
    buffer_load_dwordx4 v[176:179], v241, s[16:19], s64 offen offset:1024 sc1
    v_mfma_f32_32x32x16_bf16 v[36:51], v[100:103], a[120:123], v[36:51]
    v_exp_f32 v203, v203
    v_add_f32 v200, 1.0, v200
    v_add_f32 v201, 1.0, v201
    v_add_f32 v202, 1.0, v202
    v_add_f32 v203, 1.0, v203
    v_mfma_f32_32x32x16_bf16 v[52:67], v[100:103], a[124:127], v[52:67]
    v_rcp_f32 v200, v200
    v_rcp_f32 v201, v201
    buffer_load_dwordx4 v[180:183], v242, s[16:19], s64 offen offset:1024 sc1
    s_waitcnt vmcnt(18)
    v_mfma_f32_32x32x16_bf16 v[36:51], v[104:107], a[128:131], v[36:51]
    v_rcp_f32 v202, v202
    v_rcp_f32 v203, v203
    v_mul_f32 v72, v72, v200
    v_mul_f32 v73, v73, v201
    v_mul_f32 v74, v74, v202
    v_mfma_f32_32x32x16_bf16 v[52:67], v[104:107], a[132:135], v[52:67]
    v_mul_f32 v75, v75, v203
    v_cvt_pk_bf16_f32 v212, v72, v73
    v_cvt_pk_bf16_f32 v213, v74, v75
    v_mul_f32 v204, v80, v80
    s_add_u32 s64, s88, 442368
    buffer_load_dwordx4 v[100:103], v241, s[16:19], s64 offen offset:0 sc1
    v_mfma_f32_32x32x16_bf16 v[36:51], v[108:111], a[136:139], v[36:51]
    v_mul_f32 v205, v81, v81
    v_mul_f32 v206, v82, v82
    v_mul_f32 v207, v83, v83
    v_fma_f32 v204, v204, v236, v235
    v_fma_f32 v205, v205, v236, v235
    v_fma_f32 v206, v206, v236, v235
    v_mfma_f32_32x32x16_bf16 v[52:67], v[108:111], a[140:143], v[52:67]
    v_fma_f32 v207, v207, v236, v235
    v_mul_f32 v204, v204, v80
    v_mul_f32 v205, v205, v81
    v_mul_f32 v206, v206, v82
    buffer_load_dwordx4 v[104:107], v242, s[16:19], s64 offen offset:0 sc1
    s_waitcnt vmcnt(18)
    v_mfma_f32_32x32x16_bf16 v[36:51], v[112:115], a[144:147], v[36:51]
    v_mul_f32 v207, v207, v83
    v_exp_f32 v204, v204
    v_exp_f32 v205, v205
    v_exp_f32 v206, v206
    v_mfma_f32_32x32x16_bf16 v[52:67], v[112:115], a[148:151], v[52:67]
    v_exp_f32 v207, v207
    v_add_f32 v204, 1.0, v204
    v_add_f32 v205, 1.0, v205
    buffer_load_dwordx4 v[108:111], v241, s[16:19], s64 offen offset:1024 sc1
    v_mfma_f32_32x32x16_bf16 v[36:51], v[116:119], a[152:155], v[36:51]
    v_add_f32 v206, 1.0, v206
    v_add_f32 v207, 1.0, v207
    v_rcp_f32 v204, v204
    v_rcp_f32 v205, v205
    v_mfma_f32_32x32x16_bf16 v[52:67], v[116:119], a[156:159], v[52:67]
    v_rcp_f32 v206, v206
    v_rcp_f32 v207, v207
    buffer_load_dwordx4 v[112:115], v242, s[16:19], s64 offen offset:1024 sc1
    s_waitcnt vmcnt(18)
    v_mfma_f32_32x32x16_bf16 v[36:51], v[120:123], a[160:163], v[36:51]
    v_mul_f32 v80, v80, v204
    v_mul_f32 v81, v81, v205
    v_mul_f32 v82, v82, v206
    v_mul_f32 v83, v83, v207
    v_cvt_pk_bf16_f32 v214, v80, v81
    v_cvt_pk_bf16_f32 v215, v82, v83
    v_mfma_f32_32x32x16_bf16 v[52:67], v[120:123], a[164:167], v[52:67]
    ds_write_b128 v244, v[212:215] offset:25088
    v_mul_f32 v200, v84, v84
    buffer_load_dwordx4 v[116:119], v241, s[16:19], s64 offen offset:2048 sc1
    v_mfma_f32_32x32x16_bf16 v[36:51], v[124:127], a[168:171], v[36:51]
    v_mul_f32 v201, v85, v85
    v_mul_f32 v202, v86, v86
    v_mul_f32 v203, v87, v87
    v_fma_f32 v200, v200, v239, v238
    v_fma_f32 v201, v201, v239, v238
    v_fma_f32 v202, v202, v239, v238
    v_fma_f32 v203, v203, v239, v238
    v_mfma_f32_32x32x16_bf16 v[52:67], v[124:127], a[172:175], v[52:67]
    v_mul_f32 v200, v200, v84
    v_mul_f32 v201, v201, v85
    v_mul_f32 v202, v202, v86
    v_mul_f32 v203, v203, v87
    buffer_load_dwordx4 v[120:123], v242, s[16:19], s64 offen offset:2048 sc1
    s_waitcnt vmcnt(18)
    v_mfma_f32_32x32x16_bf16 v[36:51], v[128:131], a[176:179], v[36:51]
    v_exp_f32 v200, v200
    v_exp_f32 v201, v201
    v_exp_f32 v202, v202
    v_mfma_f32_32x32x16_bf16 v[52:67], v[128:131], a[180:183], v[52:67]
    v_exp_f32 v203, v203
    v_add_f32 v200, 1.0, v200
    v_add_f32 v201, 1.0, v201
    buffer_load_dwordx4 v[124:127], v241, s[16:19], s64 offen offset:3072 sc1
    v_mfma_f32_32x32x16_bf16 v[36:51], v[132:135], a[184:187], v[36:51]
    v_add_f32 v202, 1.0, v202
    v_add_f32 v203, 1.0, v203
    v_rcp_f32 v200, v200
    v_rcp_f32 v201, v201
    v_mfma_f32_32x32x16_bf16 v[52:67], v[132:135], a[188:191], v[52:67]
    v_rcp_f32 v202, v202
    v_rcp_f32 v203, v203
    v_mul_f32 v84, v84, v200
    buffer_load_dwordx4 v[128:131], v242, s[16:19], s64 offen offset:3072 sc1
    s_waitcnt vmcnt(18)
    v_mfma_f32_32x32x16_bf16 v[36:51], v[136:139], a[192:195], v[36:51]
    v_mul_f32 v85, v85, v201
    v_mul_f32 v86, v86, v202
    v_mul_f32 v87, v87, v203
    v_cvt_pk_bf16_f32 v208, v84, v85
    v_cvt_pk_bf16_f32 v209, v86, v87
    v_mul_f32 v204, v92, v92
    v_mul_f32 v205, v93, v93
    v_mfma_f32_32x32x16_bf16 v[52:67], v[136:139], a[196:199], v[52:67]
    v_mul_f32 v206, v94, v94
    v_mul_f32 v207, v95, v95
    v_fma_f32 v204, v204, v239, v238
    s_add_u32 s64, s88, 446464
    buffer_load_dwordx4 v[132:135], v241, s[16:19], s64 offen offset:0 sc1
    v_mfma_f32_32x32x16_bf16 v[36:51], v[140:143], a[200:203], v[36:51]
    v_fma_f32 v205, v205, v239, v238
    v_fma_f32 v206, v206, v239, v238
    v_fma_f32 v207, v207, v239, v238
    v_mul_f32 v204, v204, v92
    v_mul_f32 v205, v205, v93
    v_mul_f32 v206, v206, v94
    v_mul_f32 v207, v207, v95
    v_mfma_f32_32x32x16_bf16 v[52:67], v[140:143], a[204:207], v[52:67]
    v_exp_f32 v204, v204
    v_exp_f32 v205, v205
    buffer_load_dwordx4 v[136:139], v242, s[16:19], s64 offen offset:0 sc1
    s_waitcnt vmcnt(18)
    v_mfma_f32_32x32x16_bf16 v[36:51], v[144:147], a[208:211], v[36:51]
    v_exp_f32 v206, v206
    v_exp_f32 v207, v207
    v_add_f32 v204, 1.0, v204
    v_add_f32 v205, 1.0, v205
    v_add_f32 v206, 1.0, v206
    v_mfma_f32_32x32x16_bf16 v[52:67], v[144:147], a[212:215], v[52:67]
    v_add_f32 v207, 1.0, v207
    v_rcp_f32 v204, v204
    buffer_load_dwordx4 v[140:143], v241, s[16:19], s64 offen offset:1024 sc1
    v_mfma_f32_32x32x16_bf16 v[36:51], v[148:151], a[216:219], v[36:51]
    v_rcp_f32 v205, v205
    v_rcp_f32 v206, v206
    v_rcp_f32 v207, v207
    v_mul_f32 v92, v92, v204
    v_mfma_f32_32x32x16_bf16 v[52:67], v[148:151], a[220:223], v[52:67]
    v_mul_f32 v93, v93, v205
    v_mul_f32 v94, v94, v206
    v_mul_f32 v95, v95, v207
    v_cvt_pk_bf16_f32 v210, v92, v93
    buffer_load_dwordx4 v[144:147], v242, s[16:19], s64 offen offset:1024 sc1
    s_waitcnt vmcnt(18)
    v_mfma_f32_32x32x16_bf16 v[36:51], v[152:155], a[224:227], v[36:51]
    v_cvt_pk_bf16_f32 v211, v94, v95
    ds_write_b128 v245, v[208:211] offset:24576
    v_mul_f32 v200, v88, v88
    v_mul_f32 v201, v89, v89
    v_mfma_f32_32x32x16_bf16 v[52:67], v[152:155], a[228:231], v[52:67]
    v_mul_f32 v202, v90, v90
    v_mul_f32 v203, v91, v91
    v_fma_f32 v200, v200, v239, v238
    v_fma_f32 v201, v201, v239, v238
    buffer_load_dwordx4 v[148:151], v241, s[16:19], s64 offen offset:2048 sc1
    v_mfma_f32_32x32x16_bf16 v[36:51], v[156:159], a[232:235], v[36:51]
    v_fma_f32 v202, v202, v239, v238
    v_fma_f32 v203, v203, v239, v238
    v_mul_f32 v200, v200, v88
    v_mul_f32 v201, v201, v89
    v_mul_f32 v202, v202, v90
    v_mul_f32 v203, v203, v91
    v_mfma_f32_32x32x16_bf16 v[52:67], v[156:159], a[236:239], v[52:67]
    v_exp_f32 v200, v200
    v_exp_f32 v201, v201
    buffer_load_dwordx4 v[152:155], v242, s[16:19], s64 offen offset:2048 sc1
    s_waitcnt vmcnt(18)
    v_mfma_f32_32x32x16_bf16 v[36:51], v[160:163], a[240:243], v[36:51]
    v_exp_f32 v202, v202
    v_exp_f32 v203, v203
    v_add_f32 v200, 1.0, v200
    v_add_f32 v201, 1.0, v201
    v_add_f32 v202, 1.0, v202
    v_mfma_f32_32x32x16_bf16 v[52:67], v[160:163], a[244:247], v[52:67]
    v_add_f32 v203, 1.0, v203
    v_rcp_f32 v200, v200
    v_rcp_f32 v201, v201
    buffer_load_dwordx4 v[156:159], v241, s[16:19], s64 offen offset:3072 sc1
    v_mfma_f32_32x32x16_bf16 v[36:51], v[164:167], a[248:251], v[36:51]
    v_rcp_f32 v202, v202
    v_rcp_f32 v203, v203
    v_mul_f32 v88, v88, v200
    v_mul_f32 v89, v89, v201
    v_mfma_f32_32x32x16_bf16 v[52:67], v[164:167], a[252:255], v[52:67]
    v_mul_f32 v90, v90, v202
    v_mul_f32 v91, v91, v203
    v_cvt_pk_bf16_f32 v212, v88, v89
    v_cvt_pk_bf16_f32 v213, v90, v91
    buffer_load_dwordx4 v[160:163], v242, s[16:19], s64 offen offset:3072 sc1
    s_waitcnt vmcnt(18)
    v_mfma_f32_32x32x16_bf16 v[36:51], v[168:171], v[4:7], v[36:51]
    v_mul_f32 v204, v96, v96
    v_mul_f32 v205, v97, v97
    v_mul_f32 v206, v98, v98
    v_mul_f32 v207, v99, v99
    v_fma_f32 v204, v204, v239, v238
    v_fma_f32 v205, v205, v239, v238
    v_mfma_f32_32x32x16_bf16 v[52:67], v[168:171], v[8:11], v[52:67]
    v_fma_f32 v206, v206, v239, v238
    v_fma_f32 v207, v207, v239, v238
    v_mul_f32 v204, v204, v96
    v_mul_f32 v205, v205, v97
    s_add_u32 s64, s88, 450560
    buffer_load_dwordx4 v[164:167], v241, s[16:19], s64 offen offset:0 sc1
    v_mfma_f32_32x32x16_bf16 v[36:51], v[172:175], v[12:15], v[36:51]
    v_mul_f32 v206, v206, v98
    v_mul_f32 v207, v207, v99
    v_exp_f32 v204, v204
    v_exp_f32 v205, v205
    v_mfma_f32_32x32x16_bf16 v[52:67], v[172:175], v[16:19], v[52:67]
    v_exp_f32 v206, v206
    v_exp_f32 v207, v207
    v_add_f32 v204, 1.0, v204
    buffer_load_dwordx4 v[168:171], v242, s[16:19], s64 offen offset:0 sc1
    s_waitcnt vmcnt(18)
    v_mfma_f32_32x32x16_bf16 v[36:51], v[176:179], v[20:23], v[36:51]
    v_add_f32 v205, 1.0, v205
    v_add_f32 v206, 1.0, v206
    v_add_f32 v207, 1.0, v207
    v_rcp_f32 v204, v204
    v_rcp_f32 v205, v205
    v_mfma_f32_32x32x16_bf16 v[52:67], v[176:179], v[24:27], v[52:67]
    v_rcp_f32 v206, v206
    v_rcp_f32 v207, v207
    buffer_load_dwordx4 v[172:175], v241, s[16:19], s64 offen offset:1024 sc1
    v_mfma_f32_32x32x16_bf16 v[36:51], v[180:183], v[28:31], v[36:51]
    v_mul_f32 v96, v96, v204
    v_mul_f32 v97, v97, v205
    v_mul_f32 v98, v98, v206
    v_mul_f32 v99, v99, v207
    v_cvt_pk_bf16_f32 v214, v96, v97
    v_cvt_pk_bf16_f32 v215, v98, v99
    v_mfma_f32_32x32x16_bf16 v[52:67], v[180:183], v[32:35], v[52:67]
    ds_write_b128 v245, v[212:215] offset:25088
    s_cmp_ge_u32 s23, 1
    s_cbranch_scc1 OK_86
    s_mov_b32 s3, 0
SP_85:
    s_waitcnt lgkmcnt(0)
    s_cmp_ge_u32 s4, 576
    s_cbranch_scc1 OK_86
    s_add_u32 s3, s3, 1
    s_cmp_gt_u32 s3, 200000
    s_cbranch_scc1 OK_86
    s_sleep 8
    s_load_dword s4, s[28:29], s7 glc
    s_branch SP_85
OK_86:
    s_waitcnt lgkmcnt(0)
    s_barrier
    buffer_load_dwordx4 v[176:179], v242, s[16:19], s64 offen offset:1024 sc1
    s_waitcnt vmcnt(18)
    v_mfma_f32_32x32x16_bf16 v[68:83], v[100:103], a[0:3], 0
    v_mfma_f32_32x32x16_bf16 v[84:99], v[100:103], a[4:7], 0
    buffer_load_dwordx4 v[180:183], v241, s[16:19], s64 offen offset:2048 sc1
    v_mfma_f32_32x32x16_bf16 v[68:83], v[104:107], a[8:11], v[68:83]
    v_mfma_f32_32x32x16_bf16 v[84:99], v[104:107], a[12:15], v[84:99]
    v_fmac_f32 v36, v184, v234
    v_fmac_f32 v37, v185, v234
    v_fmac_f32 v38, v186, v234
    v_fmac_f32 v39, v187, v234
    v_fmac_f32 v40, v188, v234
    buffer_load_dwordx4 v[100:103], v242, s[16:19], s64 offen offset:2048 sc1
    s_waitcnt vmcnt(18)
    v_mfma_f32_32x32x16_bf16 v[68:83], v[108:111], a[16:19], v[68:83]
    ds_read_b128 a[0:3], v240 offset:0
    v_fmac_f32 v41, v189, v234
    v_fmac_f32 v42, v190, v234
    v_fmac_f32 v43, v191, v234
    v_fmac_f32 v44, v192, v234
    v_fmac_f32 v45, v193, v234
    v_fmac_f32 v46, v194, v234
    v_fmac_f32 v47, v195, v234
    v_fmac_f32 v48, v196, v234
    v_mfma_f32_32x32x16_bf16 v[84:99], v[108:111], a[20:23], v[84:99]
    ds_read_b128 a[4:7], v240 offset:1024
    v_fmac_f32 v49, v197, v234
    v_fmac_f32 v50, v198, v234
    v_fmac_f32 v51, v199, v234
    v_fmac_f32 v52, v184, v237
    buffer_load_dwordx4 v[104:107], v241, s[16:19], s64 offen offset:3072 sc1
    v_mfma_f32_32x32x16_bf16 v[68:83], v[112:115], a[24:27], v[68:83]
    ds_read_b128 a[8:11], v240 offset:2048
    v_fmac_f32 v53, v185, v237
    v_fmac_f32 v54, v186, v237
    v_fmac_f32 v55, v187, v237
    v_fmac_f32 v56, v188, v237
    v_fmac_f32 v57, v189, v237
    v_fmac_f32 v58, v190, v237
    v_fmac_f32 v59, v191, v237
    v_fmac_f32 v60, v192, v237
    v_mfma_f32_32x32x16_bf16 v[84:99], v[112:115], a[28:31], v[84:99]
    ds_read_b128 a[12:15], v240 offset:3072
    v_fmac_f32 v61, v193, v237
    v_fmac_f32 v62, v194, v237
    v_fmac_f32 v63, v195, v237
    buffer_load_dwordx4 v[108:111], v242, s[16:19], s64 offen offset:3072 sc1
    s_waitcnt vmcnt(18)
    v_mfma_f32_32x32x16_bf16 v[68:83], v[116:119], a[32:35], v[68:83]
    ds_read_b128 a[16:19], v240 offset:4096
    v_fmac_f32 v64, v196, v237
    v_fmac_f32 v65, v197, v237
    v_fmac_f32 v66, v198, v237
    v_fmac_f32 v67, v199, v237
    ds_read_b128 v[184:187], v246 offset:1536
    ds_read_b128 v[188:191], v246 offset:1568
    ds_read_b128 v[192:195], v246 offset:1600
    v_mfma_f32_32x32x16_bf16 v[84:99], v[116:119], a[36:39], v[84:99]
    ds_read_b128 a[20:23], v240 offset:5120
    ds_read_b128 v[196:199], v246 offset:1632
    v_mul_f32 v200, v36, v36
    v_mul_f32 v201, v37, v37
    v_mul_f32 v202, v38, v38
    s_add_u32 s64, s88, 454656
    buffer_load_dwordx4 v[112:115], v241, s[16:19], s64 offen offset:0 sc1
    v_mfma_f32_32x32x16_bf16 v[68:83], v[120:123], a[40:43], v[68:83]
    ds_read_b128 a[24:27], v240 offset:6144
    v_mul_f32 v203, v39, v39
    v_fma_f32 v200, v200, v236, v235
    v_fma_f32 v201, v201, v236, v235
    v_fma_f32 v202, v202, v236, v235
    v_fma_f32 v203, v203, v236, v235
    v_mul_f32 v200, v200, v36
    v_mul_f32 v201, v201, v37
    v_mul_f32 v202, v202, v38
    v_mfma_f32_32x32x16_bf16 v[84:99], v[120:123], a[44:47], v[84:99]
    ds_read_b128 a[28:31], v240 offset:7168
    v_mul_f32 v203, v203, v39
    v_exp_f32 v200, v200
    buffer_load_dwordx4 v[116:119], v242, s[16:19], s64 offen offset:0 sc1
    s_waitcnt vmcnt(18)
    v_mfma_f32_32x32x16_bf16 v[68:83], v[124:127], a[48:51], v[68:83]
    ds_read_b128 a[32:35], v240 offset:8192
    v_exp_f32 v201, v201
    v_exp_f32 v202, v202
    v_exp_f32 v203, v203
    v_add_f32 v200, 1.0, v200
    v_add_f32 v201, 1.0, v201
    v_mfma_f32_32x32x16_bf16 v[84:99], v[124:127], a[52:55], v[84:99]
    ds_read_b128 a[36:39], v240 offset:9216
    v_add_f32 v202, 1.0, v202
    v_add_f32 v203, 1.0, v203
    v_rcp_f32 v200, v200
    buffer_load_dwordx4 v[120:123], v241, s[16:19], s64 offen offset:1024 sc1
    v_mfma_f32_32x32x16_bf16 v[68:83], v[128:131], a[56:59], v[68:83]
    ds_read_b128 a[40:43], v240 offset:10240
    v_rcp_f32 v201, v201
    v_rcp_f32 v202, v202
    v_rcp_f32 v203, v203
    v_mul_f32 v36, v36, v200
    v_mul_f32 v37, v37, v201
    v_mfma_f32_32x32x16_bf16 v[84:99], v[128:131], a[60:63], v[84:99]
    ds_read_b128 a[44:47], v240 offset:11264
    v_mul_f32 v38, v38, v202
    v_mul_f32 v39, v39, v203
    v_cvt_pk_bf16_f32 v208, v36, v37
    buffer_load_dwordx4 v[124:127], v242, s[16:19], s64 offen offset:1024 sc1
    s_waitcnt vmcnt(18)
    v_mfma_f32_32x32x16_bf16 v[68:83], v[132:135], a[64:67], v[68:83]
    ds_read_b128 a[48:51], v240 offset:12288
    v_cvt_pk_bf16_f32 v209, v38, v39
    v_mul_f32 v204, v44, v44
    v_mul_f32 v205, v45, v45
    v_mul_f32 v206, v46, v46
    v_mul_f32 v207, v47, v47
    v_fma_f32 v204, v204, v236, v235
    v_fma_f32 v205, v205, v236, v235
    v_fma_f32 v206, v206, v236, v235
    v_mfma_f32_32x32x16_bf16 v[84:99], v[132:135], a[68:71], v[84:99]
    ds_read_b128 a[52:55], v240 offset:13312
    v_fma_f32 v207, v207, v236, v235
    v_mul_f32 v204, v204, v44
    v_mul_f32 v205, v205, v45
    v_mul_f32 v206, v206, v46
    buffer_load_dwordx4 v[128:131], v241, s[16:19], s64 offen offset:2048 sc1
    v_mfma_f32_32x32x16_bf16 v[68:83], v[136:139], a[72:75], v[68:83]
    ds_read_b128 a[56:59], v240 offset:14336
    v_mul_f32 v207, v207, v47
    v_exp_f32 v204, v204
    v_exp_f32 v205, v205
    v_exp_f32 v206, v206
    v_mfma_f32_32x32x16_bf16 v[84:99], v[136:139], a[76:79], v[84:99]
    ds_read_b128 a[60:63], v240 offset:15360
    v_exp_f32 v207, v207
    v_add_f32 v204, 1.0, v204
    v_add_f32 v205, 1.0, v205
    v_add_f32 v206, 1.0, v206
    buffer_load_dwordx4 v[132:135], v242, s[16:19], s64 offen offset:2048 sc1
    s_waitcnt vmcnt(18)
    v_mfma_f32_32x32x16_bf16 v[68:83], v[140:143], a[80:83], v[68:83]
    ds_read_b128 a[64:67], v240 offset:16384
    v_add_f32 v207, 1.0, v207
    v_rcp_f32 v204, v204
    v_rcp_f32 v205, v205
    v_rcp_f32 v206, v206
    v_mfma_f32_32x32x16_bf16 v[84:99], v[140:143], a[84:87], v[84:99]
    ds_read_b128 a[68:71], v240 offset:17408
    v_rcp_f32 v207, v207
    v_mul_f32 v44, v44, v204
    v_mul_f32 v45, v45, v205
    buffer_load_dwordx4 v[136:139], v241, s[16:19], s64 offen offset:3072 sc1
    v_mfma_f32_32x32x16_bf16 v[68:83], v[144:147], a[88:91], v[68:83]
    ds_read_b128 a[72:75], v240 offset:18432
    v_mul_f32 v46, v46, v206
    v_mul_f32 v47, v47, v207
    v_cvt_pk_bf16_f32 v210, v44, v45
    v_cvt_pk_bf16_f32 v211, v46, v47
    ds_write_b128 v244, v[208:211] offset:40960
    v_mfma_f32_32x32x16_bf16 v[84:99], v[144:147], a[92:95], v[84:99]
    ds_read_b128 a[76:79], v240 offset:19456
    v_mul_f32 v200, v40, v40
    v_mul_f32 v201, v41, v41
    v_mul_f32 v202, v42, v42
    v_mul_f32 v203, v43, v43
    buffer_load_dwordx4 v[140:143], v242, s[16:19], s64 offen offset:3072 sc1
    s_waitcnt vmcnt(18)
    v_mfma_f32_32x32x16_bf16 v[68:83], v[148:151], a[96:99], v[68:83]
    ds_read_b128 a[80:83], v240 offset:20480
    v_fma_f32 v200, v200, v236, v235
    v_fma_f32 v201, v201, v236, v235
    v_fma_f32 v202, v202, v236, v235
    v_fma_f32 v203, v203, v236, v235
    v_mul_f32 v200, v200, v40
    v_mul_f32 v201, v201, v41
    v_mul_f32 v202, v202, v42
    v_mul_f32 v203, v203, v43
    v_mfma_f32_32x32x16_bf16 v[84:99], v[148:151], a[100:103], v[84:99]
    ds_read_b128 a[84:87], v240 offset:21504
    v_exp_f32 v200, v200
    v_exp_f32 v201, v201
    s_add_u32 s64, s88, 458752
    buffer_load_dwordx4 v[144:147], v241, s[16:19], s64 offen offset:0 sc1
    v_mfma_f32_32x32x16_bf16 v[68:83], v[152:155], a[104:107], v[68:83]
    ds_read_b128 a[88:91], v240 offset:22528
    v_exp_f32 v202, v202
    v_exp_f32 v203, v203
    v_add_f32 v200, 1.0, v200
    v_add_f32 v201, 1.0, v201
    v_add_f32 v202, 1.0, v202
    v_mfma_f32_32x32x16_bf16 v[84:99], v[152:155], a[108:111], v[84:99]
    ds_read_b128 a[92:95], v240 offset:23552
    v_add_f32 v203, 1.0, v203
    v_rcp_f32 v200, v200
    buffer_load_dwordx4 v[148:151], v242, s[16:19], s64 offen offset:0 sc1
    s_waitcnt vmcnt(18)
    v_mfma_f32_32x32x16_bf16 v[68:83], v[156:159], a[112:115], v[68:83]
    ds_read_b128 a[96:99], v240 offset:24576
    v_rcp_f32 v201, v201
    v_rcp_f32 v202, v202
    v_rcp_f32 v203, v203
    v_mul_f32 v40, v40, v200
    v_mul_f32 v41, v41, v201
    v_mul_f32 v42, v42, v202
    v_mfma_f32_32x32x16_bf16 v[84:99], v[156:159], a[116:119], v[84:99]
    ds_read_b128 a[100:103], v240 offset:25600
    v_mul_f32 v43, v43, v203
    v_cvt_pk_bf16_f32 v212, v40, v41
    v_cvt_pk_bf16_f32 v213, v42, v43
    buffer_load_dwordx4 v[152:155], v241, s[16:19], s64 offen offset:1024 sc1
    v_mfma_f32_32x32x16_bf16 v[68:83], v[160:163], a[120:123], v[68:83]
    ds_read_b128 a[104:107], v240 offset:26624
    v_mul_f32 v204, v48, v48
    v_mul_f32 v205, v49, v49
    v_mul_f32 v206, v50, v50
    v_mul_f32 v207, v51, v51
    v_fma_f32 v204, v204, v236, v235
    v_fma_f32 v205, v205, v236, v235
    v_fma_f32 v206, v206, v236, v235
    v_fma_f32 v207, v207, v236, v235
    v_mfma_f32_32x32x16_bf16 v[84:99], v[160:163], a[124:127], v[84:99]
    ds_read_b128 a[108:111], v240 offset:27648
    v_mul_f32 v204, v204, v48
    v_mul_f32 v205, v205, v49
    v_mul_f32 v206, v206, v50
    v_mul_f32 v207, v207, v51
    buffer_load_dwordx4 v[156:159], v242, s[16:19], s64 offen offset:1024 sc1
    s_waitcnt vmcnt(18)
    v_mfma_f32_32x32x16_bf16 v[68:83], v[164:167], a[128:131], v[68:83]
    ds_read_b128 a[112:115], v240 offset:28672
    v_exp_f32 v204, v204
    v_exp_f32 v205, v205
    v_exp_f32 v206, v206
    v_exp_f32 v207, v207
    v_mfma_f32_32x32x16_bf16 v[84:99], v[164:167], a[132:135], v[84:99]
    s_add_u32 m0, s89, 86016
    s_add_u32 s90, s30, 589824
    buffer_load_dwordx4 v250, s[12:15], s90 offen  lds
    ds_read_b128 a[116:119], v240 offset:29696
    v_add_f32 v204, 1.0, v204
    v_mfma_f32_32x32x16_bf16 v[68:83], v[168:171], a[136:139], v[68:83]
    ds_read_b128 a[120:123], v240 offset:30720
    v_add_f32 v205, 1.0, v205
    v_add_f32 v206, 1.0, v206
    v_add_f32 v207, 1.0, v207
    v_rcp_f32 v204, v204
    v_rcp_f32 v205, v205
    v_mfma_f32_32x32x16_bf16 v[84:99], v[168:171], a[140:143], v[84:99]
    s_add_u32 m0, s89, 90112
    s_add_u32 s90, s30, 626688
    buffer_load_dwordx4 v250, s[12:15], s90 offen  lds
    ds_read_b128 a[124:127], v240 offset:31744
    s_waitcnt vmcnt(18)
    v_mfma_f32_32x32x16_bf16 v[68:83], v[172:175], a[144:147], v[68:83]
    ds_read_b128 a[128:131], v240 offset:32768
    v_rcp_f32 v206, v206
    v_rcp_f32 v207, v207
    v_mul_f32 v48, v48, v204
    v_mul_f32 v49, v49, v205
    v_mul_f32 v50, v50, v206
    v_mul_f32 v51, v51, v207
    v_cvt_pk_bf16_f32 v214, v48, v49
    v_mfma_f32_32x32x16_bf16 v[84:99], v[172:175], a[148:151], v[84:99]
    s_add_u32 m0, s89, 94208
    s_add_u32 s90, s30, 0
    buffer_load_dwordx4 v250, s[12:15], s90 offen  lds
    ds_read_b128 a[132:135], v240 offset:33792
    v_mfma_f32_32x32x16_bf16 v[68:83], v[176:179], a[152:155], v[68:83]
    ds_read_b128 a[136:139], v240 offset:34816
    v_cvt_pk_bf16_f32 v215, v50, v51
    ds_write_b128 v244, v[212:215] offset:41472
    v_mul_f32 v200, v52, v52
    v_mul_f32 v201, v53, v53
    v_mul_f32 v202, v54, v54
    v_mfma_f32_32x32x16_bf16 v[84:99], v[176:179], a[156:159], v[84:99]
    s_add_u32 m0, s89, 98304
    s_add_u32 s90, s30, 36864
    buffer_load_dwordx4 v250, s[12:15], s90 offen  lds
    ds_read_b128 a[140:143], v240 offset:35840
    v_mul_f32 v203, v55, v55
    s_waitcnt vmcnt(18)
    v_mfma_f32_32x32x16_bf16 v[68:83], v[180:183], a[160:163], v[68:83]
    ds_read_b128 a[144:147], v240 offset:36864
    v_fma_f32 v200, v200, v239, v238
    v_fma_f32 v201, v201, v239, v238
    v_fma_f32 v202, v202, v239, v238
    v_fma_f32 v203, v203, v239, v238
    v_mul_f32 v200, v200, v52
    v_mul_f32 v201, v201, v53
    v_mul_f32 v202, v202, v54
    v_mul_f32 v203, v203, v55
    v_mfma_f32_32x32x16_bf16 v[84:99], v[180:183], a[164:167], v[84:99]
    s_add_u32 m0, s89, 102400
    s_add_u32 s90, s30, 73728
    buffer_load_dwordx4 v250, s[12:15], s90 offen  lds
    ds_read_b128 a[148:151], v240 offset:37888
    v_mfma_f32_32x32x16_bf16 v[68:83], v[100:103], a[168:171], v[68:83]
    ds_read_b128 a[152:155], v240 offset:38912
    v_exp_f32 v200, v200
    v_exp_f32 v201, v201
    v_exp_f32 v202, v202
    v_exp_f32 v203, v203
    v_mfma_f32_32x32x16_bf16 v[84:99], v[100:103], a[172:175], v[84:99]
    s_add_u32 m0, s89, 106496
    s_add_u32 s90, s30, 110592
    buffer_load_dwordx4 v250, s[12:15], s90 offen  lds
    ds_read_b128 a[156:159], v240 offset:39936
    v_add_f32 v200, 1.0, v200
    s_waitcnt vmcnt(18)
    v_mfma_f32_32x32x16_bf16 v[68:83], v[104:107], a[176:179], v[68:83]
    v_add_f32 v201, 1.0, v201
    v_add_f32 v202, 1.0, v202
    v_add_f32 v203, 1.0, v203
    v_rcp_f32 v200, v200
    v_rcp_f32 v201, v201
    v_rcp_f32 v202, v202
    v_mfma_f32_32x32x16_bf16 v[84:99], v[104:107], a[180:183], v[84:99]
    s_add_u32 m0, s89, 110592
    s_add_u32 s90, s30, 147456
    buffer_load_dwordx4 v250, s[12:15], s90 offen  lds
    v_rcp_f32 v203, v203
    v_mfma_f32_32x32x16_bf16 v[68:83], v[108:111], a[184:187], v[68:83]
    v_mul_f32 v52, v52, v200
    v_mul_f32 v53, v53, v201
    v_mul_f32 v54, v54, v202
    v_mul_f32 v55, v55, v203
    v_cvt_pk_bf16_f32 v208, v52, v53
    v_cvt_pk_bf16_f32 v209, v54, v55
    v_mul_f32 v204, v60, v60
    v_mul_f32 v205, v61, v61
    v_mul_f32 v206, v62, v62
    v_mfma_f32_32x32x16_bf16 v[84:99], v[108:111], a[188:191], v[84:99]
    s_add_u32 m0, s89, 114688
    s_add_u32 s90, s30, 184320
    buffer_load_dwordx4 v250, s[12:15], s90 offen  lds
    v_mul_f32 v207, v63, v63
    s_waitcnt vmcnt(18)
    v_mfma_f32_32x32x16_bf16 v[68:83], v[112:115], a[192:195], v[68:83]
    v_fma_f32 v204, v204, v239, v238
    v_fma_f32 v205, v205, v239, v238
    v_fma_f32 v206, v206, v239, v238
    v_fma_f32 v207, v207, v239, v238
    v_mul_f32 v204, v204, v60
    v_mul_f32 v205, v205, v61
    v_mul_f32 v206, v206, v62
    v_mul_f32 v207, v207, v63
    v_exp_f32 v204, v204
    v_mfma_f32_32x32x16_bf16 v[84:99], v[112:115], a[196:199], v[84:99]
    s_add_u32 m0, s89, 118784
    s_add_u32 s90, s30, 221184
    buffer_load_dwordx4 v250, s[12:15], s90 offen  lds
    v_mfma_f32_32x32x16_bf16 v[68:83], v[116:119], a[200:203], v[68:83]
    v_exp_f32 v205, v205
    v_exp_f32 v206, v206
    v_exp_f32 v207, v207
    v_add_f32 v204, 1.0, v204
    v_add_f32 v205, 1.0, v205
    v_add_f32 v206, 1.0, v206
    v_add_f32 v207, 1.0, v207
    v_mfma_f32_32x32x16_bf16 v[84:99], v[116:119], a[204:207], v[84:99]
    s_add_u32 m0, s89, 122880
    s_add_u32 s90, s30, 258048
    buffer_load_dwordx4 v250, s[12:15], s90 offen  lds
    s_waitcnt vmcnt(18)
    v_mfma_f32_32x32x16_bf16 v[68:83], v[120:123], a[208:211], v[68:83]
    v_rcp_f32 v204, v204
    v_rcp_f32 v205, v205
    v_rcp_f32 v206, v206
    v_rcp_f32 v207, v207
    v_mul_f32 v60, v60, v204
    v_mul_f32 v61, v61, v205
    v_mfma_f32_32x32x16_bf16 v[84:99], v[120:123], a[212:215], v[84:99]
    s_add_u32 m0, s89, 126976
    s_add_u32 s90, s30, 294912
    buffer_load_dwordx4 v250, s[12:15], s90 offen  lds
    v_mul_f32 v62, v62, v206
    v_mfma_f32_32x32x16_bf16 v[68:83], v[124:127], a[216:219], v[68:83]
    v_mul_f32 v63, v63, v207
    v_cvt_pk_bf16_f32 v210, v60, v61
    v_cvt_pk_bf16_f32 v211, v62, v63
    ds_write_b128 v245, v[208:211] offset:40960
    v_mul_f32 v200, v56, v56
    v_mul_f32 v201, v57, v57
    v_mul_f32 v202, v58, v58
    v_mfma_f32_32x32x16_bf16 v[84:99], v[124:127], a[220:223], v[84:99]
    s_add_u32 m0, s89, 131072
    s_add_u32 s90, s30, 331776
    buffer_load_dwordx4 v250, s[12:15], s90 offen  lds
    s_waitcnt vmcnt(18)
    v_mfma_f32_32x32x16_bf16 v[68:83], v[128:131], a[224:227], v[68:83]
    v_mul_f32 v203, v59, v59
    v_fma_f32 v200, v200, v239, v238
    v_fma_f32 v201, v201, v239, v238
    v_fma_f32 v202, v202, v239, v238
    v_fma_f32 v203, v203, v239, v238
    v_mul_f32 v200, v200, v56
    v_mul_f32 v201, v201, v57
    v_mul_f32 v202, v202, v58
    v_mul_f32 v203, v203, v59
    v_exp_f32 v200, v200
    v_mfma_f32_32x32x16_bf16 v[84:99], v[128:131], a[228:231], v[84:99]
    s_add_u32 m0, s89, 135168
    s_add_u32 s90, s30, 368640
    buffer_load_dwordx4 v250, s[12:15], s90 offen  lds
    v_mfma_f32_32x32x16_bf16 v[68:83], v[132:135], a[232:235], v[68:83]
    v_exp_f32 v201, v201
    v_exp_f32 v202, v202
    v_exp_f32 v203, v203
    v_add_f32 v200, 1.0, v200
    v_add_f32 v201, 1.0, v201
    v_add_f32 v202, 1.0, v202
    v_add_f32 v203, 1.0, v203
    v_mfma_f32_32x32x16_bf16 v[84:99], v[132:135], a[236:239], v[84:99]
    s_add_u32 m0, s89, 139264
    s_add_u32 s90, s30, 405504
    buffer_load_dwordx4 v250, s[12:15], s90 offen  lds
    s_waitcnt vmcnt(18)
    v_mfma_f32_32x32x16_bf16 v[68:83], v[136:139], a[240:243], v[68:83]
    v_rcp_f32 v200, v200
    v_rcp_f32 v201, v201
    v_rcp_f32 v202, v202
    v_rcp_f32 v203, v203
    v_mul_f32 v56, v56, v200
    v_mul_f32 v57, v57, v201
    v_mfma_f32_32x32x16_bf16 v[84:99], v[136:139], a[244:247], v[84:99]
    s_add_u32 m0, s89, 143360
    s_add_u32 s90, s30, 442368
    buffer_load_dwordx4 v250, s[12:15], s90 offen  lds
    v_mul_f32 v58, v58, v202
    v_mfma_f32_32x32x16_bf16 v[68:83], v[140:143], a[248:251], v[68:83]
    v_mul_f32 v59, v59, v203
    v_cvt_pk_bf16_f32 v212, v56, v57
    v_cvt_pk_bf16_f32 v213, v58, v59
    v_mul_f32 v204, v64, v64
    v_mul_f32 v205, v65, v65
    v_mul_f32 v206, v66, v66
    v_mul_f32 v207, v67, v67
    v_fma_f32 v204, v204, v239, v238
    v_fma_f32 v205, v205, v239, v238
    v_fma_f32 v206, v206, v239, v238
    v_mfma_f32_32x32x16_bf16 v[84:99], v[140:143], a[252:255], v[84:99]
    s_add_u32 m0, s89, 147456
    s_add_u32 s90, s30, 479232
    buffer_load_dwordx4 v250, s[12:15], s90 offen  lds
    s_waitcnt vmcnt(18)
    v_mfma_f32_32x32x16_bf16 v[68:83], v[144:147], v[4:7], v[68:83]
    v_fma_f32 v207, v207, v239, v238
    v_mul_f32 v204, v204, v64
    v_mul_f32 v205, v205, v65
    v_mul_f32 v206, v206, v66
    v_mul_f32 v207, v207, v67
    v_exp_f32 v204, v204
    v_exp_f32 v205, v205
    v_mfma_f32_32x32x16_bf16 v[84:99], v[144:147], v[8:11], v[84:99]
    s_add_u32 m0, s89, 151552
    s_add_u32 s90, s30, 516096
    buffer_load_dwordx4 v250, s[12:15], s90 offen  lds
    v_exp_f32 v206, v206
    s_waitcnt vmcnt(14)
    s_barrier
    v_mfma_f32_32x32x16_bf16 v[68:83], v[148:151], v[12:15], v[68:83]
    ds_read_b64_tr_b16 v[100:101], v252 offset:24576
    ds_read_b64_tr_b16 v[102:103], v252 offset:26624
    v_exp_f32 v207, v207
    v_add_f32 v204, 1.0, v204
    v_add_f32 v205, 1.0, v205
    v_add_f32 v206, 1.0, v206
    v_mfma_f32_32x32x16_bf16 v[84:99], v[148:151], v[16:19], v[84:99]
    s_add_u32 m0, s89, 155648
    s_add_u32 s90, s30, 552960
    buffer_load_dwordx4 v250, s[12:15], s90 offen  lds
    v_add_f32 v207, 1.0, v207
    v_mfma_f32_32x32x16_bf16 v[68:83], v[152:155], v[20:23], v[68:83]
    ds_read_b64_tr_b16 v[104:105], v252 offset:28672
    ds_read_b64_tr_b16 v[106:107], v252 offset:30720
    v_rcp_f32 v204, v204
    v_rcp_f32 v205, v205
    v_rcp_f32 v206, v206
    v_mfma_f32_32x32x16_bf16 v[84:99], v[152:155], v[24:27], v[84:99]
    s_add_u32 m0, s89, 159744
    s_add_u32 s90, s31, 589824
    buffer_load_dwordx4 v250, s[12:15], s90 offen  lds
    v_mfma_f32_32x32x16_bf16 v[68:83], v[156:159], v[28:31], v[68:83]
    ds_read_b64_tr_b16 v[108:109], v252 offset:32768
    ds_read_b64_tr_b16 v[110:111], v252 offset:34816
    v_rcp_f32 v207, v207
    v_mul_f32 v64, v64, v204
    v_mul_f32 v65, v65, v205
    v_mul_f32 v66, v66, v206
    v_mul_f32 v67, v67, v207
    v_mfma_f32_32x32x16_bf16 v[84:99], v[156:159], v[32:35], v[84:99]
    v_cvt_pk_bf16_f32 v214, v64, v65
    v_cvt_pk_bf16_f32 v215, v66, v67
    ds_write_b128 v245, v[212:215] offset:41472
    s_waitcnt lgkmcnt(0)
    s_barrier
    s_lshl_b32 s66, s50, 18
    s_add_u32 m0, s61, 1024
    s_add_u32 s66, s66, s49
    buffer_load_dwordx4 v240, s[16:19], s66 offen sc1 lds
    v_pk_fma_f32 v[68:69], v[184:185], v[234:235], v[68:69] op_sel:[0,0,0] op_sel_hi:[1,0,1]
    v_pk_fma_f32 v[70:71], v[186:187], v[234:235], v[70:71] op_sel:[0,0,0] op_sel_hi:[1,0,1]
    v_pk_fma_f32 v[72:73], v[188:189], v[234:235], v[72:73] op_sel:[0,0,0] op_sel_hi:[1,0,1]
    v_pk_fma_f32 v[74:75], v[190:191], v[234:235], v[74:75] op_sel:[0,0,0] op_sel_hi:[1,0,1]
    v_pk_fma_f32 v[76:77], v[192:193], v[234:235], v[76:77] op_sel:[0,0,0] op_sel_hi:[1,0,1]
    v_pk_fma_f32 v[78:79], v[194:195], v[234:235], v[78:79] op_sel:[0,0,0] op_sel_hi:[1,0,1]
    s_lshl_b32 s66, s51, 18
    s_add_u32 m0, s62, 1024
    s_add_u32 s66, s66, s49
    buffer_load_dwordx4 v240, s[16:19], s66 offen sc1 lds
    v_pk_fma_f32 v[80:81], v[196:197], v[234:235], v[80:81] op_sel:[0,0,0] op_sel_hi:[1,0,1]
    v_pk_fma_f32 v[82:83], v[198:199], v[234:235], v[82:83] op_sel:[0,0,0] op_sel_hi:[1,0,1]
    v_pk_fma_f32 v[84:85], v[184:185], v[236:237], v[84:85] op_sel:[0,1,0] op_sel_hi:[1,1,1]
    v_pk_fma_f32 v[86:87], v[186:187], v[236:237], v[86:87] op_sel:[0,1,0] op_sel_hi:[1,1,1]
    v_pk_fma_f32 v[88:89], v[188:189], v[236:237], v[88:89] op_sel:[0,1,0] op_sel_hi:[1,1,1]
    v_pk_fma_f32 v[90:91], v[190:191], v[236:237], v[90:91] op_sel:[0,1,0] op_sel_hi:[1,1,1]
    v_pk_fma_f32 v[92:93], v[192:193], v[236:237], v[92:93] op_sel:[0,1,0] op_sel_hi:[1,1,1]
    s_lshl_b32 s66, s52, 18
    s_add_u32 m0, s63, 1024
    s_add_u32 s66, s66, s49
    buffer_load_dwordx4 v240, s[16:19], s66 offen sc1 lds
    v_pk_fma_f32 v[94:95], v[194:195], v[236:237], v[94:95] op_sel:[0,1,0] op_sel_hi:[1,1,1]
    v_pk_fma_f32 v[96:97], v[196:197], v[236:237], v[96:97] op_sel:[0,1,0] op_sel_hi:[1,1,1]
    v_pk_fma_f32 v[98:99], v[198:199], v[236:237], v[98:99] op_sel:[0,1,0] op_sel_hi:[1,1,1]
    v_pk_mul_f32 v[36:37], v[68:69], v[68:69]
    v_pk_mul_f32 v[38:39], v[70:71], v[70:71]
    v_pk_mul_f32 v[40:41], v[72:73], v[72:73]
    v_pk_mul_f32 v[42:43], v[74:75], v[74:75]
    s_lshl_b32 s66, s26, 3
    s_add_u32 s66, s66, 28311552
    buffer_load_dwordx2 v[216:217], v247, s[16:19], s66 offen sc1
    buffer_load_dwordx2 v[218:219], v247, s[16:19], s66 offen offset:128 sc1
    v_pk_mul_f32 v[44:45], v[76:77], v[76:77]
    v_pk_mul_f32 v[46:47], v[78:79], v[78:79]
    v_pk_mul_f32 v[48:49], v[80:81], v[80:81]
    v_pk_mul_f32 v[50:51], v[82:83], v[82:83]
    v_pk_fma_f32 v[36:37], v[36:37], v[236:237], v[234:235] op_sel:[0,0,1] op_sel_hi:[1,0,1]
    v_pk_fma_f32 v[38:39], v[38:39], v[236:237], v[234:235] op_sel:[0,0,1] op_sel_hi:[1,0,1]
    v_pk_fma_f32 v[40:41], v[40:41], v[236:237], v[234:235] op_sel:[0,0,1] op_sel_hi:[1,0,1]
    s_lshl_b32 s66, s50, 13
    s_add_u32 s66, s66, s57
    s_add_u32 s66, s66, 34209792
    buffer_load_dwordx4 v[184:187], v240, s[16:19], s66 offen sc1
    v_pk_fma_f32 v[42:43], v[42:43], v[236:237], v[234:235] op_sel:[0,0,1] op_sel_hi:[1,0,1]
    v_pk_fma_f32 v[44:45], v[44:45], v[236:237], v[234:235] op_sel:[0,0,1] op_sel_hi:[1,0,1]
    v_pk_fma_f32 v[46:47], v[46:47], v[236:237], v[234:235] op_sel:[0,0,1] op_sel_hi:[1,0,1]
    v_pk_fma_f32 v[48:49], v[48:49], v[236:237], v[234:235] op_sel:[0,0,1] op_sel_hi:[1,0,1]
    v_pk_fma_f32 v[50:51], v[50:51], v[236:237], v[234:235] op_sel:[0,0,1] op_sel_hi:[1,0,1]
    v_pk_mul_f32 v[36:37], v[36:37], v[68:69]
    v_pk_mul_f32 v[38:39], v[38:39], v[70:71]
    s_lshl_b32 s66, s51, 13
    s_add_u32 s66, s66, s57
    s_add_u32 s66, s66, 34209792
    buffer_load_dwordx4 v[188:191], v240, s[16:19], s66 offen sc1
    v_pk_mul_f32 v[40:41], v[40:41], v[72:73]
    v_pk_mul_f32 v[42:43], v[42:43], v[74:75]
    v_pk_mul_f32 v[44:45], v[44:45], v[76:77]
    v_pk_mul_f32 v[46:47], v[46:47], v[78:79]
    v_pk_mul_f32 v[48:49], v[48:49], v[80:81]
    v_pk_mul_f32 v[50:51], v[50:51], v[82:83]
    v_exp_f32 v36, v36
    s_lshl_b32 s66, s52, 13
    s_add_u32 s66, s66, s57
    s_add_u32 s66, s66, 34209792
    s_lshl_b32 s6, s23, 2
    s_add_u32 s66, s66, s6
    buffer_load_dword v192, v240, s[16:19], s66 offen sc1
    v_exp_f32 v37, v37
    v_exp_f32 v38, v38
    v_exp_f32 v39, v39
    v_exp_f32 v40, v40
    v_exp_f32 v41, v41
    v_exp_f32 v42, v42
    v_exp_f32 v43, v43
    s_add_u32 m0, s89, 0
    s_add_u32 s90, s31, 626688
    buffer_load_dwordx4 v250, s[12:15], s90 offen  lds
    v_exp_f32 v44, v44
    v_exp_f32 v45, v45
    v_exp_f32 v46, v46
    v_exp_f32 v47, v47
    v_exp_f32 v48, v48
    v_exp_f32 v49, v49
    v_exp_f32 v50, v50
    s_add_u32 m0, s89, 4096
    s_add_u32 s90, s31, 0
    buffer_load_dwordx4 v250, s[12:15], s90 offen  lds
    v_exp_f32 v51, v51
    v_pk_add_f32 v[36:37], v[36:37], 1.0 op_sel_hi:[1,0]
    v_pk_add_f32 v[38:39], v[38:39], 1.0 op_sel_hi:[1,0]
    v_pk_add_f32 v[40:41], v[40:41], 1.0 op_sel_hi:[1,0]
    v_pk_add_f32 v[42:43], v[42:43], 1.0 op_sel_hi:[1,0]
    v_pk_add_f32 v[44:45], v[44:45], 1.0 op_sel_hi:[1,0]
    v_pk_add_f32 v[46:47], v[46:47], 1.0 op_sel_hi:[1,0]
    s_add_u32 m0, s89, 8192
    s_add_u32 s90, s31, 36864
    buffer_load_dwordx4 v250, s[12:15], s90 offen  lds
    v_pk_add_f32 v[48:49], v[48:49], 1.0 op_sel_hi:[1,0]
    v_pk_add_f32 v[50:51], v[50:51], 1.0 op_sel_hi:[1,0]
    v_rcp_f32 v36, v36
    v_rcp_f32 v37, v37
    v_rcp_f32 v38, v38
    v_rcp_f32 v39, v39
    v_rcp_f32 v40, v40
    s_add_u32 m0, s89, 12288
    s_add_u32 s90, s31, 73728
    buffer_load_dwordx4 v250, s[12:15], s90 offen  lds
    v_rcp_f32 v41, v41
    v_rcp_f32 v42, v42
    v_rcp_f32 v43, v43
    v_rcp_f32 v44, v44
    v_rcp_f32 v45, v45
    v_rcp_f32 v46, v46
    v_rcp_f32 v47, v47
    s_add_u32 m0, s89, 16384
    s_add_u32 s90, s31, 110592
    buffer_load_dwordx4 v250, s[12:15], s90 offen  lds
    v_rcp_f32 v48, v48
    v_rcp_f32 v49, v49
    v_rcp_f32 v50, v50
    v_rcp_f32 v51, v51
    v_pk_mul_f32 v[68:69], v[68:69], v[36:37]
    v_pk_mul_f32 v[70:71], v[70:71], v[38:39]
    v_pk_mul_f32 v[72:73], v[72:73], v[40:41]
    s_add_u32 m0, s89, 20480
    s_add_u32 s90, s31, 147456
    buffer_load_dwordx4 v250, s[12:15], s90 offen  lds
    v_pk_mul_f32 v[74:75], v[74:75], v[42:43]
    v_pk_mul_f32 v[76:77], v[76:77], v[44:45]
    v_pk_mul_f32 v[78:79], v[78:79], v[46:47]
    v_pk_mul_f32 v[80:81], v[80:81], v[48:49]
    v_pk_mul_f32 v[82:83], v[82:83], v[50:51]
    v_cvt_pk_bf16_f32 v208, v68, v69
    v_cvt_pk_bf16_f32 v209, v70, v71
    s_add_u32 m0, s89, 24576
    s_add_u32 s90, s31, 184320
    buffer_load_dwordx4 v250, s[12:15], s90 offen  lds
    v_cvt_pk_bf16_f32 v210, v76, v77
    v_cvt_pk_bf16_f32 v211, v78, v79
    ds_write_b128 v244, v[208:211] offset:57344
    v_cvt_pk_bf16_f32 v212, v72, v73
    v_cvt_pk_bf16_f32 v213, v74, v75
    v_cvt_pk_bf16_f32 v214, v80, v81
    v_cvt_pk_bf16_f32 v215, v82, v83
    s_add_u32 m0, s89, 28672
    s_add_u32 s90, s31, 221184
    buffer_load_dwordx4 v250, s[12:15], s90 offen  lds
    ds_write_b128 v244, v[212:215] offset:57856
    v_pk_mul_f32 v[52:53], v[84:85], v[84:85]
    v_pk_mul_f32 v[54:55], v[86:87], v[86:87]
    v_pk_mul_f32 v[56:57], v[88:89], v[88:89]
    v_pk_mul_f32 v[58:59], v[90:91], v[90:91]
    v_pk_mul_f32 v[60:61], v[92:93], v[92:93]
    v_pk_mul_f32 v[62:63], v[94:95], v[94:95]
    s_add_u32 m0, s89, 32768
    s_add_u32 s90, s31, 258048
    buffer_load_dwordx4 v250, s[12:15], s90 offen  lds
    v_pk_mul_f32 v[64:65], v[96:97], v[96:97]
    v_pk_mul_f32 v[66:67], v[98:99], v[98:99]
    v_pk_fma_f32 v[52:53], v[52:53], v[238:239], v[238:239] op_sel:[0,1,0] op_sel_hi:[1,1,0]
    v_pk_fma_f32 v[54:55], v[54:55], v[238:239], v[238:239] op_sel:[0,1,0] op_sel_hi:[1,1,0]
    v_pk_fma_f32 v[56:57], v[56:57], v[238:239], v[238:239] op_sel:[0,1,0] op_sel_hi:[1,1,0]
    v_pk_fma_f32 v[58:59], v[58:59], v[238:239], v[238:239] op_sel:[0,1,0] op_sel_hi:[1,1,0]
    v_pk_fma_f32 v[60:61], v[60:61], v[238:239], v[238:239] op_sel:[0,1,0] op_sel_hi:[1,1,0]
    s_add_u32 m0, s89, 36864
    s_add_u32 s90, s31, 294912
    buffer_load_dwordx4 v250, s[12:15], s90 offen  lds
    v_pk_fma_f32 v[62:63], v[62:63], v[238:239], v[238:239] op_sel:[0,1,0] op_sel_hi:[1,1,0]
    v_pk_fma_f32 v[64:65], v[64:65], v[238:239], v[238:239] op_sel:[0,1,0] op_sel_hi:[1,1,0]
    v_pk_fma_f32 v[66:67], v[66:67], v[238:239], v[238:239] op_sel:[0,1,0] op_sel_hi:[1,1,0]
    v_pk_mul_f32 v[52:53], v[52:53], v[84:85]
    v_pk_mul_f32 v[54:55], v[54:55], v[86:87]
    v_pk_mul_f32 v[56:57], v[56:57], v[88:89]
    v_pk_mul_f32 v[58:59], v[58:59], v[90:91]
    ds_read_b128 a[160:163], v240 offset:40960
    ds_read_b128 a[164:167], v240 offset:41984
    ds_read_b128 a[168:171], v240 offset:43008
    ds_read_b128 a[172:175], v240 offset:44032
    v_pk_mul_f32 v[60:61], v[60:61], v[92:93]
    v_pk_mul_f32 v[62:63], v[62:63], v[94:95]
    v_pk_mul_f32 v[64:65], v[64:65], v[96:97]
    v_pk_mul_f32 v[66:67], v[66:67], v[98:99]
    v_exp_f32 v52, v52
    v_exp_f32 v53, v53
    v_exp_f32 v54, v54
    ds_read_b128 a[176:179], v240 offset:45056
    ds_read_b128 a[180:183], v240 offset:46080
    ds_read_b128 a[184:187], v240 offset:47104
    ds_read_b128 a[188:191], v240 offset:48128
    v_exp_f32 v55, v55
    v_exp_f32 v56, v56
    v_exp_f32 v57, v57
    v_exp_f32 v58, v58
    v_exp_f32 v59, v59
    v_exp_f32 v60, v60
    v_exp_f32 v61, v61
    ds_read_b128 a[192:195], v240 offset:49152
    ds_read_b128 a[196:199], v240 offset:50176
    ds_read_b128 a[200:203], v240 offset:51200
    ds_read_b128 a[204:207], v240 offset:52224
    v_exp_f32 v62, v62
    v_exp_f32 v63, v63
    v_exp_f32 v64, v64
    v_exp_f32 v65, v65
    v_exp_f32 v66, v66
    v_exp_f32 v67, v67
    v_pk_add_f32 v[52:53], v[52:53], 1.0 op_sel_hi:[1,0]
    ds_read_b128 a[208:211], v240 offset:53248
    ds_read_b128 a[212:215], v240 offset:54272
    ds_read_b128 a[216:219], v240 offset:55296
    ds_read_b128 a[220:223], v240 offset:56320
    v_pk_add_f32 v[54:55], v[54:55], 1.0 op_sel_hi:[1,0]
    v_pk_add_f32 v[56:57], v[56:57], 1.0 op_sel_hi:[1,0]
    v_pk_add_f32 v[58:59], v[58:59], 1.0 op_sel_hi:[1,0]
    v_pk_add_f32 v[60:61], v[60:61], 1.0 op_sel_hi:[1,0]
    v_pk_add_f32 v[62:63], v[62:63], 1.0 op_sel_hi:[1,0]
    v_pk_add_f32 v[64:65], v[64:65], 1.0 op_sel_hi:[1,0]
    v_pk_add_f32 v[66:67], v[66:67], 1.0 op_sel_hi:[1,0]
    v_rcp_f32 v52, v52
    v_rcp_f32 v53, v53
    v_rcp_f32 v54, v54
    v_rcp_f32 v55, v55
    v_rcp_f32 v56, v56
    v_rcp_f32 v57, v57
    v_rcp_f32 v58, v58
    v_rcp_f32 v59, v59
    v_rcp_f32 v60, v60
    v_rcp_f32 v61, v61
    v_rcp_f32 v62, v62
    v_rcp_f32 v63, v63
    v_rcp_f32 v64, v64
    v_rcp_f32 v65, v65
    v_rcp_f32 v66, v66
    v_rcp_f32 v67, v67
    v_pk_mul_f32 v[84:85], v[84:85], v[52:53]
    v_pk_mul_f32 v[86:87], v[86:87], v[54:55]
    v_pk_mul_f32 v[88:89], v[88:89], v[56:57]
    v_pk_mul_f32 v[90:91], v[90:91], v[58:59]
    v_pk_mul_f32 v[92:93], v[92:93], v[60:61]
    v_pk_mul_f32 v[94:95], v[94:95], v[62:63]
    v_pk_mul_f32 v[96:97], v[96:97], v[64:65]
    v_pk_mul_f32 v[98:99], v[98:99], v[66:67]
    v_cvt_pk_bf16_f32 v200, v84, v85
    v_cvt_pk_bf16_f32 v201, v86, v87
    v_cvt_pk_bf16_f32 v202, v92, v93
    v_cvt_pk_bf16_f32 v203, v94, v95
    ds_write_b128 v245, v[200:203] offset:57344
    v_cvt_pk_bf16_f32 v204, v88, v89
    v_cvt_pk_bf16_f32 v205, v90, v91
    v_cvt_pk_bf16_f32 v206, v96, v97
    v_cvt_pk_bf16_f32 v207, v98, v99
    ds_write_b128 v245, v[204:207] offset:57856
    s_waitcnt vmcnt(28)
    s_waitcnt lgkmcnt(0)
    s_barrier
    v_mfma_f32_16x16x32_bf16 v[36:39], v[100:103], a[0:3], 0
    ds_read_b64_tr_b16 v[112:113], v252 offset:36864
    ds_read_b64_tr_b16 v[114:115], v252 offset:38912
    ds_read_b128 a[224:227], v240 offset:57344
    v_mfma_f32_16x16x32_bf16 v[40:43], v[100:103], a[4:7], 0
    ds_read_b128 a[228:231], v240 offset:58368
    v_mfma_f32_16x16x32_bf16 v[44:47], v[100:103], a[8:11], 0
    ds_read_b128 a[232:235], v240 offset:59392
    v_mfma_f32_16x16x32_bf16 v[48:51], v[100:103], a[12:15], 0
    ds_read_b128 a[236:239], v240 offset:60416
    v_mfma_f32_16x16x32_bf16 v[36:39], v[104:107], a[16:19], v[36:39]
    ds_read_b64_tr_b16 v[116:117], v252 offset:40960
    ds_read_b64_tr_b16 v[118:119], v252 offset:43008
    ds_read_b128 a[240:243], v240 offset:61440
    v_mfma_f32_16x16x32_bf16 v[40:43], v[104:107], a[20:23], v[40:43]
    ds_read_b128 a[244:247], v240 offset:62464
    v_mfma_f32_16x16x32_bf16 v[44:47], v[104:107], a[24:27], v[44:47]
    ds_read_b128 a[248:251], v240 offset:63488
    v_mfma_f32_16x16x32_bf16 v[48:51], v[104:107], a[28:31], v[48:51]
    ds_read_b128 a[252:255], v240 offset:64512
    v_mfma_f32_16x16x32_bf16 v[36:39], v[108:111], a[32:35], v[36:39]
    ds_read_b64_tr_b16 v[100:101], v252 offset:45056
    ds_read_b64_tr_b16 v[102:103], v252 offset:47104
    ds_read_b128 v[4:7], v243 offset:0
    v_mfma_f32_16x16x32_bf16 v[40:43], v[108:111], a[36:39], v[40:43]
    ds_read_b128 v[8:11], v243 offset:1024
    v_mfma_f32_16x16x32_bf16 v[44:47], v[108:111], a[40:43], v[44:47]
    ds_read_b128 v[12:15], v243 offset:2048
    v_mfma_f32_16x16x32_bf16 v[48:51], v[108:111], a[44:47], v[48:51]
    ds_read_b128 v[16:19], v243 offset:3072
    s_waitcnt lgkmcnt(15)
    v_mfma_f32_16x16x32_bf16 v[36:39], v[112:115], a[48:51], v[36:39]
    ds_read_b64_tr_b16 v[104:105], v252 offset:49152
    ds_read_b64_tr_b16 v[106:107], v252 offset:51200
    ds_read_b128 v[20:23], v243 offset:4096
    v_mfma_f32_16x16x32_bf16 v[40:43], v[112:115], a[52:55], v[40:43]
    ds_read_b128 v[24:27], v243 offset:5120
    v_mfma_f32_16x16x32_bf16 v[44:47], v[112:115], a[56:59], v[44:47]
    ds_read_b128 v[28:31], v243 offset:6144
    v_mfma_f32_16x16x32_bf16 v[48:51], v[112:115], a[60:63], v[48:51]
    ds_read_b128 v[32:35], v243 offset:7168
    s_waitcnt lgkmcnt(15)
    v_mfma_f32_16x16x32_bf16 v[36:39], v[116:119], a[64:67], v[36:39]
    ds_read_b64_tr_b16 v[108:109], v252 offset:53248
    ds_read_b64_tr_b16 v[110:111], v252 offset:55296
    v_mfma_f32_16x16x32_bf16 v[40:43], v[116:119], a[68:71], v[40:43]
    v_mfma_f32_16x16x32_bf16 v[44:47], v[116:119], a[72:75], v[44:47]
    v_mfma_f32_16x16x32_bf16 v[48:51], v[116:119], a[76:79], v[48:51]
    s_waitcnt lgkmcnt(12)
    v_mfma_f32_16x16x32_bf16 v[36:39], v[100:103], a[80:83], v[36:39]
    ds_read_b64_tr_b16 v[112:113], v252 offset:57344
    ds_read_b64_tr_b16 v[114:115], v252 offset:59392
    v_mfma_f32_16x16x32_bf16 v[40:43], v[100:103], a[84:87], v[40:43]
    v_mfma_f32_16x16x32_bf16 v[44:47], v[100:103], a[88:91], v[44:47]
    v_mfma_f32_16x16x32_bf16 v[48:51], v[100:103], a[92:95], v[48:51]
    s_waitcnt vmcnt(22)
    s_barrier
    s_waitcnt lgkmcnt(8)
    v_mfma_f32_16x16x32_bf16 v[36:39], v[104:107], a[96:99], v[36:39]
    ds_read_b64_tr_b16 v[116:117], v253 offset:0
    ds_read_b64_tr_b16 v[118:119], v253 offset:2048
    s_mov_b32 s66, 0
    v_mfma_f32_16x16x32_bf16 v[40:43], v[104:107], a[100:103], v[40:43]
    v_and_b32 v144, 31, v0
    v_lshrrev_b32 v145, 5, v0
    v_lshlrev_b32 v145, 4, v145
    v_mul_u32_u24 v204, 1152, v144
    v_mfma_f32_16x16x32_bf16 v[44:47], v[104:107], a[104:107], v[44:47]
    v_add_u32 v204, v204, v145
    s_waitcnt vmcnt(10)
    v_lshrrev_b32 v144, 2, v0
    v_and_b32 v145, 3, v0
    v_lshlrev_b32 v145, 3, v145
    v_mfma_f32_16x16x32_bf16 v[48:51], v[104:107], a[108:111], v[48:51]
    v_lshl_add_u32 v144, v144, 6, v145
    s_lshl_b32 s58, s66, 5
    s_add_u32 s58, s58, s61
    s_waitcnt lgkmcnt(4)
    v_mfma_f32_16x16x32_bf16 v[36:39], v[108:111], a[112:115], v[36:39]
    ds_read_b64_tr_b16 v[100:101], v253 offset:4096
    ds_read_b64_tr_b16 v[102:103], v253 offset:6144
    v_add_u32 v144, s58, v144
    v_mfma_f32_16x16x32_bf16 v[40:43], v[108:111], a[116:119], v[40:43]
    ds_read_b64_tr_b16 v[120:121], v144 offset:1024
    ds_read_b64_tr_b16 v[122:123], v144 offset:1056
    s_mul_i32 s58, s66, 18432
    s_add_u32 s58, s58, s39
    v_mfma_f32_16x16x32_bf16 v[44:47], v[108:111], a[120:123], v[44:47]
    v_add_u32 v204, s58, v204
    s_lshl_b32 s58, s50, 7
    v_add_u32 v204, s58, v204
    v_lshlrev_b32 v124, 16, v184
    v_and_b32 v125, 0xffff0000, v184
    v_mfma_f32_16x16x32_bf16 v[48:51], v[108:111], a[124:127], v[48:51]
    v_lshlrev_b32 v126, 16, v185
    v_and_b32 v127, 0xffff0000, v185
    v_lshlrev_b32 v128, 16, v186
    s_waitcnt lgkmcnt(6)
    v_mfma_f32_16x16x32_bf16 v[36:39], v[112:115], a[128:131], v[36:39]
    ds_read_b64_tr_b16 v[104:105], v253 offset:8192
    ds_read_b64_tr_b16 v[106:107], v253 offset:10240
    v_mfma_f32_16x16x32_bf16 v[40:43], v[112:115], a[132:135], v[40:43]
    v_and_b32 v129, 0xffff0000, v186
    v_lshlrev_b32 v130, 16, v187
    v_and_b32 v131, 0xffff0000, v187
    v_sub_f32 v124, v124, v216
    v_sub_f32 v125, v125, v216
    v_mfma_f32_16x16x32_bf16 v[44:47], v[112:115], a[136:139], v[44:47]
    v_sub_f32 v126, v126, v216
    v_sub_f32 v127, v127, v216
    v_sub_f32 v128, v128, v218
    v_sub_f32 v129, v129, v218
    v_sub_f32 v130, v130, v218
    v_mfma_f32_16x16x32_bf16 v[48:51], v[112:115], a[140:143], v[48:51]
    v_sub_f32 v131, v131, v218
    v_cvt_pk_bf16_f32 v140, v124, v125
    v_cvt_pk_bf16_f32 v141, v126, v127
    s_waitcnt lgkmcnt(6)
    v_mfma_f32_16x16x32_bf16 v[36:39], v[116:119], a[144:147], v[36:39]
    ds_read_b64_tr_b16 v[108:109], v253 offset:12288
    ds_read_b64_tr_b16 v[110:111], v253 offset:14336
    v_mfma_f32_16x16x32_bf16 v[40:43], v[116:119], a[148:151], v[40:43]
    s_add_u32 m0, s89, 40960
    s_add_u32 s90, s31, 331776
    v_cvt_pk_bf16_f32 v142, v128, v129
    v_mfma_f32_16x16x32_bf16 v[44:47], v[116:119], a[152:155], v[44:47]
    buffer_load_dwordx4 v250, s[12:15], s90 offen  lds
    v_cvt_pk_bf16_f32 v143, v130, v131
    v_lshlrev_b32 v124, 16, v140
    v_mfma_f32_16x16x32_bf16 v[48:51], v[116:119], a[156:159], v[48:51]
    v_and_b32 v125, 0xffff0000, v140
    v_lshlrev_b32 v126, 16, v141
    s_waitcnt lgkmcnt(6)
    v_mfma_f32_16x16x32_bf16 v[36:39], v[100:103], a[160:163], v[36:39]
    ds_read_b64_tr_b16 v[112:113], v253 offset:16384
    ds_read_b64_tr_b16 v[114:115], v253 offset:18432
    v_and_b32 v127, 0xffff0000, v141
    v_mfma_f32_16x16x32_bf16 v[40:43], v[100:103], a[164:167], v[40:43]
    s_add_u32 m0, s89, 45056
    s_add_u32 s90, s31, 368640
    v_lshlrev_b32 v128, 16, v142
    v_mfma_f32_16x16x32_bf16 v[44:47], v[100:103], a[168:171], v[44:47]
    buffer_load_dwordx4 v250, s[12:15], s90 offen  lds
    v_and_b32 v129, 0xffff0000, v142
    v_mfma_f32_16x16x32_bf16 v[48:51], v[100:103], a[172:175], v[48:51]
    v_lshlrev_b32 v130, 16, v143
    v_and_b32 v131, 0xffff0000, v143
    v_mul_f32 v124, v124, v217
    s_waitcnt lgkmcnt(4)
    v_mfma_f32_16x16x32_bf16 v[36:39], v[104:107], a[176:179], v[36:39]
    ds_read_b64_tr_b16 v[116:117], v253 offset:20480
    ds_read_b64_tr_b16 v[118:119], v253 offset:22528
    v_mul_f32 v125, v125, v217
    v_mfma_f32_16x16x32_bf16 v[40:43], v[104:107], a[180:183], v[40:43]
    s_add_u32 m0, s89, 49152
    s_add_u32 s90, s31, 405504
    v_mul_f32 v126, v126, v217
    v_mfma_f32_16x16x32_bf16 v[44:47], v[104:107], a[184:187], v[44:47]
    buffer_load_dwordx4 v250, s[12:15], s90 offen  lds
    v_mul_f32 v127, v127, v217
    v_mfma_f32_16x16x32_bf16 v[48:51], v[104:107], a[188:191], v[48:51]
    v_mul_f32 v128, v128, v219
    v_mul_f32 v129, v129, v219
    v_mul_f32 v130, v130, v219
    s_waitcnt vmcnt(11)
    s_barrier
    s_waitcnt lgkmcnt(4)
    v_mfma_f32_16x16x32_bf16 v[36:39], v[108:111], a[192:195], v[36:39]
    ds_read_b64_tr_b16 v[100:101], v253 offset:24576
    ds_read_b64_tr_b16 v[102:103], v253 offset:26624
    v_mfma_f32_16x16x32_bf16 v[40:43], v[108:111], a[196:199], v[40:43]
    s_add_u32 m0, s89, 53248
    s_add_u32 s90, s31, 442368
    v_mul_f32 v131, v131, v219
    v_mfma_f32_16x16x32_bf16 v[44:47], v[108:111], a[200:203], v[44:47]
    buffer_load_dwordx4 v250, s[12:15], s90 offen  lds
    v_cvt_pk_bf16_f32 v140, v124, v125
    v_mfma_f32_16x16x32_bf16 v[48:51], v[108:111], a[204:207], v[48:51]
    v_cvt_pk_bf16_f32 v141, v126, v127
    v_cvt_pk_bf16_f32 v142, v128, v129
    v_cvt_pk_bf16_f32 v143, v130, v131
    s_waitcnt lgkmcnt(4)
    v_mfma_f32_16x16x32_bf16 v[36:39], v[112:115], a[208:211], v[36:39]
    ds_read_b64_tr_b16 v[104:105], v253 offset:28672
    ds_read_b64_tr_b16 v[106:107], v253 offset:30720
    v_lshlrev_b32 v124, 16, v140
    v_mfma_f32_16x16x32_bf16 v[40:43], v[112:115], a[212:215], v[40:43]
    s_add_u32 m0, s89, 86016
    s_add_u32 s90, s31, 479232
    v_and_b32 v125, 0xffff0000, v140
    v_mfma_f32_16x16x32_bf16 v[44:47], v[112:115], a[216:219], v[44:47]
    buffer_load_dwordx4 v250, s[12:15], s90 offen  lds
    v_lshlrev_b32 v126, 16, v141
    v_mfma_f32_16x16x32_bf16 v[48:51], v[112:115], a[220:223], v[48:51]
    v_and_b32 v127, 0xffff0000, v141
    v_lshlrev_b32 v128, 16, v142
    v_and_b32 v129, 0xffff0000, v142
    s_waitcnt lgkmcnt(4)
    v_mfma_f32_16x16x32_bf16 v[36:39], v[116:119], a[224:227], v[36:39]
    ds_read_b64_tr_b16 v[108:109], v253 offset:32768
    ds_read_b64_tr_b16 v[110:111], v253 offset:34816
    v_lshlrev_b32 v130, 16, v143
    v_mfma_f32_16x16x32_bf16 v[40:43], v[116:119], a[228:231], v[40:43]
    s_add_u32 m0, s89, 90112
    s_add_u32 s90, s31, 516096
    v_and_b32 v131, 0xffff0000, v143
    v_mfma_f32_16x16x32_bf16 v[44:47], v[116:119], a[232:235], v[44:47]
    buffer_load_dwordx4 v250, s[12:15], s90 offen  lds
    v_mfma_f32_16x16x32_bf16 v[48:51], v[116:119], a[236:239], v[48:51]
    v_lshlrev_b32 v132, 16, v120
    v_and_b32 v133, 0xffff0000, v120
    v_lshlrev_b32 v134, 16, v121
    s_waitcnt lgkmcnt(4)
    v_mfma_f32_16x16x32_bf16 v[36:39], v[100:103], a[240:243], v[36:39]
    ds_read_b64_tr_b16 v[112:113], v253 offset:36864
    ds_read_b64_tr_b16 v[114:115], v253 offset:38912
    v_and_b32 v135, 0xffff0000, v121
    v_mfma_f32_16x16x32_bf16 v[40:43], v[100:103], a[244:247], v[40:43]
    s_add_u32 m0, s89, 94208
    s_add_u32 s90, s31, 552960
    v_lshlrev_b32 v136, 16, v122
    v_mfma_f32_16x16x32_bf16 v[44:47], v[100:103], a[248:251], v[44:47]
    buffer_load_dwordx4 v250, s[12:15], s90 offen  lds
    v_and_b32 v137, 0xffff0000, v122
    v_mfma_f32_16x16x32_bf16 v[48:51], v[100:103], a[252:255], v[48:51]
    v_lshlrev_b32 v138, 16, v123
    v_and_b32 v139, 0xffff0000, v123
    v_mul_f32 v124, v124, v132
    s_waitcnt lgkmcnt(4)
    v_mfma_f32_16x16x32_bf16 v[36:39], v[104:107], v[4:7], v[36:39]
    ds_read_b64_tr_b16 v[116:117], v251 offset:0
    ds_read_b64_tr_b16 v[118:119], v251 offset:2048
    v_mfma_f32_16x16x32_bf16 v[40:43], v[104:107], v[8:11], v[40:43]
    s_add_u32 m0, s89, 98304
    s_add_u32 s90, s32, 589824
    v_mul_f32 v125, v125, v133
    v_mfma_f32_16x16x32_bf16 v[44:47], v[104:107], v[12:15], v[44:47]
    buffer_load_dwordx4 v250, s[12:15], s90 offen  lds
    v_mul_f32 v126, v126, v134
    v_mfma_f32_16x16x32_bf16 v[48:51], v[104:107], v[16:19], v[48:51]
    v_mul_f32 v127, v127, v135
    v_mul_f32 v128, v128, v136
    v_mul_f32 v129, v129, v137
    s_waitcnt lgkmcnt(4)
    v_mfma_f32_16x16x32_bf16 v[36:39], v[108:111], v[20:23], v[36:39]
    ds_read_b64_tr_b16 v[100:101], v251 offset:4096
    ds_read_b64_tr_b16 v[102:103], v251 offset:6144
    v_mul_f32 v130, v130, v138
    v_mfma_f32_16x16x32_bf16 v[40:43], v[108:111], v[24:27], v[40:43]
    s_add_u32 m0, s89, 102400
    s_add_u32 s90, s32, 626688
    v_mul_f32 v131, v131, v139
    v_mfma_f32_16x16x32_bf16 v[44:47], v[108:111], v[28:31], v[44:47]
    buffer_load_dwordx4 v250, s[12:15], s90 offen  lds
    v_cvt_pk_bf16_f32 v196, v124, v125
    v_mfma_f32_16x16x32_bf16 v[48:51], v[108:111], v[32:35], v[48:51]
    v_cvt_pk_bf16_f32 v197, v126, v127
    v_cvt_pk_bf16_f32 v198, v128, v129
    v_cvt_pk_bf16_f32 v199, v130, v131
    s_waitcnt vmcnt(11)
    s_barrier
    s_waitcnt lgkmcnt(4)
    v_mfma_f32_16x16x32_bf16 v[52:55], v[112:115], a[0:3], 0
    ds_read_b64_tr_b16 v[104:105], v251 offset:8192
    ds_read_b64_tr_b16 v[106:107], v251 offset:10240
    v_mfma_f32_16x16x32_bf16 v[56:59], v[112:115], a[4:7], 0
    s_add_u32 m0, s89, 106496
    s_add_u32 s90, s32, 0
    v_mfma_f32_16x16x32_bf16 v[60:63], v[112:115], a[8:11], 0
    buffer_load_dwordx4 v250, s[12:15], s90 offen  lds
    s_add_u32 s65, s40, s60
    v_mfma_f32_16x16x32_bf16 v[64:67], v[112:115], a[12:15], 0
    v_cvt_pk_bf16_f32 v208, v36, v37
    s_waitcnt lgkmcnt(4)
    v_mfma_f32_16x16x32_bf16 v[52:55], v[116:119], a[16:19], v[52:55]
    ds_read_b64_tr_b16 v[108:109], v251 offset:12288
    ds_read_b64_tr_b16 v[110:111], v251 offset:14336
    v_mfma_f32_16x16x32_bf16 v[56:59], v[116:119], a[20:23], v[56:59]
    s_add_u32 m0, s89, 57344
    s_add_u32 s90, s32, 36864
    v_cvt_pk_bf16_f32 v209, v38, v39
    v_mfma_f32_16x16x32_bf16 v[60:63], v[116:119], a[24:27], v[60:63]
    buffer_load_dwordx4 v250, s[12:15], s90 offen  lds
    v_cvt_pk_bf16_f32 v210, v40, v41
    v_mfma_f32_16x16x32_bf16 v[64:67], v[116:119], a[28:31], v[64:67]
    v_cvt_pk_bf16_f32 v211, v42, v43
    s_waitcnt lgkmcnt(4)
    v_mfma_f32_16x16x32_bf16 v[52:55], v[100:103], a[32:35], v[52:55]
    ds_read_b64_tr_b16 v[112:113], v251 offset:16384
    ds_read_b64_tr_b16 v[114:115], v251 offset:18432
    v_mfma_f32_16x16x32_bf16 v[56:59], v[100:103], a[36:39], v[56:59]
    s_add_u32 m0, s89, 61440
    s_add_u32 s90, s32, 73728
    v_mfma_f32_16x16x32_bf16 v[60:63], v[100:103], a[40:43], v[60:63]
    buffer_load_dwordx4 v250, s[12:15], s90 offen  lds
    s_cmp_eq_u32 s91, 0
    s_cbranch_scc1 FS_49
    buffer_store_dwordx4 v[208:211], v240, s[16:19], s65 offen sc1
    s_branch FE_50
FS_49:
    ds_write_b128 v243, v[208:211] offset:10496
FE_50:
    v_mfma_f32_16x16x32_bf16 v[64:67], v[100:103], a[44:47], v[64:67]
    v_cvt_pk_bf16_f32 v212, v44, v45
    s_waitcnt lgkmcnt(4)
    v_mfma_f32_16x16x32_bf16 v[52:55], v[104:107], a[48:51], v[52:55]
    ds_read_b64_tr_b16 v[116:117], v251 offset:20480
    ds_read_b64_tr_b16 v[118:119], v251 offset:22528
    v_mfma_f32_16x16x32_bf16 v[56:59], v[104:107], a[52:55], v[56:59]
    s_add_u32 m0, s89, 65536
    s_add_u32 s90, s32, 110592
    v_cvt_pk_bf16_f32 v213, v46, v47
    v_mfma_f32_16x16x32_bf16 v[60:63], v[104:107], a[56:59], v[60:63]
    buffer_load_dwordx4 v250, s[12:15], s90 offen  lds
    v_mfma_f32_16x16x32_bf16 v[64:67], v[104:107], a[60:63], v[64:67]
    v_cvt_pk_bf16_f32 v214, v48, v49
    v_cvt_pk_bf16_f32 v215, v50, v51
    s_waitcnt lgkmcnt(4)
    v_mfma_f32_16x16x32_bf16 v[52:55], v[108:111], a[64:67], v[52:55]
    ds_read_b64_tr_b16 v[100:101], v251 offset:24576
    ds_read_b64_tr_b16 v[102:103], v251 offset:26624
    v_mfma_f32_16x16x32_bf16 v[56:59], v[108:111], a[68:71], v[56:59]
    s_add_u32 m0, s89, 69632
    s_add_u32 s90, s32, 147456
    s_add_u32 s65, s65, 4096
    v_mfma_f32_16x16x32_bf16 v[60:63], v[108:111], a[72:75], v[60:63]
    buffer_load_dwordx4 v250, s[12:15], s90 offen  lds
    v_mfma_f32_16x16x32_bf16 v[64:67], v[108:111], a[76:79], v[64:67]
    s_cmp_eq_u32 s91, 1
    s_cbranch_scc1 FS_51
    buffer_store_dwordx4 v[212:215], v240, s[16:19], s65 offen sc1
    s_branch FE_52
FS_51:
    ds_write_b128 v243, v[212:215] offset:10496
FE_52:
    s_waitcnt lgkmcnt(4)
    v_mfma_f32_16x16x32_bf16 v[52:55], v[112:115], a[80:83], v[52:55]
    ds_read_b64_tr_b16 v[104:105], v251 offset:28672
    ds_read_b64_tr_b16 v[106:107], v251 offset:30720
    v_mfma_f32_16x16x32_bf16 v[56:59], v[112:115], a[84:87], v[56:59]
    s_add_u32 m0, s89, 110592
    s_add_u32 s90, s32, 184320
    v_mfma_f32_16x16x32_bf16 v[60:63], v[112:115], a[88:91], v[60:63]
    buffer_load_dwordx4 v250, s[12:15], s90 offen  lds
    v_mfma_f32_16x16x32_bf16 v[64:67], v[112:115], a[92:95], v[64:67]
    s_waitcnt vmcnt(11)
    s_barrier
    s_waitcnt lgkmcnt(4)
    v_mfma_f32_16x16x32_bf16 v[52:55], v[116:119], a[96:99], v[52:55]
    ds_read_b64_tr_b16 v[108:109], v251 offset:32768
    ds_read_b64_tr_b16 v[110:111], v251 offset:34816
    s_mov_b32 s66, 0
    v_mfma_f32_16x16x32_bf16 v[56:59], v[116:119], a[100:103], v[56:59]
    s_add_u32 m0, s89, 114688
    s_add_u32 s90, s32, 221184
    v_and_b32 v144, 31, v0
    v_mfma_f32_16x16x32_bf16 v[60:63], v[116:119], a[104:107], v[60:63]
    buffer_load_dwordx4 v250, s[12:15], s90 offen  lds
    v_lshrrev_b32 v145, 5, v0
    v_lshlrev_b32 v145, 4, v145
    v_mfma_f32_16x16x32_bf16 v[64:67], v[116:119], a[108:111], v[64:67]
    v_mul_u32_u24 v205, 1152, v144
    v_add_u32 v205, v205, v145
    v_lshrrev_b32 v144, 2, v0
    s_waitcnt lgkmcnt(4)
    v_mfma_f32_16x16x32_bf16 v[52:55], v[100:103], a[112:115], v[52:55]
    ds_read_b64_tr_b16 v[112:113], v251 offset:36864
    ds_read_b64_tr_b16 v[114:115], v251 offset:38912
    v_and_b32 v145, 3, v0
    v_mfma_f32_16x16x32_bf16 v[56:59], v[100:103], a[116:119], v[56:59]
    s_add_u32 m0, s89, 118784
    s_add_u32 s90, s32, 258048
    v_lshlrev_b32 v145, 3, v145
    v_mfma_f32_16x16x32_bf16 v[60:63], v[100:103], a[120:123], v[60:63]
    buffer_load_dwordx4 v250, s[12:15], s90 offen  lds
    v_lshl_add_u32 v144, v144, 6, v145
    s_lshl_b32 s58, s66, 5
    v_mfma_f32_16x16x32_bf16 v[64:67], v[100:103], a[124:127], v[64:67]
    s_add_u32 s58, s58, s62
    v_add_u32 v144, s58, v144
    ds_read_b64_tr_b16 v[120:121], v144 offset:1024
    s_waitcnt lgkmcnt(5)
    v_mfma_f32_16x16x32_bf16 v[52:55], v[104:107], a[128:131], v[52:55]
    ds_read_b64_tr_b16 v[116:117], v251 offset:40960
    ds_read_b64_tr_b16 v[118:119], v251 offset:43008
    ds_read_b64_tr_b16 v[122:123], v144 offset:1056
    v_mfma_f32_16x16x32_bf16 v[56:59], v[104:107], a[132:135], v[56:59]
    s_add_u32 m0, s89, 122880
    s_add_u32 s90, s32, 294912
    s_mul_i32 s58, s66, 18432
    v_mfma_f32_16x16x32_bf16 v[60:63], v[104:107], a[136:139], v[60:63]
    buffer_load_dwordx4 v250, s[12:15], s90 offen  lds
    s_add_u32 s58, s58, s39
    v_add_u32 v205, s58, v205
    v_mfma_f32_16x16x32_bf16 v[64:67], v[104:107], a[140:143], v[64:67]
    s_lshl_b32 s58, s51, 7
    v_add_u32 v205, s58, v205
    v_lshlrev_b32 v124, 16, v188
    s_waitcnt lgkmcnt(6)
    v_mfma_f32_16x16x32_bf16 v[52:55], v[108:111], a[144:147], v[52:55]
    ds_read_b64_tr_b16 v[100:101], v251 offset:45056
    ds_read_b64_tr_b16 v[102:103], v251 offset:47104
    v_and_b32 v125, 0xffff0000, v188
    v_mfma_f32_16x16x32_bf16 v[56:59], v[108:111], a[148:151], v[56:59]
    s_add_u32 m0, s89, 126976
    s_add_u32 s90, s32, 331776
    v_lshlrev_b32 v126, 16, v189
    v_and_b32 v127, 0xffff0000, v189
    v_mfma_f32_16x16x32_bf16 v[60:63], v[108:111], a[152:155], v[60:63]
    buffer_load_dwordx4 v250, s[12:15], s90 offen  lds
    v_lshlrev_b32 v128, 16, v190
    v_mfma_f32_16x16x32_bf16 v[64:67], v[108:111], a[156:159], v[64:67]
    v_and_b32 v129, 0xffff0000, v190
    v_lshlrev_b32 v130, 16, v191
    v_and_b32 v131, 0xffff0000, v191
    v_sub_f32 v124, v124, v216
    s_waitcnt lgkmcnt(6)
    v_mfma_f32_16x16x32_bf16 v[52:55], v[112:115], a[160:163], v[52:55]
    ds_read_b64_tr_b16 v[104:105], v251 offset:49152
    ds_read_b64_tr_b16 v[106:107], v251 offset:51200
    v_sub_f32 v125, v125, v216
    v_mfma_f32_16x16x32_bf16 v[56:59], v[112:115], a[164:167], v[56:59]
    s_add_u32 m0, s89, 131072
    s_add_u32 s90, s32, 368640
    v_sub_f32 v126, v126, v216
    v_mfma_f32_16x16x32_bf16 v[60:63], v[112:115], a[168:171], v[60:63]
    buffer_load_dwordx4 v250, s[12:15], s90 offen  lds
    v_sub_f32 v127, v127, v216
    v_sub_f32 v128, v128, v218
    v_mfma_f32_16x16x32_bf16 v[64:67], v[112:115], a[172:175], v[64:67]
    v_sub_f32 v129, v129, v218
    v_sub_f32 v130, v130, v218
    v_sub_f32 v131, v131, v218
    s_waitcnt lgkmcnt(5)
    v_mfma_f32_16x16x32_bf16 v[52:55], v[116:119], a[176:179], v[52:55]
    ds_read_b64_tr_b16 v[108:109], v251 offset:53248
    ds_read_b64_tr_b16 v[110:111], v251 offset:55296
    v_cvt_pk_bf16_f32 v140, v124, v125
    v_mfma_f32_16x16x32_bf16 v[56:59], v[116:119], a[180:183], v[56:59]
    s_add_u32 m0, s89, 135168
    s_add_u32 s90, s32, 405504
    v_cvt_pk_bf16_f32 v141, v126, v127
    v_cvt_pk_bf16_f32 v142, v128, v129
    v_mfma_f32_16x16x32_bf16 v[60:63], v[116:119], a[184:187], v[60:63]
    buffer_load_dwordx4 v250, s[12:15], s90 offen  lds
    v_cvt_pk_bf16_f32 v143, v130, v131
    v_mfma_f32_16x16x32_bf16 v[64:67], v[116:119], a[188:191], v[64:67]
    v_lshlrev_b32 v124, 16, v140
    v_and_b32 v125, 0xffff0000, v140
    v_lshlrev_b32 v126, 16, v141
    v_and_b32 v127, 0xffff0000, v141
    s_waitcnt vmcnt(11)
    s_barrier
    s_waitcnt lgkmcnt(4)
    v_mfma_f32_16x16x32_bf16 v[52:55], v[100:103], a[192:195], v[52:55]
    ds_read_b64_tr_b16 v[112:113], v252 offset:24576
    ds_read_b64_tr_b16 v[114:115], v252 offset:26624
    v_lshlrev_b32 v128, 16, v142
    v_mfma_f32_16x16x32_bf16 v[56:59], v[100:103], a[196:199], v[56:59]
    s_add_u32 m0, s89, 139264
    s_add_u32 s90, s32, 442368
    v_and_b32 v129, 0xffff0000, v142
    v_mfma_f32_16x16x32_bf16 v[60:63], v[100:103], a[200:203], v[60:63]
    buffer_load_dwordx4 v250, s[12:15], s90 offen  lds
    v_lshlrev_b32 v130, 16, v143
    v_mfma_f32_16x16x32_bf16 v[64:67], v[100:103], a[204:207], v[64:67]
    v_and_b32 v131, 0xffff0000, v143
    v_mul_f32 v124, v124, v217
    v_mul_f32 v125, v125, v217
    v_mul_f32 v126, v126, v217
    s_waitcnt lgkmcnt(4)
    v_mfma_f32_16x16x32_bf16 v[52:55], v[104:107], a[208:211], v[52:55]
    ds_read_b64_tr_b16 v[116:117], v252 offset:28672
    ds_read_b64_tr_b16 v[118:119], v252 offset:30720
    v_mul_f32 v127, v127, v217
    v_mfma_f32_16x16x32_bf16 v[56:59], v[104:107], a[212:215], v[56:59]
    s_add_u32 m0, s89, 143360
    s_add_u32 s90, s32, 479232
    v_mul_f32 v128, v128, v219
    v_mfma_f32_16x16x32_bf16 v[60:63], v[104:107], a[216:219], v[60:63]
    buffer_load_dwordx4 v250, s[12:15], s90 offen  lds
    v_mul_f32 v129, v129, v219
    v_mul_f32 v130, v130, v219
    v_mfma_f32_16x16x32_bf16 v[64:67], v[104:107], a[220:223], v[64:67]
    v_mul_f32 v131, v131, v219
    v_cvt_pk_bf16_f32 v140, v124, v125
    v_cvt_pk_bf16_f32 v141, v126, v127
    v_cvt_pk_bf16_f32 v142, v128, v129
    s_waitcnt lgkmcnt(4)
    v_mfma_f32_16x16x32_bf16 v[52:55], v[108:111], a[224:227], v[52:55]
    ds_read_b64_tr_b16 v[100:101], v252 offset:32768
    ds_read_b64_tr_b16 v[102:103], v252 offset:34816
    v_mfma_f32_16x16x32_bf16 v[56:59], v[108:111], a[228:231], v[56:59]
    s_add_u32 m0, s89, 147456
    s_add_u32 s90, s32, 516096
    v_cvt_pk_bf16_f32 v143, v130, v131
    v_lshlrev_b32 v124, 16, v140
    v_mfma_f32_16x16x32_bf16 v[60:63], v[108:111], a[232:235], v[60:63]
    buffer_load_dwordx4 v250, s[12:15], s90 offen  lds
    v_and_b32 v125, 0xffff0000, v140
    v_mfma_f32_16x16x32_bf16 v[64:67], v[108:111], a[236:239], v[64:67]
    v_lshlrev_b32 v126, 16, v141
    v_and_b32 v127, 0xffff0000, v141
    v_lshlrev_b32 v128, 16, v142
    v_and_b32 v129, 0xffff0000, v142
    s_waitcnt lgkmcnt(4)
    v_mfma_f32_16x16x32_bf16 v[52:55], v[112:115], a[240:243], v[52:55]
    ds_read_b64_tr_b16 v[104:105], v252 offset:36864
    ds_read_b64_tr_b16 v[106:107], v252 offset:38912
    v_lshlrev_b32 v130, 16, v143
    v_mfma_f32_16x16x32_bf16 v[56:59], v[112:115], a[244:247], v[56:59]
    s_add_u32 m0, s89, 151552
    s_add_u32 s90, s32, 552960
    v_and_b32 v131, 0xffff0000, v143
    v_mfma_f32_16x16x32_bf16 v[60:63], v[112:115], a[248:251], v[60:63]
    buffer_load_dwordx4 v250, s[12:15], s90 offen  lds
    v_lshlrev_b32 v132, 16, v120
    v_mfma_f32_16x16x32_bf16 v[64:67], v[112:115], a[252:255], v[64:67]
    v_and_b32 v133, 0xffff0000, v120
    v_lshlrev_b32 v134, 16, v121
    v_and_b32 v135, 0xffff0000, v121
    v_lshlrev_b32 v136, 16, v122
    s_waitcnt lgkmcnt(4)
    v_mfma_f32_16x16x32_bf16 v[52:55], v[116:119], v[4:7], v[52:55]
    ds_read_b64_tr_b16 v[108:109], v252 offset:40960
    ds_read_b64_tr_b16 v[110:111], v252 offset:43008
    v_and_b32 v137, 0xffff0000, v122
    v_mfma_f32_16x16x32_bf16 v[56:59], v[116:119], v[8:11], v[56:59]
    s_add_u32 m0, s89, 155648
    s_add_u32 s90, s33, 589824
    v_lshlrev_b32 v138, 16, v123
    v_mfma_f32_16x16x32_bf16 v[60:63], v[116:119], v[12:15], v[60:63]
    buffer_load_dwordx4 v250, s[12:15], s90 offen  lds
    v_and_b32 v139, 0xffff0000, v123
    v_mul_f32 v124, v124, v132
    v_mfma_f32_16x16x32_bf16 v[64:67], v[116:119], v[16:19], v[64:67]
    v_mul_f32 v125, v125, v133
    v_mul_f32 v126, v126, v134
    v_mul_f32 v127, v127, v135
    v_mul_f32 v128, v128, v136
    s_waitcnt lgkmcnt(4)
    v_mfma_f32_16x16x32_bf16 v[52:55], v[100:103], v[20:23], v[52:55]
    ds_read_b64_tr_b16 v[112:113], v252 offset:45056
    ds_read_b64_tr_b16 v[114:115], v252 offset:47104
    v_mfma_f32_16x16x32_bf16 v[56:59], v[100:103], v[24:27], v[56:59]
    s_add_u32 m0, s89, 159744
    s_add_u32 s90, s33, 626688
    v_mul_f32 v129, v129, v137
    v_mul_f32 v130, v130, v138
    v_mfma_f32_16x16x32_bf16 v[60:63], v[100:103], v[28:31], v[60:63]
    buffer_load_dwordx4 v250, s[12:15], s90 offen  lds
    v_mul_f32 v131, v131, v139
    v_mfma_f32_16x16x32_bf16 v[64:67], v[100:103], v[32:35], v[64:67]
    v_cvt_pk_bf16_f32 v200, v124, v125
    v_cvt_pk_bf16_f32 v201, v126, v127
    v_cvt_pk_bf16_f32 v202, v128, v129
    v_cvt_pk_bf16_f32 v203, v130, v131
    s_waitcnt vmcnt(11)
    s_barrier
    s_waitcnt lgkmcnt(4)
    v_mfma_f32_16x16x32_bf16 v[68:71], v[104:107], a[0:3], 0
    ds_read_b64_tr_b16 v[116:117], v251 offset:57344
    ds_read_b64_tr_b16 v[118:119], v251 offset:59392
    v_mfma_f32_16x16x32_bf16 v[72:75], v[104:107], a[4:7], 0
    s_add_u32 m0, s89, 0
    s_add_u32 s90, s33, 0
    v_mfma_f32_16x16x32_bf16 v[76:79], v[104:107], a[8:11], 0
    buffer_load_dwordx4 v250, s[12:15], s90 offen  lds
    s_add_u32 s65, s41, s60
    v_mfma_f32_16x16x32_bf16 v[80:83], v[104:107], a[12:15], 0
    v_cvt_pk_bf16_f32 v208, v52, v53
    s_waitcnt lgkmcnt(4)
    v_mfma_f32_16x16x32_bf16 v[68:71], v[108:111], a[16:19], v[68:71]
    ds_read_b64_tr_b16 v[100:101], v252 offset:0
    ds_read_b64_tr_b16 v[102:103], v252 offset:2048
    v_mfma_f32_16x16x32_bf16 v[72:75], v[108:111], a[20:23], v[72:75]
    s_add_u32 m0, s89, 4096
    s_add_u32 s90, s33, 36864
    v_cvt_pk_bf16_f32 v209, v54, v55
    v_mfma_f32_16x16x32_bf16 v[76:79], v[108:111], a[24:27], v[76:79]
    buffer_load_dwordx4 v250, s[12:15], s90 offen  lds
    v_cvt_pk_bf16_f32 v210, v56, v57
    v_mfma_f32_16x16x32_bf16 v[80:83], v[108:111], a[28:31], v[80:83]
    v_cvt_pk_bf16_f32 v211, v58, v59
    s_waitcnt lgkmcnt(4)
    v_mfma_f32_16x16x32_bf16 v[68:71], v[112:115], a[32:35], v[68:71]
    ds_read_b64_tr_b16 v[104:105], v252 offset:4096
    ds_read_b64_tr_b16 v[106:107], v252 offset:6144
    v_mfma_f32_16x16x32_bf16 v[72:75], v[112:115], a[36:39], v[72:75]
    s_add_u32 m0, s89, 8192
    s_add_u32 s90, s33, 73728
    v_mfma_f32_16x16x32_bf16 v[76:79], v[112:115], a[40:43], v[76:79]
    buffer_load_dwordx4 v250, s[12:15], s90 offen  lds
    s_cmp_eq_u32 s91, 0
    s_cbranch_scc1 FS_53
    buffer_store_dwordx4 v[208:211], v240, s[16:19], s65 offen sc1
    s_branch FE_54
FS_53:
    ds_write_b128 v243, v[208:211] offset:11520
FE_54:
    v_mfma_f32_16x16x32_bf16 v[80:83], v[112:115], a[44:47], v[80:83]
    v_cvt_pk_bf16_f32 v212, v60, v61
    s_waitcnt lgkmcnt(4)
    v_mfma_f32_16x16x32_bf16 v[68:71], v[116:119], a[48:51], v[68:71]
    ds_read_b64_tr_b16 v[108:109], v252 offset:8192
    ds_read_b64_tr_b16 v[110:111], v252 offset:10240
    v_mfma_f32_16x16x32_bf16 v[72:75], v[116:119], a[52:55], v[72:75]
    s_add_u32 m0, s89, 12288
    s_add_u32 s90, s33, 110592
    v_cvt_pk_bf16_f32 v213, v62, v63
    v_mfma_f32_16x16x32_bf16 v[76:79], v[116:119], a[56:59], v[76:79]
    buffer_load_dwordx4 v250, s[12:15], s90 offen  lds
    v_mfma_f32_16x16x32_bf16 v[80:83], v[116:119], a[60:63], v[80:83]
    v_cvt_pk_bf16_f32 v214, v64, v65
    v_cvt_pk_bf16_f32 v215, v66, v67
    s_waitcnt lgkmcnt(4)
    v_mfma_f32_16x16x32_bf16 v[68:71], v[100:103], a[64:67], v[68:71]
    ds_read_b64_tr_b16 v[112:113], v252 offset:49152
    ds_read_b64_tr_b16 v[114:115], v252 offset:51200
    v_mfma_f32_16x16x32_bf16 v[72:75], v[100:103], a[68:71], v[72:75]
    s_add_u32 m0, s89, 16384
    s_add_u32 s90, s33, 147456
    s_add_u32 s65, s65, 4096
    v_mfma_f32_16x16x32_bf16 v[76:79], v[100:103], a[72:75], v[76:79]
    buffer_load_dwordx4 v250, s[12:15], s90 offen  lds
    v_mfma_f32_16x16x32_bf16 v[80:83], v[100:103], a[76:79], v[80:83]
    s_cmp_eq_u32 s91, 1
    s_cbranch_scc1 FS_55
    buffer_store_dwordx4 v[212:215], v240, s[16:19], s65 offen sc1
    s_branch FE_56
FS_55:
    ds_write_b128 v243, v[212:215] offset:11520
FE_56:
    s_waitcnt lgkmcnt(4)
    v_mfma_f32_16x16x32_bf16 v[68:71], v[104:107], a[80:83], v[68:71]
    ds_read_b64_tr_b16 v[116:117], v252 offset:53248
    ds_read_b64_tr_b16 v[118:119], v252 offset:55296
    v_mfma_f32_16x16x32_bf16 v[72:75], v[104:107], a[84:87], v[72:75]
    s_add_u32 m0, s89, 20480
    s_add_u32 s90, s33, 184320
    v_mfma_f32_16x16x32_bf16 v[76:79], v[104:107], a[88:91], v[76:79]
    buffer_load_dwordx4 v250, s[12:15], s90 offen  lds
    v_mfma_f32_16x16x32_bf16 v[80:83], v[104:107], a[92:95], v[80:83]
    s_waitcnt vmcnt(11)
    s_barrier
    s_waitcnt lgkmcnt(4)
    v_mfma_f32_16x16x32_bf16 v[68:71], v[108:111], a[96:99], v[68:71]
    ds_read_b64_tr_b16 v[100:101], v252 offset:57344
    ds_read_b64_tr_b16 v[102:103], v252 offset:59392
    v_mfma_f32_16x16x32_bf16 v[72:75], v[108:111], a[100:103], v[72:75]
    s_add_u32 m0, s89, 24576
    s_add_u32 s90, s33, 221184
    s_lshr_b32 s66, s23, 1
    v_mfma_f32_16x16x32_bf16 v[76:79], v[108:111], a[104:107], v[76:79]
    buffer_load_dwordx4 v250, s[12:15], s90 offen  lds
    v_and_b32 v144, 15, v0
    v_mfma_f32_16x16x32_bf16 v[80:83], v[108:111], a[108:111], v[80:83]
    v_lshrrev_b32 v145, 4, v0
    v_lshlrev_b32 v145, 3, v145
    s_waitcnt lgkmcnt(4)
    v_mfma_f32_16x16x32_bf16 v[68:71], v[112:115], a[112:115], v[68:71]
    ds_read_b64_tr_b16 v[104:105], v253 offset:0
    ds_read_b64_tr_b16 v[106:107], v253 offset:2048
    v_mfma_f32_16x16x32_bf16 v[72:75], v[112:115], a[116:119], v[72:75]
    s_add_u32 m0, s89, 28672
    s_add_u32 s90, s33, 258048
    v_mul_u32_u24 v206, 1152, v144
    v_mfma_f32_16x16x32_bf16 v[76:79], v[112:115], a[120:123], v[76:79]
    buffer_load_dwordx4 v250, s[12:15], s90 offen  lds
    v_add_u32 v206, v206, v145
    v_mfma_f32_16x16x32_bf16 v[80:83], v[112:115], a[124:127], v[80:83]
    v_lshrrev_b32 v144, 2, v0
    s_waitcnt lgkmcnt(4)
    v_mfma_f32_16x16x32_bf16 v[68:71], v[116:119], a[128:131], v[68:71]
    ds_read_b64_tr_b16 v[108:109], v253 offset:4096
    ds_read_b64_tr_b16 v[110:111], v253 offset:6144
    v_and_b32 v145, 3, v0
    v_mfma_f32_16x16x32_bf16 v[72:75], v[116:119], a[132:135], v[72:75]
    s_add_u32 m0, s89, 32768
    s_add_u32 s90, s33, 294912
    v_mfma_f32_16x16x32_bf16 v[76:79], v[116:119], a[136:139], v[76:79]
    buffer_load_dwordx4 v250, s[12:15], s90 offen  lds
    v_lshlrev_b32 v145, 3, v145
    v_mfma_f32_16x16x32_bf16 v[80:83], v[116:119], a[140:143], v[80:83]
    v_lshl_add_u32 v144, v144, 6, v145
    s_lshl_b32 s58, s66, 5
    s_waitcnt lgkmcnt(4)
    v_mfma_f32_16x16x32_bf16 v[68:71], v[100:103], a[144:147], v[68:71]
    ds_read_b64_tr_b16 v[112:113], v253 offset:8192
    ds_read_b64_tr_b16 v[114:115], v253 offset:10240
    s_add_u32 s58, s58, s63
    v_mfma_f32_16x16x32_bf16 v[72:75], v[100:103], a[148:151], v[72:75]
    s_add_u32 m0, s89, 36864
    s_add_u32 s90, s33, 331776
    v_mfma_f32_16x16x32_bf16 v[76:79], v[100:103], a[152:155], v[76:79]
    buffer_load_dwordx4 v250, s[12:15], s90 offen  lds
    v_add_u32 v144, s58, v144
    v_mfma_f32_16x16x32_bf16 v[80:83], v[100:103], a[156:159], v[80:83]
    ds_read_b64_tr_b16 v[120:121], v144 offset:1024
    s_mul_i32 s58, s66, 18432
    s_waitcnt lgkmcnt(5)
    v_mfma_f32_16x16x32_bf16 v[68:71], v[104:107], a[160:163], v[68:71]
    ds_read_b64_tr_b16 v[116:117], v253 offset:12288
    ds_read_b64_tr_b16 v[118:119], v253 offset:14336
    v_mfma_f32_16x16x32_bf16 v[72:75], v[104:107], a[164:167], v[72:75]
    s_add_u32 m0, s89, 40960
    s_add_u32 s90, s33, 368640
    s_add_u32 s58, s58, s39
    v_mfma_f32_16x16x32_bf16 v[76:79], v[104:107], a[168:171], v[76:79]
    buffer_load_dwordx4 v250, s[12:15], s90 offen  lds
    v_add_u32 v206, s58, v206
    v_mfma_f32_16x16x32_bf16 v[80:83], v[104:107], a[172:175], v[80:83]
    s_lshl_b32 s58, s52, 7
    v_add_u32 v206, s58, v206
    s_waitcnt lgkmcnt(5)
    v_mfma_f32_16x16x32_bf16 v[68:71], v[108:111], a[176:179], v[68:71]
    ds_read_b64_tr_b16 v[100:101], v253 offset:16384
    ds_read_b64_tr_b16 v[102:103], v253 offset:18432
    v_mfma_f32_16x16x32_bf16 v[72:75], v[108:111], a[180:183], v[72:75]
    s_add_u32 m0, s89, 45056
    s_add_u32 s90, s33, 405504
    v_mfma_f32_16x16x32_bf16 v[76:79], v[108:111], a[184:187], v[76:79]
    buffer_load_dwordx4 v250, s[12:15], s90 offen  lds
    s_cmp_eq_u32 s66, 1
    s_cselect_b64 vcc, -1, 0
    v_mfma_f32_16x16x32_bf16 v[80:83], v[108:111], a[188:191], v[80:83]
    v_cndmask_b32 v216, v216, v218, vcc
    v_cndmask_b32 v217, v217, v219, vcc
    s_waitcnt vmcnt(11)
    s_barrier
    s_waitcnt lgkmcnt(5)
    v_mfma_f32_16x16x32_bf16 v[68:71], v[112:115], a[192:195], v[68:71]
    ds_read_b64_tr_b16 v[104:105], v253 offset:20480
    ds_read_b64_tr_b16 v[106:107], v253 offset:22528
    v_mfma_f32_16x16x32_bf16 v[72:75], v[112:115], a[196:199], v[72:75]
    s_add_u32 m0, s89, 49152
    s_add_u32 s90, s33, 442368
    s_waitcnt lgkmcnt(6)
    v_mfma_f32_16x16x32_bf16 v[76:79], v[112:115], a[200:203], v[76:79]
    buffer_load_dwordx4 v250, s[12:15], s90 offen  lds
    v_mfma_f32_16x16x32_bf16 v[80:83], v[112:115], a[204:207], v[80:83]
    s_bitcmp1_b32 s23, 0
    s_cselect_b64 vcc, -1, 0
    s_cselect_b32 s58, 4, 0
    s_waitcnt lgkmcnt(4)
    v_mfma_f32_16x16x32_bf16 v[68:71], v[116:119], a[208:211], v[68:71]
    ds_read_b64_tr_b16 v[108:109], v253 offset:24576
    ds_read_b64_tr_b16 v[110:111], v253 offset:26624
    v_mfma_f32_16x16x32_bf16 v[72:75], v[116:119], a[212:215], v[72:75]
    s_add_u32 m0, s89, 53248
    s_add_u32 s90, s33, 479232
    v_cndmask_b32 v120, v120, v121, vcc
    v_mfma_f32_16x16x32_bf16 v[76:79], v[116:119], a[216:219], v[76:79]
    buffer_load_dwordx4 v250, s[12:15], s90 offen  lds
    v_add_u32 v206, s58, v206
    v_mfma_f32_16x16x32_bf16 v[80:83], v[116:119], a[220:223], v[80:83]
    v_lshlrev_b32 v124, 16, v192
    v_and_b32 v125, 0xffff0000, v192
    s_waitcnt lgkmcnt(4)
    v_mfma_f32_16x16x32_bf16 v[68:71], v[100:103], a[224:227], v[68:71]
    ds_read_b64_tr_b16 v[112:113], v253 offset:28672
    ds_read_b64_tr_b16 v[114:115], v253 offset:30720
    v_mfma_f32_16x16x32_bf16 v[72:75], v[100:103], a[228:231], v[72:75]
    s_add_u32 m0, s89, 86016
    s_add_u32 s90, s33, 516096
    v_sub_f32 v124, v124, v216
    v_mfma_f32_16x16x32_bf16 v[76:79], v[100:103], a[232:235], v[76:79]
    buffer_load_dwordx4 v250, s[12:15], s90 offen  lds
    v_sub_f32 v125, v125, v216
    v_mfma_f32_16x16x32_bf16 v[80:83], v[100:103], a[236:239], v[80:83]
    v_cvt_pk_bf16_f32 v140, v124, v125
    v_lshlrev_b32 v124, 16, v140
    s_waitcnt lgkmcnt(4)
    v_mfma_f32_16x16x32_bf16 v[68:71], v[104:107], a[240:243], v[68:71]
    ds_read_b64_tr_b16 v[116:117], v253 offset:32768
    ds_read_b64_tr_b16 v[118:119], v253 offset:34816
    v_mfma_f32_16x16x32_bf16 v[72:75], v[104:107], a[244:247], v[72:75]
    s_add_u32 m0, s89, 90112
    s_add_u32 s90, s33, 552960
    v_and_b32 v125, 0xffff0000, v140
    v_mfma_f32_16x16x32_bf16 v[76:79], v[104:107], a[248:251], v[76:79]
    buffer_load_dwordx4 v250, s[12:15], s90 offen  lds
    v_mul_f32 v124, v124, v217
    v_mfma_f32_16x16x32_bf16 v[80:83], v[104:107], a[252:255], v[80:83]
    v_mul_f32 v125, v125, v217
    v_cvt_pk_bf16_f32 v140, v124, v125
    s_waitcnt lgkmcnt(4)
    v_mfma_f32_16x16x32_bf16 v[68:71], v[108:111], v[4:7], v[68:71]
    ds_read_b64_tr_b16 v[100:101], v253 offset:36864
    ds_read_b64_tr_b16 v[102:103], v253 offset:38912
    v_mfma_f32_16x16x32_bf16 v[72:75], v[108:111], v[8:11], v[72:75]
    s_add_u32 m0, s89, 94208
    s_add_u32 s90, s34, 589824
    v_lshlrev_b32 v124, 16, v140
    v_mfma_f32_16x16x32_bf16 v[76:79], v[108:111], v[12:15], v[76:79]
    buffer_load_dwordx4 v250, s[12:15], s90 offen  lds
    v_and_b32 v125, 0xffff0000, v140
    v_mfma_f32_16x16x32_bf16 v[80:83], v[108:111], v[16:19], v[80:83]
    v_lshlrev_b32 v132, 16, v120
    s_waitcnt lgkmcnt(4)
    v_mfma_f32_16x16x32_bf16 v[68:71], v[112:115], v[20:23], v[68:71]
    ds_read_b64_tr_b16 v[104:105], v251 offset:0
    ds_read_b64_tr_b16 v[106:107], v251 offset:2048
    v_mfma_f32_16x16x32_bf16 v[72:75], v[112:115], v[24:27], v[72:75]
    s_add_u32 m0, s89, 98304
    s_add_u32 s90, s34, 626688
    v_and_b32 v133, 0xffff0000, v120
    v_mfma_f32_16x16x32_bf16 v[76:79], v[112:115], v[28:31], v[76:79]
    buffer_load_dwordx4 v250, s[12:15], s90 offen  lds
    v_mul_f32 v124, v124, v132
    v_mfma_f32_16x16x32_bf16 v[80:83], v[112:115], v[32:35], v[80:83]
    v_mul_f32 v125, v125, v133
    v_cvt_pk_bf16_f32 v194, v124, v125
    s_waitcnt vmcnt(11)
    s_barrier
    s_waitcnt lgkmcnt(4)
    v_mfma_f32_16x16x32_bf16 v[84:87], v[116:119], a[0:3], 0
    ds_read_b64_tr_b16 v[108:109], v251 offset:4096
    ds_read_b64_tr_b16 v[110:111], v251 offset:6144
    v_mfma_f32_16x16x32_bf16 v[88:91], v[116:119], a[4:7], 0
    s_add_u32 m0, s89, 102400
    s_add_u32 s90, s34, 0
    v_mfma_f32_16x16x32_bf16 v[92:95], v[116:119], a[8:11], 0
    buffer_load_dwordx4 v250, s[12:15], s90 offen  lds
    s_add_u32 s65, s42, s60
    v_mfma_f32_16x16x32_bf16 v[96:99], v[116:119], a[12:15], 0
    v_cvt_pk_bf16_f32 v208, v68, v69
    s_waitcnt lgkmcnt(4)
    v_mfma_f32_16x16x32_bf16 v[84:87], v[100:103], a[16:19], v[84:87]
    ds_read_b64_tr_b16 v[112:113], v251 offset:8192
    ds_read_b64_tr_b16 v[114:115], v251 offset:10240
    v_mfma_f32_16x16x32_bf16 v[88:91], v[100:103], a[20:23], v[88:91]
    s_add_u32 m0, s89, 106496
    s_add_u32 s90, s34, 36864
    v_cvt_pk_bf16_f32 v209, v70, v71
    v_mfma_f32_16x16x32_bf16 v[92:95], v[100:103], a[24:27], v[92:95]
    buffer_load_dwordx4 v250, s[12:15], s90 offen  lds
    v_cvt_pk_bf16_f32 v210, v72, v73
    v_mfma_f32_16x16x32_bf16 v[96:99], v[100:103], a[28:31], v[96:99]
    v_cvt_pk_bf16_f32 v211, v74, v75
    s_waitcnt lgkmcnt(4)
    v_mfma_f32_16x16x32_bf16 v[84:87], v[104:107], a[32:35], v[84:87]
    ds_read_b64_tr_b16 v[116:117], v251 offset:12288
    ds_read_b64_tr_b16 v[118:119], v251 offset:14336
    v_mfma_f32_16x16x32_bf16 v[88:91], v[104:107], a[36:39], v[88:91]
    s_add_u32 m0, s89, 57344
    s_add_u32 s90, s34, 73728
    v_mfma_f32_16x16x32_bf16 v[92:95], v[104:107], a[40:43], v[92:95]
    buffer_load_dwordx4 v250, s[12:15], s90 offen  lds
    s_cmp_eq_u32 s91, 0
    s_cbranch_scc1 FS_57
    buffer_store_dwordx4 v[208:211], v240, s[16:19], s65 offen sc1
    s_branch FE_58
FS_57:
    ds_write_b128 v243, v[208:211] offset:12544
FE_58:
    v_mfma_f32_16x16x32_bf16 v[96:99], v[104:107], a[44:47], v[96:99]
    v_cvt_pk_bf16_f32 v212, v76, v77
    s_waitcnt lgkmcnt(4)
    v_mfma_f32_16x16x32_bf16 v[84:87], v[108:111], a[48:51], v[84:87]
    ds_read_b64_tr_b16 v[100:101], v251 offset:16384
    ds_read_b64_tr_b16 v[102:103], v251 offset:18432
    v_mfma_f32_16x16x32_bf16 v[88:91], v[108:111], a[52:55], v[88:91]
    s_add_u32 m0, s89, 61440
    s_add_u32 s90, s34, 110592
    v_cvt_pk_bf16_f32 v213, v78, v79
    v_mfma_f32_16x16x32_bf16 v[92:95], v[108:111], a[56:59], v[92:95]
    buffer_load_dwordx4 v250, s[12:15], s90 offen  lds
    v_mfma_f32_16x16x32_bf16 v[96:99], v[108:111], a[60:63], v[96:99]
    v_cvt_pk_bf16_f32 v214, v80, v81
    v_cvt_pk_bf16_f32 v215, v82, v83
    s_waitcnt lgkmcnt(4)
    v_mfma_f32_16x16x32_bf16 v[84:87], v[112:115], a[64:67], v[84:87]
    ds_read_b64_tr_b16 v[104:105], v251 offset:20480
    ds_read_b64_tr_b16 v[106:107], v251 offset:22528
    v_mfma_f32_16x16x32_bf16 v[88:91], v[112:115], a[68:71], v[88:91]
    s_add_u32 m0, s89, 65536
    s_add_u32 s90, s34, 147456
    s_add_u32 s65, s65, 4096
    v_mfma_f32_16x16x32_bf16 v[92:95], v[112:115], a[72:75], v[92:95]
    buffer_load_dwordx4 v250, s[12:15], s90 offen  lds
    v_mfma_f32_16x16x32_bf16 v[96:99], v[112:115], a[76:79], v[96:99]
    s_cmp_eq_u32 s91, 1
    s_cbranch_scc1 FS_59
    buffer_store_dwordx4 v[212:215], v240, s[16:19], s65 offen sc1
    s_branch FE_60
FS_59:
    ds_write_b128 v243, v[212:215] offset:12544
FE_60:
    s_waitcnt lgkmcnt(4)
    v_mfma_f32_16x16x32_bf16 v[84:87], v[116:119], a[80:83], v[84:87]
    ds_read_b64_tr_b16 v[108:109], v251 offset:24576
    ds_read_b64_tr_b16 v[110:111], v251 offset:26624
    v_mfma_f32_16x16x32_bf16 v[88:91], v[116:119], a[84:87], v[88:91]
    s_add_u32 m0, s89, 69632
    s_add_u32 s90, s34, 184320
    v_mfma_f32_16x16x32_bf16 v[92:95], v[116:119], a[88:91], v[92:95]
    buffer_load_dwordx4 v250, s[12:15], s90 offen  lds
    v_mfma_f32_16x16x32_bf16 v[96:99], v[116:119], a[92:95], v[96:99]
    s_waitcnt vmcnt(11)
    s_barrier
    s_waitcnt lgkmcnt(4)
    v_mfma_f32_16x16x32_bf16 v[84:87], v[100:103], a[96:99], v[84:87]
    ds_read_b64_tr_b16 v[112:113], v251 offset:28672
    ds_read_b64_tr_b16 v[114:115], v251 offset:30720
    v_mfma_f32_16x16x32_bf16 v[88:91], v[100:103], a[100:103], v[88:91]
    s_add_u32 m0, s89, 110592
    s_add_u32 s90, s34, 221184
    v_mfma_f32_16x16x32_bf16 v[92:95], v[100:103], a[104:107], v[92:95]
    buffer_load_dwordx4 v250, s[12:15], s90 offen  lds
    v_mfma_f32_16x16x32_bf16 v[96:99], v[100:103], a[108:111], v[96:99]
    s_waitcnt lgkmcnt(4)
    v_mfma_f32_16x16x32_bf16 v[84:87], v[104:107], a[112:115], v[84:87]
    ds_read_b64_tr_b16 v[116:117], v251 offset:32768
    ds_read_b64_tr_b16 v[118:119], v251 offset:34816
    v_mfma_f32_16x16x32_bf16 v[88:91], v[104:107], a[116:119], v[88:91]
    s_add_u32 m0, s89, 114688
    s_add_u32 s90, s34, 258048
    v_mfma_f32_16x16x32_bf16 v[92:95], v[104:107], a[120:123], v[92:95]
    buffer_load_dwordx4 v250, s[12:15], s90 offen  lds
    v_mfma_f32_16x16x32_bf16 v[96:99], v[104:107], a[124:127], v[96:99]
    s_waitcnt lgkmcnt(4)
    v_mfma_f32_16x16x32_bf16 v[84:87], v[108:111], a[128:131], v[84:87]
    ds_read_b64_tr_b16 v[100:101], v251 offset:36864
    ds_read_b64_tr_b16 v[102:103], v251 offset:38912
    v_mfma_f32_16x16x32_bf16 v[88:91], v[108:111], a[132:135], v[88:91]
    s_add_u32 m0, s89, 118784
    s_add_u32 s90, s34, 294912
    v_mfma_f32_16x16x32_bf16 v[92:95], v[108:111], a[136:139], v[92:95]
    buffer_load_dwordx4 v250, s[12:15], s90 offen  lds
    v_mfma_f32_16x16x32_bf16 v[96:99], v[108:111], a[140:143], v[96:99]
    s_waitcnt lgkmcnt(4)
    v_mfma_f32_16x16x32_bf16 v[84:87], v[112:115], a[144:147], v[84:87]
    ds_read_b64_tr_b16 v[104:105], v251 offset:40960
    ds_read_b64_tr_b16 v[106:107], v251 offset:43008
    v_mfma_f32_16x16x32_bf16 v[88:91], v[112:115], a[148:151], v[88:91]
    s_add_u32 m0, s89, 122880
    s_add_u32 s90, s34, 331776
    v_mfma_f32_16x16x32_bf16 v[92:95], v[112:115], a[152:155], v[92:95]
    buffer_load_dwordx4 v250, s[12:15], s90 offen  lds
    v_mfma_f32_16x16x32_bf16 v[96:99], v[112:115], a[156:159], v[96:99]
    s_waitcnt lgkmcnt(4)
    v_mfma_f32_16x16x32_bf16 v[84:87], v[116:119], a[160:163], v[84:87]
    ds_read_b64_tr_b16 v[108:109], v251 offset:45056
    ds_read_b64_tr_b16 v[110:111], v251 offset:47104
    v_mfma_f32_16x16x32_bf16 v[88:91], v[116:119], a[164:167], v[88:91]
    s_add_u32 m0, s89, 126976
    s_add_u32 s90, s34, 368640
    v_mfma_f32_16x16x32_bf16 v[92:95], v[116:119], a[168:171], v[92:95]
    buffer_load_dwordx4 v250, s[12:15], s90 offen  lds
    v_mfma_f32_16x16x32_bf16 v[96:99], v[116:119], a[172:175], v[96:99]
    s_waitcnt lgkmcnt(4)
    v_mfma_f32_16x16x32_bf16 v[84:87], v[100:103], a[176:179], v[84:87]
    ds_read_b64_tr_b16 v[112:113], v251 offset:49152
    ds_read_b64_tr_b16 v[114:115], v251 offset:51200
    v_mfma_f32_16x16x32_bf16 v[88:91], v[100:103], a[180:183], v[88:91]
    s_add_u32 m0, s89, 131072
    s_add_u32 s90, s34, 405504
    v_mfma_f32_16x16x32_bf16 v[92:95], v[100:103], a[184:187], v[92:95]
    buffer_load_dwordx4 v250, s[12:15], s90 offen  lds
    v_mfma_f32_16x16x32_bf16 v[96:99], v[100:103], a[188:191], v[96:99]
    s_waitcnt vmcnt(11)
    s_barrier
    s_waitcnt lgkmcnt(4)
    v_mfma_f32_16x16x32_bf16 v[84:87], v[104:107], a[192:195], v[84:87]
    ds_read_b64_tr_b16 v[116:117], v251 offset:53248
    ds_read_b64_tr_b16 v[118:119], v251 offset:55296
    v_mfma_f32_16x16x32_bf16 v[88:91], v[104:107], a[196:199], v[88:91]
    s_add_u32 m0, s89, 135168
    s_add_u32 s90, s34, 442368
    v_mfma_f32_16x16x32_bf16 v[92:95], v[104:107], a[200:203], v[92:95]
    buffer_load_dwordx4 v250, s[12:15], s90 offen  lds
    v_mfma_f32_16x16x32_bf16 v[96:99], v[104:107], a[204:207], v[96:99]
    s_waitcnt lgkmcnt(4)
    v_mfma_f32_16x16x32_bf16 v[84:87], v[108:111], a[208:211], v[84:87]
    ds_read_b64_tr_b16 v[100:101], v252 offset:24576
    ds_read_b64_tr_b16 v[102:103], v252 offset:26624
    v_mfma_f32_16x16x32_bf16 v[88:91], v[108:111], a[212:215], v[88:91]
    s_add_u32 m0, s89, 139264
    s_add_u32 s90, s34, 479232
    v_mfma_f32_16x16x32_bf16 v[92:95], v[108:111], a[216:219], v[92:95]
    buffer_load_dwordx4 v250, s[12:15], s90 offen  lds
    v_mfma_f32_16x16x32_bf16 v[96:99], v[108:111], a[220:223], v[96:99]
    s_waitcnt lgkmcnt(4)
    v_mfma_f32_16x16x32_bf16 v[84:87], v[112:115], a[224:227], v[84:87]
    ds_read_b64_tr_b16 v[104:105], v252 offset:28672
    ds_read_b64_tr_b16 v[106:107], v252 offset:30720
    v_mfma_f32_16x16x32_bf16 v[88:91], v[112:115], a[228:231], v[88:91]
    s_add_u32 m0, s89, 143360
    s_add_u32 s90, s34, 516096
    v_mfma_f32_16x16x32_bf16 v[92:95], v[112:115], a[232:235], v[92:95]
    buffer_load_dwordx4 v250, s[12:15], s90 offen  lds
    v_mfma_f32_16x16x32_bf16 v[96:99], v[112:115], a[236:239], v[96:99]
    s_waitcnt lgkmcnt(4)
    v_mfma_f32_16x16x32_bf16 v[84:87], v[116:119], a[240:243], v[84:87]
    ds_read_b64_tr_b16 v[108:109], v252 offset:32768
    ds_read_b64_tr_b16 v[110:111], v252 offset:34816
    v_mfma_f32_16x16x32_bf16 v[88:91], v[116:119], a[244:247], v[88:91]
    s_add_u32 m0, s89, 147456
    s_add_u32 s90, s34, 552960
    v_mfma_f32_16x16x32_bf16 v[92:95], v[116:119], a[248:251], v[92:95]
    buffer_load_dwordx4 v250, s[12:15], s90 offen  lds
    v_mfma_f32_16x16x32_bf16 v[96:99], v[116:119], a[252:255], v[96:99]
    s_waitcnt lgkmcnt(4)
    v_mfma_f32_16x16x32_bf16 v[84:87], v[100:103], v[4:7], v[84:87]
    ds_read_b64_tr_b16 v[112:113], v252 offset:36864
    ds_read_b64_tr_b16 v[114:115], v252 offset:38912
    v_mfma_f32_16x16x32_bf16 v[88:91], v[100:103], v[8:11], v[88:91]
    s_add_u32 m0, s89, 151552
    s_add_u32 s90, s35, 589824
    v_mfma_f32_16x16x32_bf16 v[92:95], v[100:103], v[12:15], v[92:95]
    buffer_load_dwordx4 v250, s[12:15], s90 offen  lds
    v_mfma_f32_16x16x32_bf16 v[96:99], v[100:103], v[16:19], v[96:99]
    s_waitcnt lgkmcnt(4)
    v_mfma_f32_16x16x32_bf16 v[84:87], v[104:107], v[20:23], v[84:87]
    ds_read_b64_tr_b16 v[116:117], v252 offset:40960
    ds_read_b64_tr_b16 v[118:119], v252 offset:43008
    v_mfma_f32_16x16x32_bf16 v[88:91], v[104:107], v[24:27], v[88:91]
    s_add_u32 m0, s89, 155648
    s_add_u32 s90, s35, 626688
    v_mfma_f32_16x16x32_bf16 v[92:95], v[104:107], v[28:31], v[92:95]
    buffer_load_dwordx4 v250, s[12:15], s90 offen  lds
    v_mfma_f32_16x16x32_bf16 v[96:99], v[104:107], v[32:35], v[96:99]
    s_waitcnt vmcnt(11)
    s_barrier
    s_waitcnt lgkmcnt(4)
    v_mfma_f32_16x16x32_bf16 v[36:39], v[108:111], a[0:3], 0
    ds_read_b64_tr_b16 v[100:101], v252 offset:45056
    ds_read_b64_tr_b16 v[102:103], v252 offset:47104
    v_mfma_f32_16x16x32_bf16 v[40:43], v[108:111], a[4:7], 0
    s_add_u32 m0, s89, 159744
    s_add_u32 s90, s35, 0
    v_mfma_f32_16x16x32_bf16 v[44:47], v[108:111], a[8:11], 0
    buffer_load_dwordx4 v250, s[12:15], s90 offen  lds
    s_add_u32 s65, s43, s60
    v_mfma_f32_16x16x32_bf16 v[48:51], v[108:111], a[12:15], 0
    v_cvt_pk_bf16_f32 v208, v84, v85
    s_waitcnt lgkmcnt(4)
    v_mfma_f32_16x16x32_bf16 v[36:39], v[112:115], a[16:19], v[36:39]
    ds_read_b64_tr_b16 v[104:105], v251 offset:57344
    ds_read_b64_tr_b16 v[106:107], v251 offset:59392
    v_mfma_f32_16x16x32_bf16 v[40:43], v[112:115], a[20:23], v[40:43]
    s_add_u32 m0, s89, 0
    s_add_u32 s90, s35, 36864
    v_cvt_pk_bf16_f32 v209, v86, v87
    v_mfma_f32_16x16x32_bf16 v[44:47], v[112:115], a[24:27], v[44:47]
    buffer_load_dwordx4 v250, s[12:15], s90 offen  lds
    v_cvt_pk_bf16_f32 v210, v88, v89
    v_mfma_f32_16x16x32_bf16 v[48:51], v[112:115], a[28:31], v[48:51]
    v_cvt_pk_bf16_f32 v211, v90, v91
    s_waitcnt lgkmcnt(4)
    v_mfma_f32_16x16x32_bf16 v[36:39], v[116:119], a[32:35], v[36:39]
    ds_read_b64_tr_b16 v[108:109], v252 offset:0
    ds_read_b64_tr_b16 v[110:111], v252 offset:2048
    v_mfma_f32_16x16x32_bf16 v[40:43], v[116:119], a[36:39], v[40:43]
    s_add_u32 m0, s89, 4096
    s_add_u32 s90, s35, 73728
    v_mfma_f32_16x16x32_bf16 v[44:47], v[116:119], a[40:43], v[44:47]
    buffer_load_dwordx4 v250, s[12:15], s90 offen  lds
    s_cmp_eq_u32 s91, 0
    s_cbranch_scc1 FS_61
    buffer_store_dwordx4 v[208:211], v240, s[16:19], s65 offen sc1
    s_branch FE_62
FS_61:
    ds_write_b128 v243, v[208:211] offset:13568
FE_62:
    v_mfma_f32_16x16x32_bf16 v[48:51], v[116:119], a[44:47], v[48:51]
    v_cvt_pk_bf16_f32 v212, v92, v93
    s_waitcnt lgkmcnt(4)
    v_mfma_f32_16x16x32_bf16 v[36:39], v[100:103], a[48:51], v[36:39]
    ds_read_b64_tr_b16 v[112:113], v252 offset:4096
    ds_read_b64_tr_b16 v[114:115], v252 offset:6144
    v_mfma_f32_16x16x32_bf16 v[40:43], v[100:103], a[52:55], v[40:43]
    s_add_u32 m0, s89, 8192
    s_add_u32 s90, s35, 110592
    v_cvt_pk_bf16_f32 v213, v94, v95
    v_mfma_f32_16x16x32_bf16 v[44:47], v[100:103], a[56:59], v[44:47]
    buffer_load_dwordx4 v250, s[12:15], s90 offen  lds
    v_mfma_f32_16x16x32_bf16 v[48:51], v[100:103], a[60:63], v[48:51]
    v_cvt_pk_bf16_f32 v214, v96, v97
    v_cvt_pk_bf16_f32 v215, v98, v99
    s_waitcnt lgkmcnt(4)
    v_mfma_f32_16x16x32_bf16 v[36:39], v[104:107], a[64:67], v[36:39]
    ds_read_b64_tr_b16 v[116:117], v252 offset:8192
    ds_read_b64_tr_b16 v[118:119], v252 offset:10240
    v_mfma_f32_16x16x32_bf16 v[40:43], v[104:107], a[68:71], v[40:43]
    s_add_u32 m0, s89, 12288
    s_add_u32 s90, s35, 147456
    s_add_u32 s65, s65, 4096
    v_mfma_f32_16x16x32_bf16 v[44:47], v[104:107], a[72:75], v[44:47]
    buffer_load_dwordx4 v250, s[12:15], s90 offen  lds
    v_mfma_f32_16x16x32_bf16 v[48:51], v[104:107], a[76:79], v[48:51]
    s_cmp_eq_u32 s91, 1
    s_cbranch_scc1 FS_63
    buffer_store_dwordx4 v[212:215], v240, s[16:19], s65 offen sc1
    s_branch FE_64
FS_63:
    ds_write_b128 v243, v[212:215] offset:13568
FE_64:
    s_waitcnt lgkmcnt(4)
    v_mfma_f32_16x16x32_bf16 v[36:39], v[108:111], a[80:83], v[36:39]
    ds_read_b64_tr_b16 v[100:101], v252 offset:49152
    ds_read_b64_tr_b16 v[102:103], v252 offset:51200
    v_mfma_f32_16x16x32_bf16 v[40:43], v[108:111], a[84:87], v[40:43]
    s_add_u32 m0, s89, 16384
    s_add_u32 s90, s35, 184320
    v_mfma_f32_16x16x32_bf16 v[44:47], v[108:111], a[88:91], v[44:47]
    buffer_load_dwordx4 v250, s[12:15], s90 offen  lds
    v_mfma_f32_16x16x32_bf16 v[48:51], v[108:111], a[92:95], v[48:51]
    s_waitcnt vmcnt(11)
    s_barrier
    s_waitcnt lgkmcnt(4)
    v_mfma_f32_16x16x32_bf16 v[36:39], v[112:115], a[96:99], v[36:39]
    ds_read_b64_tr_b16 v[104:105], v252 offset:53248
    ds_read_b64_tr_b16 v[106:107], v252 offset:55296
    v_mfma_f32_16x16x32_bf16 v[40:43], v[112:115], a[100:103], v[40:43]
    s_add_u32 m0, s89, 20480
    s_add_u32 s90, s35, 221184
    v_mfma_f32_16x16x32_bf16 v[44:47], v[112:115], a[104:107], v[44:47]
    buffer_load_dwordx4 v250, s[12:15], s90 offen  lds
    v_mfma_f32_16x16x32_bf16 v[48:51], v[112:115], a[108:111], v[48:51]
    s_waitcnt lgkmcnt(4)
    v_mfma_f32_16x16x32_bf16 v[36:39], v[116:119], a[112:115], v[36:39]
    ds_read_b64_tr_b16 v[108:109], v252 offset:57344
    ds_read_b64_tr_b16 v[110:111], v252 offset:59392
    v_mfma_f32_16x16x32_bf16 v[40:43], v[116:119], a[116:119], v[40:43]
    s_add_u32 m0, s89, 24576
    s_add_u32 s90, s35, 258048
    v_mfma_f32_16x16x32_bf16 v[44:47], v[116:119], a[120:123], v[44:47]
    buffer_load_dwordx4 v250, s[12:15], s90 offen  lds
    v_mfma_f32_16x16x32_bf16 v[48:51], v[116:119], a[124:127], v[48:51]
    s_waitcnt lgkmcnt(4)
    v_mfma_f32_16x16x32_bf16 v[36:39], v[100:103], a[128:131], v[36:39]
    ds_read_b64_tr_b16 v[112:113], v253 offset:0
    ds_read_b64_tr_b16 v[114:115], v253 offset:2048
    v_mfma_f32_16x16x32_bf16 v[40:43], v[100:103], a[132:135], v[40:43]
    s_add_u32 m0, s89, 28672
    s_add_u32 s90, s35, 294912
    v_mfma_f32_16x16x32_bf16 v[44:47], v[100:103], a[136:139], v[44:47]
    buffer_load_dwordx4 v250, s[12:15], s90 offen  lds
    v_mfma_f32_16x16x32_bf16 v[48:51], v[100:103], a[140:143], v[48:51]
    s_waitcnt lgkmcnt(4)
    v_mfma_f32_16x16x32_bf16 v[36:39], v[104:107], a[144:147], v[36:39]
    ds_read_b64_tr_b16 v[116:117], v253 offset:4096
    ds_read_b64_tr_b16 v[118:119], v253 offset:6144
    v_mfma_f32_16x16x32_bf16 v[40:43], v[104:107], a[148:151], v[40:43]
    s_add_u32 m0, s89, 32768
    s_add_u32 s90, s35, 331776
    v_mfma_f32_16x16x32_bf16 v[44:47], v[104:107], a[152:155], v[44:47]
    buffer_load_dwordx4 v250, s[12:15], s90 offen  lds
    v_mfma_f32_16x16x32_bf16 v[48:51], v[104:107], a[156:159], v[48:51]
    s_waitcnt lgkmcnt(4)
    v_mfma_f32_16x16x32_bf16 v[36:39], v[108:111], a[160:163], v[36:39]
    ds_read_b64_tr_b16 v[100:101], v253 offset:8192
    ds_read_b64_tr_b16 v[102:103], v253 offset:10240
    v_mfma_f32_16x16x32_bf16 v[40:43], v[108:111], a[164:167], v[40:43]
    s_add_u32 m0, s89, 36864
    s_add_u32 s90, s35, 368640
    v_mfma_f32_16x16x32_bf16 v[44:47], v[108:111], a[168:171], v[44:47]
    buffer_load_dwordx4 v250, s[12:15], s90 offen  lds
    v_mfma_f32_16x16x32_bf16 v[48:51], v[108:111], a[172:175], v[48:51]
    s_waitcnt lgkmcnt(4)
    v_mfma_f32_16x16x32_bf16 v[36:39], v[112:115], a[176:179], v[36:39]
    ds_read_b64_tr_b16 v[104:105], v253 offset:12288
    ds_read_b64_tr_b16 v[106:107], v253 offset:14336
    v_mfma_f32_16x16x32_bf16 v[40:43], v[112:115], a[180:183], v[40:43]
    s_add_u32 m0, s89, 40960
    s_add_u32 s90, s35, 405504
    v_mfma_f32_16x16x32_bf16 v[44:47], v[112:115], a[184:187], v[44:47]
    buffer_load_dwordx4 v250, s[12:15], s90 offen  lds
    v_mfma_f32_16x16x32_bf16 v[48:51], v[112:115], a[188:191], v[48:51]
    s_waitcnt vmcnt(11)
    s_barrier
    s_waitcnt lgkmcnt(4)
    v_mfma_f32_16x16x32_bf16 v[36:39], v[116:119], a[192:195], v[36:39]
    ds_read_b64_tr_b16 v[108:109], v253 offset:16384
    ds_read_b64_tr_b16 v[110:111], v253 offset:18432
    v_mfma_f32_16x16x32_bf16 v[40:43], v[116:119], a[196:199], v[40:43]
    s_add_u32 m0, s89, 45056
    s_add_u32 s90, s35, 442368
    v_mfma_f32_16x16x32_bf16 v[44:47], v[116:119], a[200:203], v[44:47]
    buffer_load_dwordx4 v250, s[12:15], s90 offen  lds
    v_mfma_f32_16x16x32_bf16 v[48:51], v[116:119], a[204:207], v[48:51]
    s_waitcnt lgkmcnt(4)
    v_mfma_f32_16x16x32_bf16 v[36:39], v[100:103], a[208:211], v[36:39]
    ds_read_b64_tr_b16 v[112:113], v253 offset:20480
    ds_read_b64_tr_b16 v[114:115], v253 offset:22528
    v_mfma_f32_16x16x32_bf16 v[40:43], v[100:103], a[212:215], v[40:43]
    s_add_u32 m0, s89, 49152
    s_add_u32 s90, s35, 479232
    v_mfma_f32_16x16x32_bf16 v[44:47], v[100:103], a[216:219], v[44:47]
    buffer_load_dwordx4 v250, s[12:15], s90 offen  lds
    v_mfma_f32_16x16x32_bf16 v[48:51], v[100:103], a[220:223], v[48:51]
    s_waitcnt lgkmcnt(4)
    v_mfma_f32_16x16x32_bf16 v[36:39], v[104:107], a[224:227], v[36:39]
    ds_read_b64_tr_b16 v[116:117], v253 offset:24576
    ds_read_b64_tr_b16 v[118:119], v253 offset:26624
    v_mfma_f32_16x16x32_bf16 v[40:43], v[104:107], a[228:231], v[40:43]
    s_add_u32 m0, s89, 53248
    s_add_u32 s90, s35, 516096
    v_mfma_f32_16x16x32_bf16 v[44:47], v[104:107], a[232:235], v[44:47]
    buffer_load_dwordx4 v250, s[12:15], s90 offen  lds
    v_mfma_f32_16x16x32_bf16 v[48:51], v[104:107], a[236:239], v[48:51]
    s_waitcnt lgkmcnt(4)
    v_mfma_f32_16x16x32_bf16 v[36:39], v[108:111], a[240:243], v[36:39]
    ds_read_b64_tr_b16 v[100:101], v253 offset:28672
    ds_read_b64_tr_b16 v[102:103], v253 offset:30720
    v_mfma_f32_16x16x32_bf16 v[40:43], v[108:111], a[244:247], v[40:43]
    s_add_u32 m0, s89, 86016
    s_add_u32 s90, s35, 552960
    v_mfma_f32_16x16x32_bf16 v[44:47], v[108:111], a[248:251], v[44:47]
    buffer_load_dwordx4 v250, s[12:15], s90 offen  lds
    v_mfma_f32_16x16x32_bf16 v[48:51], v[108:111], a[252:255], v[48:51]
    s_waitcnt lgkmcnt(4)
    v_mfma_f32_16x16x32_bf16 v[36:39], v[112:115], v[4:7], v[36:39]
    ds_read_b64_tr_b16 v[104:105], v253 offset:32768
    ds_read_b64_tr_b16 v[106:107], v253 offset:34816
    v_mfma_f32_16x16x32_bf16 v[40:43], v[112:115], v[8:11], v[40:43]
    s_add_u32 m0, s89, 90112
    s_add_u32 s90, s36, 589824
    v_mfma_f32_16x16x32_bf16 v[44:47], v[112:115], v[12:15], v[44:47]
    buffer_load_dwordx4 v250, s[12:15], s90 offen  lds
    v_mfma_f32_16x16x32_bf16 v[48:51], v[112:115], v[16:19], v[48:51]
    s_waitcnt lgkmcnt(4)
    v_mfma_f32_16x16x32_bf16 v[36:39], v[116:119], v[20:23], v[36:39]
    ds_read_b64_tr_b16 v[108:109], v253 offset:36864
    ds_read_b64_tr_b16 v[110:111], v253 offset:38912
    v_mfma_f32_16x16x32_bf16 v[40:43], v[116:119], v[24:27], v[40:43]
    s_add_u32 m0, s89, 94208
    s_add_u32 s90, s36, 626688
    v_mfma_f32_16x16x32_bf16 v[44:47], v[116:119], v[28:31], v[44:47]
    buffer_load_dwordx4 v250, s[12:15], s90 offen  lds
    v_mfma_f32_16x16x32_bf16 v[48:51], v[116:119], v[32:35], v[48:51]
    s_waitcnt vmcnt(11)
    s_barrier
    s_waitcnt lgkmcnt(4)
    v_mfma_f32_16x16x32_bf16 v[52:55], v[100:103], a[0:3], 0
    ds_read_b64_tr_b16 v[112:113], v251 offset:0
    ds_read_b64_tr_b16 v[114:115], v251 offset:2048
    v_mfma_f32_16x16x32_bf16 v[56:59], v[100:103], a[4:7], 0
    s_add_u32 m0, s89, 98304
    s_add_u32 s90, s36, 0
    v_mfma_f32_16x16x32_bf16 v[60:63], v[100:103], a[8:11], 0
    buffer_load_dwordx4 v250, s[12:15], s90 offen  lds
    s_add_u32 s65, s44, s60
    v_mfma_f32_16x16x32_bf16 v[64:67], v[100:103], a[12:15], 0
    v_cvt_pk_bf16_f32 v208, v36, v37
    s_waitcnt lgkmcnt(4)
    v_mfma_f32_16x16x32_bf16 v[52:55], v[104:107], a[16:19], v[52:55]
    ds_read_b64_tr_b16 v[116:117], v251 offset:4096
    ds_read_b64_tr_b16 v[118:119], v251 offset:6144
    v_mfma_f32_16x16x32_bf16 v[56:59], v[104:107], a[20:23], v[56:59]
    s_add_u32 m0, s89, 102400
    s_add_u32 s90, s36, 36864
    v_cvt_pk_bf16_f32 v209, v38, v39
    v_mfma_f32_16x16x32_bf16 v[60:63], v[104:107], a[24:27], v[60:63]
    buffer_load_dwordx4 v250, s[12:15], s90 offen  lds
    v_cvt_pk_bf16_f32 v210, v40, v41
    v_mfma_f32_16x16x32_bf16 v[64:67], v[104:107], a[28:31], v[64:67]
    v_cvt_pk_bf16_f32 v211, v42, v43
    s_waitcnt lgkmcnt(4)
    v_mfma_f32_16x16x32_bf16 v[52:55], v[108:111], a[32:35], v[52:55]
    ds_read_b64_tr_b16 v[100:101], v251 offset:8192
    ds_read_b64_tr_b16 v[102:103], v251 offset:10240
    v_mfma_f32_16x16x32_bf16 v[56:59], v[108:111], a[36:39], v[56:59]
    s_add_u32 m0, s89, 106496
    s_add_u32 s90, s36, 73728
    v_mfma_f32_16x16x32_bf16 v[60:63], v[108:111], a[40:43], v[60:63]
    buffer_load_dwordx4 v250, s[12:15], s90 offen  lds
    s_cmp_eq_u32 s91, 0
    s_cbranch_scc1 FS_65
    buffer_store_dwordx4 v[208:211], v240, s[16:19], s65 offen sc1
    s_branch FE_66
FS_65:
    ds_write_b128 v243, v[208:211] offset:14592
FE_66:
    v_mfma_f32_16x16x32_bf16 v[64:67], v[108:111], a[44:47], v[64:67]
    v_cvt_pk_bf16_f32 v212, v44, v45
    s_mov_b32 s5, 1
    s_add_u32 s6, s55, 0
    s_atomic_add s5, s[28:29], s6
    s_waitcnt lgkmcnt(4)
    v_mfma_f32_16x16x32_bf16 v[52:55], v[112:115], a[48:51], v[52:55]
    ds_read_b64_tr_b16 v[104:105], v251 offset:12288
    ds_read_b64_tr_b16 v[106:107], v251 offset:14336
    v_mfma_f32_16x16x32_bf16 v[56:59], v[112:115], a[52:55], v[56:59]
    s_add_u32 m0, s89, 57344
    s_add_u32 s90, s36, 110592
    v_cvt_pk_bf16_f32 v213, v46, v47
    v_mfma_f32_16x16x32_bf16 v[60:63], v[112:115], a[56:59], v[60:63]
    buffer_load_dwordx4 v250, s[12:15], s90 offen  lds
    v_mfma_f32_16x16x32_bf16 v[64:67], v[112:115], a[60:63], v[64:67]
    v_cvt_pk_bf16_f32 v214, v48, v49
    v_cvt_pk_bf16_f32 v215, v50, v51
    s_waitcnt lgkmcnt(4)
    v_mfma_f32_16x16x32_bf16 v[52:55], v[116:119], a[64:67], v[52:55]
    ds_read_b64_tr_b16 v[108:109], v251 offset:16384
    ds_read_b64_tr_b16 v[110:111], v251 offset:18432
    v_mfma_f32_16x16x32_bf16 v[56:59], v[116:119], a[68:71], v[56:59]
    s_add_u32 m0, s89, 61440
    s_add_u32 s90, s36, 147456
    s_add_u32 s65, s65, 4096
    v_mfma_f32_16x16x32_bf16 v[60:63], v[116:119], a[72:75], v[60:63]
    buffer_load_dwordx4 v250, s[12:15], s90 offen  lds
    v_mfma_f32_16x16x32_bf16 v[64:67], v[116:119], a[76:79], v[64:67]
    s_cmp_eq_u32 s91, 1
    s_cbranch_scc1 FS_67
    buffer_store_dwordx4 v[212:215], v240, s[16:19], s65 offen sc1
    s_branch FE_68
FS_67:
    ds_write_b128 v243, v[212:215] offset:14592
FE_68:
    s_waitcnt lgkmcnt(4)
    v_mfma_f32_16x16x32_bf16 v[52:55], v[100:103], a[80:83], v[52:55]
    ds_read_b64_tr_b16 v[112:113], v251 offset:20480
    ds_read_b64_tr_b16 v[114:115], v251 offset:22528
    v_mfma_f32_16x16x32_bf16 v[56:59], v[100:103], a[84:87], v[56:59]
    s_add_u32 m0, s89, 65536
    s_add_u32 s90, s36, 184320
    v_mfma_f32_16x16x32_bf16 v[60:63], v[100:103], a[88:91], v[60:63]
    buffer_load_dwordx4 v250, s[12:15], s90 offen  lds
    v_mfma_f32_16x16x32_bf16 v[64:67], v[100:103], a[92:95], v[64:67]
    s_waitcnt vmcnt(11)
    s_barrier
    s_waitcnt lgkmcnt(4)
    v_mfma_f32_16x16x32_bf16 v[52:55], v[104:107], a[96:99], v[52:55]
    ds_read_b64_tr_b16 v[116:117], v251 offset:24576
    ds_read_b64_tr_b16 v[118:119], v251 offset:26624
    v_mfma_f32_16x16x32_bf16 v[56:59], v[104:107], a[100:103], v[56:59]
    s_add_u32 m0, s89, 69632
    s_add_u32 s90, s36, 221184
    v_mfma_f32_16x16x32_bf16 v[60:63], v[104:107], a[104:107], v[60:63]
    buffer_load_dwordx4 v250, s[12:15], s90 offen  lds
    v_mfma_f32_16x16x32_bf16 v[64:67], v[104:107], a[108:111], v[64:67]
    s_waitcnt lgkmcnt(4)
    v_mfma_f32_16x16x32_bf16 v[52:55], v[108:111], a[112:115], v[52:55]
    ds_read_b64_tr_b16 v[100:101], v251 offset:28672
    ds_read_b64_tr_b16 v[102:103], v251 offset:30720
    v_mfma_f32_16x16x32_bf16 v[56:59], v[108:111], a[116:119], v[56:59]
    s_add_u32 m0, s89, 110592
    s_add_u32 s90, s36, 258048
    v_mfma_f32_16x16x32_bf16 v[60:63], v[108:111], a[120:123], v[60:63]
    buffer_load_dwordx4 v250, s[12:15], s90 offen  lds
    v_mfma_f32_16x16x32_bf16 v[64:67], v[108:111], a[124:127], v[64:67]
    s_waitcnt lgkmcnt(4)
    v_mfma_f32_16x16x32_bf16 v[52:55], v[112:115], a[128:131], v[52:55]
    ds_read_b64_tr_b16 v[104:105], v251 offset:32768
    ds_read_b64_tr_b16 v[106:107], v251 offset:34816
    v_mfma_f32_16x16x32_bf16 v[56:59], v[112:115], a[132:135], v[56:59]
    s_add_u32 m0, s89, 114688
    s_add_u32 s90, s36, 294912
    v_mfma_f32_16x16x32_bf16 v[60:63], v[112:115], a[136:139], v[60:63]
    buffer_load_dwordx4 v250, s[12:15], s90 offen  lds
    v_mfma_f32_16x16x32_bf16 v[64:67], v[112:115], a[140:143], v[64:67]
    s_waitcnt lgkmcnt(4)
    v_mfma_f32_16x16x32_bf16 v[52:55], v[116:119], a[144:147], v[52:55]
    ds_read_b64_tr_b16 v[108:109], v251 offset:36864
    ds_read_b64_tr_b16 v[110:111], v251 offset:38912
    v_mfma_f32_16x16x32_bf16 v[56:59], v[116:119], a[148:151], v[56:59]
    s_add_u32 m0, s89, 118784
    s_add_u32 s90, s36, 331776
    v_mfma_f32_16x16x32_bf16 v[60:63], v[116:119], a[152:155], v[60:63]
    buffer_load_dwordx4 v250, s[12:15], s90 offen  lds
    v_mfma_f32_16x16x32_bf16 v[64:67], v[116:119], a[156:159], v[64:67]
    s_waitcnt lgkmcnt(4)
    v_mfma_f32_16x16x32_bf16 v[52:55], v[100:103], a[160:163], v[52:55]
    ds_read_b64_tr_b16 v[112:113], v251 offset:40960
    ds_read_b64_tr_b16 v[114:115], v251 offset:43008
    v_mfma_f32_16x16x32_bf16 v[56:59], v[100:103], a[164:167], v[56:59]
    s_add_u32 m0, s89, 122880
    s_add_u32 s90, s36, 368640
    v_mfma_f32_16x16x32_bf16 v[60:63], v[100:103], a[168:171], v[60:63]
    buffer_load_dwordx4 v250, s[12:15], s90 offen  lds
    v_mfma_f32_16x16x32_bf16 v[64:67], v[100:103], a[172:175], v[64:67]
    s_waitcnt lgkmcnt(4)
    v_mfma_f32_16x16x32_bf16 v[52:55], v[104:107], a[176:179], v[52:55]
    ds_read_b64_tr_b16 v[116:117], v251 offset:45056
    ds_read_b64_tr_b16 v[118:119], v251 offset:47104
    v_mfma_f32_16x16x32_bf16 v[56:59], v[104:107], a[180:183], v[56:59]
    s_add_u32 m0, s89, 126976
    s_add_u32 s90, s36, 405504
    v_mfma_f32_16x16x32_bf16 v[60:63], v[104:107], a[184:187], v[60:63]
    buffer_load_dwordx4 v250, s[12:15], s90 offen  lds
    v_mfma_f32_16x16x32_bf16 v[64:67], v[104:107], a[188:191], v[64:67]
    s_waitcnt vmcnt(11)
    s_barrier
    s_waitcnt lgkmcnt(4)
    v_mfma_f32_16x16x32_bf16 v[52:55], v[108:111], a[192:195], v[52:55]
    ds_read_b64_tr_b16 v[100:101], v251 offset:49152
    ds_read_b64_tr_b16 v[102:103], v251 offset:51200
    v_mfma_f32_16x16x32_bf16 v[56:59], v[108:111], a[196:199], v[56:59]
    s_add_u32 m0, s89, 131072
    s_add_u32 s90, s36, 442368
    v_mfma_f32_16x16x32_bf16 v[60:63], v[108:111], a[200:203], v[60:63]
    buffer_load_dwordx4 v250, s[12:15], s90 offen  lds
    v_mfma_f32_16x16x32_bf16 v[64:67], v[108:111], a[204:207], v[64:67]
    s_waitcnt lgkmcnt(4)
    v_mfma_f32_16x16x32_bf16 v[52:55], v[112:115], a[208:211], v[52:55]
    ds_read_b64_tr_b16 v[104:105], v251 offset:53248
    ds_read_b64_tr_b16 v[106:107], v251 offset:55296
    v_mfma_f32_16x16x32_bf16 v[56:59], v[112:115], a[212:215], v[56:59]
    s_add_u32 m0, s89, 135168
    s_add_u32 s90, s36, 479232
    v_mfma_f32_16x16x32_bf16 v[60:63], v[112:115], a[216:219], v[60:63]
    buffer_load_dwordx4 v250, s[12:15], s90 offen  lds
    v_mfma_f32_16x16x32_bf16 v[64:67], v[112:115], a[220:223], v[64:67]
    s_waitcnt lgkmcnt(4)
    v_mfma_f32_16x16x32_bf16 v[52:55], v[116:119], a[224:227], v[52:55]
    ds_read_b64_tr_b16 v[108:109], v252 offset:24576
    ds_read_b64_tr_b16 v[110:111], v252 offset:26624
    v_mfma_f32_16x16x32_bf16 v[56:59], v[116:119], a[228:231], v[56:59]
    s_add_u32 m0, s89, 139264
    s_add_u32 s90, s36, 516096
    v_mfma_f32_16x16x32_bf16 v[60:63], v[116:119], a[232:235], v[60:63]
    buffer_load_dwordx4 v250, s[12:15], s90 offen  lds
    v_mfma_f32_16x16x32_bf16 v[64:67], v[116:119], a[236:239], v[64:67]
    s_waitcnt lgkmcnt(4)
    v_mfma_f32_16x16x32_bf16 v[52:55], v[100:103], a[240:243], v[52:55]
    ds_read_b64_tr_b16 v[112:113], v252 offset:28672
    ds_read_b64_tr_b16 v[114:115], v252 offset:30720
    v_mfma_f32_16x16x32_bf16 v[56:59], v[100:103], a[244:247], v[56:59]
    s_add_u32 m0, s89, 143360
    s_add_u32 s90, s36, 552960
    v_mfma_f32_16x16x32_bf16 v[60:63], v[100:103], a[248:251], v[60:63]
    buffer_load_dwordx4 v250, s[12:15], s90 offen  lds
    v_mfma_f32_16x16x32_bf16 v[64:67], v[100:103], a[252:255], v[64:67]
    s_waitcnt lgkmcnt(4)
    v_mfma_f32_16x16x32_bf16 v[52:55], v[104:107], v[4:7], v[52:55]
    ds_read_b64_tr_b16 v[116:117], v252 offset:32768
    ds_read_b64_tr_b16 v[118:119], v252 offset:34816
    v_mfma_f32_16x16x32_bf16 v[56:59], v[104:107], v[8:11], v[56:59]
    s_add_u32 m0, s89, 147456
    s_add_u32 s90, s37, 589824
    v_mfma_f32_16x16x32_bf16 v[60:63], v[104:107], v[12:15], v[60:63]
    buffer_load_dwordx4 v250, s[12:15], s90 offen  lds
    v_mfma_f32_16x16x32_bf16 v[64:67], v[104:107], v[16:19], v[64:67]
    s_waitcnt lgkmcnt(4)
    v_mfma_f32_16x16x32_bf16 v[52:55], v[108:111], v[20:23], v[52:55]
    ds_read_b64_tr_b16 v[100:101], v252 offset:36864
    ds_read_b64_tr_b16 v[102:103], v252 offset:38912
    v_mfma_f32_16x16x32_bf16 v[56:59], v[108:111], v[24:27], v[56:59]
    s_add_u32 m0, s89, 151552
    s_add_u32 s90, s37, 626688
    v_mfma_f32_16x16x32_bf16 v[60:63], v[108:111], v[28:31], v[60:63]
    buffer_load_dwordx4 v250, s[12:15], s90 offen  lds
    v_mfma_f32_16x16x32_bf16 v[64:67], v[108:111], v[32:35], v[64:67]
    s_waitcnt vmcnt(11)
    s_barrier
    s_waitcnt lgkmcnt(4)
    v_mfma_f32_16x16x32_bf16 v[68:71], v[112:115], a[0:3], 0
    ds_read_b64_tr_b16 v[104:105], v252 offset:40960
    ds_read_b64_tr_b16 v[106:107], v252 offset:43008
    v_mfma_f32_16x16x32_bf16 v[72:75], v[112:115], a[4:7], 0
    s_add_u32 m0, s89, 155648
    s_add_u32 s90, s37, 0
    v_mfma_f32_16x16x32_bf16 v[76:79], v[112:115], a[8:11], 0
    buffer_load_dwordx4 v250, s[12:15], s90 offen  lds
    s_add_u32 s65, s45, s60
    v_mfma_f32_16x16x32_bf16 v[80:83], v[112:115], a[12:15], 0
    v_cvt_pk_bf16_f32 v208, v52, v53
    s_waitcnt lgkmcnt(4)
    v_mfma_f32_16x16x32_bf16 v[68:71], v[116:119], a[16:19], v[68:71]
    ds_read_b64_tr_b16 v[108:109], v252 offset:45056
    ds_read_b64_tr_b16 v[110:111], v252 offset:47104
    v_mfma_f32_16x16x32_bf16 v[72:75], v[116:119], a[20:23], v[72:75]
    s_add_u32 m0, s89, 159744
    s_add_u32 s90, s37, 36864
    v_cvt_pk_bf16_f32 v209, v54, v55
    v_mfma_f32_16x16x32_bf16 v[76:79], v[116:119], a[24:27], v[76:79]
    buffer_load_dwordx4 v250, s[12:15], s90 offen  lds
    v_cvt_pk_bf16_f32 v210, v56, v57
    v_mfma_f32_16x16x32_bf16 v[80:83], v[116:119], a[28:31], v[80:83]
    v_cvt_pk_bf16_f32 v211, v58, v59
    s_waitcnt lgkmcnt(4)
    v_mfma_f32_16x16x32_bf16 v[68:71], v[100:103], a[32:35], v[68:71]
    ds_read_b64_tr_b16 v[112:113], v251 offset:57344
    ds_read_b64_tr_b16 v[114:115], v251 offset:59392
    v_mfma_f32_16x16x32_bf16 v[72:75], v[100:103], a[36:39], v[72:75]
    s_add_u32 m0, s89, 0
    s_add_u32 s90, s37, 73728
    v_mfma_f32_16x16x32_bf16 v[76:79], v[100:103], a[40:43], v[76:79]
    buffer_load_dwordx4 v250, s[12:15], s90 offen  lds
    s_cmp_eq_u32 s91, 0
    s_cbranch_scc1 FS_69
    buffer_store_dwordx4 v[208:211], v240, s[16:19], s65 offen sc1
    s_branch FE_70
FS_69:
    ds_write_b128 v243, v[208:211] offset:15616
FE_70:
    v_mfma_f32_16x16x32_bf16 v[80:83], v[100:103], a[44:47], v[80:83]
    v_cvt_pk_bf16_f32 v212, v60, v61
    s_waitcnt lgkmcnt(4)
    v_mfma_f32_16x16x32_bf16 v[68:71], v[104:107], a[48:51], v[68:71]
    ds_read_b64_tr_b16 v[116:117], v252 offset:0
    ds_read_b64_tr_b16 v[118:119], v252 offset:2048
    v_mfma_f32_16x16x32_bf16 v[72:75], v[104:107], a[52:55], v[72:75]
    s_add_u32 m0, s89, 4096
    s_add_u32 s90, s37, 110592
    v_cvt_pk_bf16_f32 v213, v62, v63
    v_mfma_f32_16x16x32_bf16 v[76:79], v[104:107], a[56:59], v[76:79]
    buffer_load_dwordx4 v250, s[12:15], s90 offen  lds
    v_mfma_f32_16x16x32_bf16 v[80:83], v[104:107], a[60:63], v[80:83]
    v_cvt_pk_bf16_f32 v214, v64, v65
    v_cvt_pk_bf16_f32 v215, v66, v67
    s_waitcnt lgkmcnt(4)
    v_mfma_f32_16x16x32_bf16 v[68:71], v[108:111], a[64:67], v[68:71]
    ds_read_b64_tr_b16 v[100:101], v252 offset:4096
    ds_read_b64_tr_b16 v[102:103], v252 offset:6144
    v_mfma_f32_16x16x32_bf16 v[72:75], v[108:111], a[68:71], v[72:75]
    s_add_u32 m0, s89, 8192
    s_add_u32 s90, s37, 147456
    s_add_u32 s65, s65, 4096
    v_mfma_f32_16x16x32_bf16 v[76:79], v[108:111], a[72:75], v[76:79]
    buffer_load_dwordx4 v250, s[12:15], s90 offen  lds
    v_mfma_f32_16x16x32_bf16 v[80:83], v[108:111], a[76:79], v[80:83]
    s_cmp_eq_u32 s91, 1
    s_cbranch_scc1 FS_71
    buffer_store_dwordx4 v[212:215], v240, s[16:19], s65 offen sc1
    s_branch FE_72
FS_71:
    ds_write_b128 v243, v[212:215] offset:15616
FE_72:
    s_waitcnt lgkmcnt(4)
    v_mfma_f32_16x16x32_bf16 v[68:71], v[112:115], a[80:83], v[68:71]
    ds_read_b64_tr_b16 v[104:105], v252 offset:8192
    ds_read_b64_tr_b16 v[106:107], v252 offset:10240
    v_mfma_f32_16x16x32_bf16 v[72:75], v[112:115], a[84:87], v[72:75]
    s_add_u32 m0, s89, 12288
    s_add_u32 s90, s37, 184320
    v_mfma_f32_16x16x32_bf16 v[76:79], v[112:115], a[88:91], v[76:79]
    buffer_load_dwordx4 v250, s[12:15], s90 offen  lds
    v_mfma_f32_16x16x32_bf16 v[80:83], v[112:115], a[92:95], v[80:83]
    s_waitcnt vmcnt(11)
    s_barrier
    s_waitcnt lgkmcnt(4)
    v_mfma_f32_16x16x32_bf16 v[68:71], v[116:119], a[96:99], v[68:71]
    ds_read_b64_tr_b16 v[108:109], v252 offset:49152
    ds_read_b64_tr_b16 v[110:111], v252 offset:51200
    v_mfma_f32_16x16x32_bf16 v[72:75], v[116:119], a[100:103], v[72:75]
    s_add_u32 m0, s89, 16384
    s_add_u32 s90, s37, 221184
    v_mfma_f32_16x16x32_bf16 v[76:79], v[116:119], a[104:107], v[76:79]
    buffer_load_dwordx4 v250, s[12:15], s90 offen  lds
    v_mfma_f32_16x16x32_bf16 v[80:83], v[116:119], a[108:111], v[80:83]
    s_waitcnt lgkmcnt(4)
    v_mfma_f32_16x16x32_bf16 v[68:71], v[100:103], a[112:115], v[68:71]
    ds_read_b64_tr_b16 v[112:113], v252 offset:53248
    ds_read_b64_tr_b16 v[114:115], v252 offset:55296
    v_mfma_f32_16x16x32_bf16 v[72:75], v[100:103], a[116:119], v[72:75]
    s_add_u32 m0, s89, 20480
    s_add_u32 s90, s37, 258048
    v_mfma_f32_16x16x32_bf16 v[76:79], v[100:103], a[120:123], v[76:79]
    buffer_load_dwordx4 v250, s[12:15], s90 offen  lds
    v_mfma_f32_16x16x32_bf16 v[80:83], v[100:103], a[124:127], v[80:83]
    s_waitcnt lgkmcnt(4)
    v_mfma_f32_16x16x32_bf16 v[68:71], v[104:107], a[128:131], v[68:71]
    ds_read_b64_tr_b16 v[116:117], v252 offset:57344
    ds_read_b64_tr_b16 v[118:119], v252 offset:59392
    v_mfma_f32_16x16x32_bf16 v[72:75], v[104:107], a[132:135], v[72:75]
    s_add_u32 m0, s89, 24576
    s_add_u32 s90, s37, 294912
    v_mfma_f32_16x16x32_bf16 v[76:79], v[104:107], a[136:139], v[76:79]
    buffer_load_dwordx4 v250, s[12:15], s90 offen  lds
    v_mfma_f32_16x16x32_bf16 v[80:83], v[104:107], a[140:143], v[80:83]
    s_waitcnt lgkmcnt(4)
    v_mfma_f32_16x16x32_bf16 v[68:71], v[108:111], a[144:147], v[68:71]
    ds_read_b64_tr_b16 v[100:101], v253 offset:0
    ds_read_b64_tr_b16 v[102:103], v253 offset:2048
    v_mfma_f32_16x16x32_bf16 v[72:75], v[108:111], a[148:151], v[72:75]
    s_add_u32 m0, s89, 28672
    s_add_u32 s90, s37, 331776
    v_mfma_f32_16x16x32_bf16 v[76:79], v[108:111], a[152:155], v[76:79]
    buffer_load_dwordx4 v250, s[12:15], s90 offen  lds
    v_mfma_f32_16x16x32_bf16 v[80:83], v[108:111], a[156:159], v[80:83]
    s_waitcnt lgkmcnt(4)
    v_mfma_f32_16x16x32_bf16 v[68:71], v[112:115], a[160:163], v[68:71]
    ds_read_b64_tr_b16 v[104:105], v253 offset:4096
    ds_read_b64_tr_b16 v[106:107], v253 offset:6144
    v_mfma_f32_16x16x32_bf16 v[72:75], v[112:115], a[164:167], v[72:75]
    s_add_u32 m0, s89, 32768
    s_add_u32 s90, s37, 368640
    v_mfma_f32_16x16x32_bf16 v[76:79], v[112:115], a[168:171], v[76:79]
    buffer_load_dwordx4 v250, s[12:15], s90 offen  lds
    v_mfma_f32_16x16x32_bf16 v[80:83], v[112:115], a[172:175], v[80:83]
    s_waitcnt lgkmcnt(4)
    v_mfma_f32_16x16x32_bf16 v[68:71], v[116:119], a[176:179], v[68:71]
    ds_read_b64_tr_b16 v[108:109], v253 offset:8192
    ds_read_b64_tr_b16 v[110:111], v253 offset:10240
    v_mfma_f32_16x16x32_bf16 v[72:75], v[116:119], a[180:183], v[72:75]
    s_add_u32 m0, s89, 36864
    s_add_u32 s90, s37, 405504
    v_mfma_f32_16x16x32_bf16 v[76:79], v[116:119], a[184:187], v[76:79]
    buffer_load_dwordx4 v250, s[12:15], s90 offen  lds
    v_mfma_f32_16x16x32_bf16 v[80:83], v[116:119], a[188:191], v[80:83]
    s_waitcnt vmcnt(11)
    s_barrier
    s_waitcnt lgkmcnt(4)
    v_mfma_f32_16x16x32_bf16 v[68:71], v[100:103], a[192:195], v[68:71]
    ds_read_b64_tr_b16 v[112:113], v253 offset:12288
    ds_read_b64_tr_b16 v[114:115], v253 offset:14336
    v_mfma_f32_16x16x32_bf16 v[72:75], v[100:103], a[196:199], v[72:75]
    s_add_u32 m0, s89, 40960
    s_add_u32 s90, s37, 442368
    v_mfma_f32_16x16x32_bf16 v[76:79], v[100:103], a[200:203], v[76:79]
    buffer_load_dwordx4 v250, s[12:15], s90 offen  lds
    v_mfma_f32_16x16x32_bf16 v[80:83], v[100:103], a[204:207], v[80:83]
    s_waitcnt lgkmcnt(4)
    v_mfma_f32_16x16x32_bf16 v[68:71], v[104:107], a[208:211], v[68:71]
    ds_read_b64_tr_b16 v[116:117], v253 offset:16384
    ds_read_b64_tr_b16 v[118:119], v253 offset:18432
    v_mfma_f32_16x16x32_bf16 v[72:75], v[104:107], a[212:215], v[72:75]
    s_add_u32 m0, s89, 45056
    s_add_u32 s90, s37, 479232
    v_mfma_f32_16x16x32_bf16 v[76:79], v[104:107], a[216:219], v[76:79]
    buffer_load_dwordx4 v250, s[12:15], s90 offen  lds
    v_mfma_f32_16x16x32_bf16 v[80:83], v[104:107], a[220:223], v[80:83]
    s_waitcnt lgkmcnt(4)
    v_mfma_f32_16x16x32_bf16 v[68:71], v[108:111], a[224:227], v[68:71]
    ds_read_b64_tr_b16 v[100:101], v253 offset:20480
    ds_read_b64_tr_b16 v[102:103], v253 offset:22528
    v_mfma_f32_16x16x32_bf16 v[72:75], v[108:111], a[228:231], v[72:75]
    s_add_u32 m0, s89, 49152
    s_add_u32 s90, s37, 516096
    v_mfma_f32_16x16x32_bf16 v[76:79], v[108:111], a[232:235], v[76:79]
    buffer_load_dwordx4 v250, s[12:15], s90 offen  lds
    v_mfma_f32_16x16x32_bf16 v[80:83], v[108:111], a[236:239], v[80:83]
    s_waitcnt lgkmcnt(4)
    v_mfma_f32_16x16x32_bf16 v[68:71], v[112:115], a[240:243], v[68:71]
    ds_read_b64_tr_b16 v[104:105], v253 offset:24576
    ds_read_b64_tr_b16 v[106:107], v253 offset:26624
    v_mfma_f32_16x16x32_bf16 v[72:75], v[112:115], a[244:247], v[72:75]
    s_add_u32 m0, s89, 53248
    s_add_u32 s90, s37, 552960
    v_mfma_f32_16x16x32_bf16 v[76:79], v[112:115], a[248:251], v[76:79]
    buffer_load_dwordx4 v250, s[12:15], s90 offen  lds
    v_mfma_f32_16x16x32_bf16 v[80:83], v[112:115], a[252:255], v[80:83]
    s_waitcnt lgkmcnt(4)
    v_mfma_f32_16x16x32_bf16 v[68:71], v[116:119], v[4:7], v[68:71]
    ds_read_b64_tr_b16 v[108:109], v253 offset:28672
    ds_read_b64_tr_b16 v[110:111], v253 offset:30720
    v_mfma_f32_16x16x32_bf16 v[72:75], v[116:119], v[8:11], v[72:75]
    s_add_u32 m0, s89, 86016
    s_add_u32 s90, s38, 589824
    v_mfma_f32_16x16x32_bf16 v[76:79], v[116:119], v[12:15], v[76:79]
    buffer_load_dwordx4 v250, s[12:15], s90 offen  lds
    v_mfma_f32_16x16x32_bf16 v[80:83], v[116:119], v[16:19], v[80:83]
    s_waitcnt lgkmcnt(4)
    v_mfma_f32_16x16x32_bf16 v[68:71], v[100:103], v[20:23], v[68:71]
    ds_read_b64_tr_b16 v[112:113], v253 offset:32768
    ds_read_b64_tr_b16 v[114:115], v253 offset:34816
    v_mfma_f32_16x16x32_bf16 v[72:75], v[100:103], v[24:27], v[72:75]
    s_add_u32 m0, s89, 90112
    s_add_u32 s90, s38, 626688
    v_mfma_f32_16x16x32_bf16 v[76:79], v[100:103], v[28:31], v[76:79]
    buffer_load_dwordx4 v250, s[12:15], s90 offen  lds
    v_mfma_f32_16x16x32_bf16 v[80:83], v[100:103], v[32:35], v[80:83]
    s_waitcnt vmcnt(11)
    s_barrier
    s_waitcnt lgkmcnt(4)
    v_mfma_f32_16x16x32_bf16 v[84:87], v[104:107], a[0:3], 0
    ds_read_b64_tr_b16 v[116:117], v253 offset:36864
    ds_read_b64_tr_b16 v[118:119], v253 offset:38912
    v_mfma_f32_16x16x32_bf16 v[88:91], v[104:107], a[4:7], 0
    s_add_u32 m0, s89, 94208
    s_add_u32 s90, s38, 0
    v_mfma_f32_16x16x32_bf16 v[92:95], v[104:107], a[8:11], 0
    buffer_load_dwordx4 v250, s[12:15], s90 offen  lds
    s_add_u32 s65, s46, s60
    v_mfma_f32_16x16x32_bf16 v[96:99], v[104:107], a[12:15], 0
    v_cvt_pk_bf16_f32 v208, v68, v69
    s_waitcnt lgkmcnt(4)
    v_mfma_f32_16x16x32_bf16 v[84:87], v[108:111], a[16:19], v[84:87]
    ds_read_b64_tr_b16 v[100:101], v251 offset:0
    ds_read_b64_tr_b16 v[102:103], v251 offset:2048
    v_mfma_f32_16x16x32_bf16 v[88:91], v[108:111], a[20:23], v[88:91]
    s_add_u32 m0, s89, 98304
    s_add_u32 s90, s38, 36864
    v_cvt_pk_bf16_f32 v209, v70, v71
    v_mfma_f32_16x16x32_bf16 v[92:95], v[108:111], a[24:27], v[92:95]
    buffer_load_dwordx4 v250, s[12:15], s90 offen  lds
    v_cvt_pk_bf16_f32 v210, v72, v73
    v_mfma_f32_16x16x32_bf16 v[96:99], v[108:111], a[28:31], v[96:99]
    v_cvt_pk_bf16_f32 v211, v74, v75
    s_waitcnt lgkmcnt(4)
    v_mfma_f32_16x16x32_bf16 v[84:87], v[112:115], a[32:35], v[84:87]
    ds_read_b64_tr_b16 v[104:105], v251 offset:4096
    ds_read_b64_tr_b16 v[106:107], v251 offset:6144
    v_mfma_f32_16x16x32_bf16 v[88:91], v[112:115], a[36:39], v[88:91]
    s_add_u32 m0, s89, 102400
    s_add_u32 s90, s38, 73728
    v_mfma_f32_16x16x32_bf16 v[92:95], v[112:115], a[40:43], v[92:95]
    buffer_load_dwordx4 v250, s[12:15], s90 offen  lds
    s_cmp_eq_u32 s91, 0
    s_cbranch_scc1 FS_73
    buffer_store_dwordx4 v[208:211], v240, s[16:19], s65 offen sc1
    s_branch FE_74
FS_73:
    ds_write_b128 v243, v[208:211] offset:16640
FE_74:
    v_mfma_f32_16x16x32_bf16 v[96:99], v[112:115], a[44:47], v[96:99]
    v_cvt_pk_bf16_f32 v212, v76, v77
    s_load_dword s4, s[28:29], s56 glc
    s_waitcnt lgkmcnt(4)
    v_mfma_f32_16x16x32_bf16 v[84:87], v[116:119], a[48:51], v[84:87]
    ds_read_b64_tr_b16 v[108:109], v251 offset:8192
    ds_read_b64_tr_b16 v[110:111], v251 offset:10240
    v_mfma_f32_16x16x32_bf16 v[88:91], v[116:119], a[52:55], v[88:91]
    s_add_u32 m0, s89, 106496
    s_add_u32 s90, s38, 110592
    v_cvt_pk_bf16_f32 v213, v78, v79
    v_mfma_f32_16x16x32_bf16 v[92:95], v[116:119], a[56:59], v[92:95]
    buffer_load_dwordx4 v250, s[12:15], s90 offen  lds
    v_mfma_f32_16x16x32_bf16 v[96:99], v[116:119], a[60:63], v[96:99]
    v_cvt_pk_bf16_f32 v214, v80, v81
    v_cvt_pk_bf16_f32 v215, v82, v83
    s_waitcnt lgkmcnt(4)
    v_mfma_f32_16x16x32_bf16 v[84:87], v[100:103], a[64:67], v[84:87]
    ds_read_b64_tr_b16 v[112:113], v251 offset:12288
    ds_read_b64_tr_b16 v[114:115], v251 offset:14336
    v_mfma_f32_16x16x32_bf16 v[88:91], v[100:103], a[68:71], v[88:91]
    s_add_u32 m0, s89, 57344
    s_add_u32 s90, s38, 147456
    s_add_u32 s65, s65, 4096
    v_mfma_f32_16x16x32_bf16 v[92:95], v[100:103], a[72:75], v[92:95]
    buffer_load_dwordx4 v250, s[12:15], s90 offen  lds
    v_mfma_f32_16x16x32_bf16 v[96:99], v[100:103], a[76:79], v[96:99]
    s_cmp_eq_u32 s91, 1
    s_cbranch_scc1 FS_75
    buffer_store_dwordx4 v[212:215], v240, s[16:19], s65 offen sc1
    s_branch FE_76
FS_75:
    ds_write_b128 v243, v[212:215] offset:16640
FE_76:
    s_waitcnt lgkmcnt(4)
    v_mfma_f32_16x16x32_bf16 v[84:87], v[104:107], a[80:83], v[84:87]
    ds_read_b64_tr_b16 v[116:117], v251 offset:16384
    ds_read_b64_tr_b16 v[118:119], v251 offset:18432
    v_mfma_f32_16x16x32_bf16 v[88:91], v[104:107], a[84:87], v[88:91]
    s_add_u32 m0, s89, 61440
    s_add_u32 s90, s38, 184320
    v_mfma_f32_16x16x32_bf16 v[92:95], v[104:107], a[88:91], v[92:95]
    buffer_load_dwordx4 v250, s[12:15], s90 offen  lds
    v_mfma_f32_16x16x32_bf16 v[96:99], v[104:107], a[92:95], v[96:99]
    s_waitcnt vmcnt(11)
    s_barrier
    s_waitcnt lgkmcnt(4)
    v_mfma_f32_16x16x32_bf16 v[84:87], v[108:111], a[96:99], v[84:87]
    ds_read_b64_tr_b16 v[100:101], v251 offset:20480
    ds_read_b64_tr_b16 v[102:103], v251 offset:22528
    v_mfma_f32_16x16x32_bf16 v[88:91], v[108:111], a[100:103], v[88:91]
    s_add_u32 m0, s89, 65536
    s_add_u32 s90, s38, 221184
    v_mfma_f32_16x16x32_bf16 v[92:95], v[108:111], a[104:107], v[92:95]
    buffer_load_dwordx4 v250, s[12:15], s90 offen  lds
    v_mfma_f32_16x16x32_bf16 v[96:99], v[108:111], a[108:111], v[96:99]
    s_waitcnt lgkmcnt(4)
    v_mfma_f32_16x16x32_bf16 v[84:87], v[112:115], a[112:115], v[84:87]
    ds_read_b64_tr_b16 v[104:105], v251 offset:24576
    ds_read_b64_tr_b16 v[106:107], v251 offset:26624
    v_mfma_f32_16x16x32_bf16 v[88:91], v[112:115], a[116:119], v[88:91]
    s_add_u32 m0, s89, 69632
    s_add_u32 s90, s38, 258048
    v_mfma_f32_16x16x32_bf16 v[92:95], v[112:115], a[120:123], v[92:95]
    buffer_load_dwordx4 v250, s[12:15], s90 offen  lds
    v_mfma_f32_16x16x32_bf16 v[96:99], v[112:115], a[124:127], v[96:99]
    s_waitcnt lgkmcnt(4)
    v_mfma_f32_16x16x32_bf16 v[84:87], v[116:119], a[128:131], v[84:87]
    ds_read_b64_tr_b16 v[108:109], v251 offset:28672
    ds_read_b64_tr_b16 v[110:111], v251 offset:30720
    v_mfma_f32_16x16x32_bf16 v[88:91], v[116:119], a[132:135], v[88:91]
    s_add_u32 m0, s89, 110592
    s_add_u32 s90, s38, 294912
    v_mfma_f32_16x16x32_bf16 v[92:95], v[116:119], a[136:139], v[92:95]
    buffer_load_dwordx4 v250, s[12:15], s90 offen  lds
    v_mfma_f32_16x16x32_bf16 v[96:99], v[116:119], a[140:143], v[96:99]
    s_waitcnt lgkmcnt(4)
    v_mfma_f32_16x16x32_bf16 v[84:87], v[100:103], a[144:147], v[84:87]
    ds_read_b64_tr_b16 v[112:113], v251 offset:32768
    ds_read_b64_tr_b16 v[114:115], v251 offset:34816
    v_mfma_f32_16x16x32_bf16 v[88:91], v[100:103], a[148:151], v[88:91]
    s_add_u32 m0, s89, 114688
    s_add_u32 s90, s38, 331776
    v_mfma_f32_16x16x32_bf16 v[92:95], v[100:103], a[152:155], v[92:95]
    buffer_load_dwordx4 v250, s[12:15], s90 offen  lds
    v_mfma_f32_16x16x32_bf16 v[96:99], v[100:103], a[156:159], v[96:99]
    s_waitcnt lgkmcnt(4)
    v_mfma_f32_16x16x32_bf16 v[84:87], v[104:107], a[160:163], v[84:87]
    ds_read_b64_tr_b16 v[116:117], v251 offset:36864
    ds_read_b64_tr_b16 v[118:119], v251 offset:38912
    v_mfma_f32_16x16x32_bf16 v[88:91], v[104:107], a[164:167], v[88:91]
    s_add_u32 m0, s89, 118784
    s_add_u32 s90, s38, 368640
    v_mfma_f32_16x16x32_bf16 v[92:95], v[104:107], a[168:171], v[92:95]
    buffer_load_dwordx4 v250, s[12:15], s90 offen  lds
    v_mfma_f32_16x16x32_bf16 v[96:99], v[104:107], a[172:175], v[96:99]
    s_waitcnt lgkmcnt(4)
    v_mfma_f32_16x16x32_bf16 v[84:87], v[108:111], a[176:179], v[84:87]
    ds_read_b64_tr_b16 v[100:101], v251 offset:40960
    ds_read_b64_tr_b16 v[102:103], v251 offset:43008
    v_mfma_f32_16x16x32_bf16 v[88:91], v[108:111], a[180:183], v[88:91]
    s_add_u32 m0, s89, 122880
    s_add_u32 s90, s38, 405504
    v_mfma_f32_16x16x32_bf16 v[92:95], v[108:111], a[184:187], v[92:95]
    buffer_load_dwordx4 v250, s[12:15], s90 offen  lds
    v_mfma_f32_16x16x32_bf16 v[96:99], v[108:111], a[188:191], v[96:99]
    s_waitcnt vmcnt(11)
    s_barrier
    s_waitcnt lgkmcnt(4)
    v_mfma_f32_16x16x32_bf16 v[84:87], v[112:115], a[192:195], v[84:87]
    ds_read_b64_tr_b16 v[104:105], v251 offset:45056
    ds_read_b64_tr_b16 v[106:107], v251 offset:47104
    v_mfma_f32_16x16x32_bf16 v[88:91], v[112:115], a[196:199], v[88:91]
    s_add_u32 m0, s89, 126976
    s_add_u32 s90, s38, 442368
    v_mfma_f32_16x16x32_bf16 v[92:95], v[112:115], a[200:203], v[92:95]
    buffer_load_dwordx4 v250, s[12:15], s90 offen  lds
    v_mfma_f32_16x16x32_bf16 v[96:99], v[112:115], a[204:207], v[96:99]
    s_waitcnt lgkmcnt(0)
    s_mov_b32 s58, 0
K3_sp_81:
    s_cmp_ge_u32 s4, 8
    s_cbranch_scc1 K3_ok_82
    s_add_u32 s58, s58, 1
    s_cmp_gt_u32 s58, 200000
    s_cbranch_scc1 K3_ok_82
    s_load_dword s4, s[28:29], s56 glc
    s_waitcnt lgkmcnt(0)
    s_branch K3_sp_81
K3_ok_82:
    s_waitcnt lgkmcnt(4)
    v_mfma_f32_16x16x32_bf16 v[84:87], v[116:119], a[208:211], v[84:87]
    ds_read_b64_tr_b16 v[108:109], v251 offset:49152
    ds_read_b64_tr_b16 v[110:111], v251 offset:51200
    s_lshl_b32 s65, s50, 13
    s_add_u32 s65, s65, s57
    v_mfma_f32_16x16x32_bf16 v[88:91], v[116:119], a[212:215], v[88:91]
    s_add_u32 m0, s89, 131072
    s_add_u32 s90, s38, 479232
    s_add_u32 s64, s65, 18874368
    s_mul_i32 s6, s20, 2359296
    s_add_u32 s65, s65, s6
    v_mfma_f32_16x16x32_bf16 v[92:95], v[116:119], a[216:219], v[92:95]
    buffer_load_dwordx4 v250, s[12:15], s90 offen  lds
    s_add_u32 s6, s61, 1024
    v_add_u32 v248, s6, v240
    ds_read_b128 v[120:123], v248
    v_mfma_f32_16x16x32_bf16 v[96:99], v[116:119], a[220:223], v[96:99]
    s_add_u32 s65, s65, 2359296
    s_cmp_ge_u32 s65, s64
    s_cselect_b32 s6, 18874368, 0
    s_sub_u32 s65, s65, s6
    buffer_load_dwordx4 v[124:127], v240, s[16:19], s65 offen sc1
    s_add_u32 s65, s65, 2359296
    s_cmp_ge_u32 s65, s64
    s_cselect_b32 s6, 18874368, 0
    s_sub_u32 s65, s65, s6
    s_waitcnt lgkmcnt(5)
    v_mfma_f32_16x16x32_bf16 v[84:87], v[100:103], a[224:227], v[84:87]
    ds_read_b64_tr_b16 v[112:113], v251 offset:53248
    ds_read_b64_tr_b16 v[114:115], v251 offset:55296
    v_mfma_f32_16x16x32_bf16 v[88:91], v[100:103], a[228:231], v[88:91]
    s_add_u32 m0, s89, 135168
    s_add_u32 s90, s38, 516096
    buffer_load_dwordx4 v[128:131], v240, s[16:19], s65 offen sc1
    v_mfma_f32_16x16x32_bf16 v[92:95], v[100:103], a[232:235], v[92:95]
    buffer_load_dwordx4 v250, s[12:15], s90 offen  lds
    s_add_u32 s65, s65, 2359296
    s_cmp_ge_u32 s65, s64
    s_cselect_b32 s6, 18874368, 0
    s_sub_u32 s65, s65, s6
    v_mfma_f32_16x16x32_bf16 v[96:99], v[100:103], a[236:239], v[96:99]
    buffer_load_dwordx4 v[132:135], v240, s[16:19], s65 offen sc1
    s_add_u32 s65, s65, 2359296
    s_cmp_ge_u32 s65, s64
    s_cselect_b32 s6, 18874368, 0
    s_sub_u32 s65, s65, s6
    buffer_load_dwordx4 v[136:139], v240, s[16:19], s65 offen sc1
    s_waitcnt lgkmcnt(5)
    v_mfma_f32_16x16x32_bf16 v[84:87], v[104:107], a[240:243], v[84:87]
    ds_read_b64_tr_b16 v[116:117], v252 offset:24576
    ds_read_b64_tr_b16 v[118:119], v252 offset:26624
    s_add_u32 s65, s65, 2359296
    s_cmp_ge_u32 s65, s64
    s_cselect_b32 s6, 18874368, 0
    s_sub_u32 s65, s65, s6
    v_mfma_f32_16x16x32_bf16 v[88:91], v[104:107], a[244:247], v[88:91]
    s_add_u32 m0, s89, 139264
    s_add_u32 s90, s38, 552960
    buffer_load_dwordx4 v[140:143], v240, s[16:19], s65 offen sc1
    v_mfma_f32_16x16x32_bf16 v[92:95], v[104:107], a[248:251], v[92:95]
    buffer_load_dwordx4 v250, s[12:15], s90 offen  lds
    s_add_u32 s65, s65, 2359296
    s_cmp_ge_u32 s65, s64
    s_cselect_b32 s6, 18874368, 0
    s_sub_u32 s65, s65, s6
    v_mfma_f32_16x16x32_bf16 v[96:99], v[104:107], a[252:255], v[96:99]
    buffer_load_dwordx4 v[144:147], v240, s[16:19], s65 offen sc1
    s_add_u32 s65, s65, 2359296
    s_cmp_ge_u32 s65, s64
    s_cselect_b32 s6, 18874368, 0
    s_sub_u32 s65, s65, s6
    buffer_load_dwordx4 v[148:151], v240, s[16:19], s65 offen sc1
    s_waitcnt vmcnt(18)
    s_mov_b32 s5, 1
    s_add_u32 s6, s55, 4
    s_atomic_add s5, s[28:29], s6
    s_waitcnt lgkmcnt(5)
    v_mfma_f32_16x16x32_bf16 v[84:87], v[108:111], v[4:7], v[84:87]
    ds_read_b64_tr_b16 v[100:101], v252 offset:28672
    ds_read_b64_tr_b16 v[102:103], v252 offset:30720
    v_mfma_f32_16x16x32_bf16 v[88:91], v[108:111], v[8:11], v[88:91]
    v_mfma_f32_16x16x32_bf16 v[92:95], v[108:111], v[12:15], v[92:95]
    v_mfma_f32_16x16x32_bf16 v[96:99], v[108:111], v[16:19], v[96:99]
    s_waitcnt lgkmcnt(4)
    v_mfma_f32_16x16x32_bf16 v[84:87], v[112:115], v[20:23], v[84:87]
    ds_read_b64_tr_b16 v[104:105], v252 offset:32768
    ds_read_b64_tr_b16 v[106:107], v252 offset:34816
    v_mfma_f32_16x16x32_bf16 v[88:91], v[112:115], v[24:27], v[88:91]
    v_mfma_f32_16x16x32_bf16 v[92:95], v[112:115], v[28:31], v[92:95]
    v_mfma_f32_16x16x32_bf16 v[96:99], v[112:115], v[32:35], v[96:99]
    s_waitcnt vmcnt(16)
    s_barrier
    s_waitcnt lgkmcnt(4)
    v_mfma_f32_16x16x32_bf16 v[36:39], v[116:119], a[0:3], 0
    ds_read_b64_tr_b16 v[108:109], v252 offset:36864
    ds_read_b64_tr_b16 v[110:111], v252 offset:38912
    v_mfma_f32_16x16x32_bf16 v[40:43], v[116:119], a[4:7], 0
    v_mfma_f32_16x16x32_bf16 v[44:47], v[116:119], a[8:11], 0
    s_add_u32 s65, s47, s60
    v_mfma_f32_16x16x32_bf16 v[48:51], v[116:119], a[12:15], 0
    v_cvt_pk_bf16_f32 v208, v84, v85
    s_waitcnt lgkmcnt(4)
    v_mfma_f32_16x16x32_bf16 v[36:39], v[100:103], a[16:19], v[36:39]
    ds_read_b64_tr_b16 v[112:113], v252 offset:40960
    ds_read_b64_tr_b16 v[114:115], v252 offset:43008
    v_mfma_f32_16x16x32_bf16 v[40:43], v[100:103], a[20:23], v[40:43]
    v_cvt_pk_bf16_f32 v209, v86, v87
    v_mfma_f32_16x16x32_bf16 v[44:47], v[100:103], a[24:27], v[44:47]
    v_cvt_pk_bf16_f32 v210, v88, v89
    v_mfma_f32_16x16x32_bf16 v[48:51], v[100:103], a[28:31], v[48:51]
    v_cvt_pk_bf16_f32 v211, v90, v91
    s_waitcnt lgkmcnt(4)
    v_mfma_f32_16x16x32_bf16 v[36:39], v[104:107], a[32:35], v[36:39]
    ds_read_b64_tr_b16 v[116:117], v252 offset:45056
    ds_read_b64_tr_b16 v[118:119], v252 offset:47104
    v_mfma_f32_16x16x32_bf16 v[40:43], v[104:107], a[36:39], v[40:43]
    s_cmp_eq_u32 s91, 0
    s_cbranch_scc1 FS_77
    buffer_store_dwordx4 v[208:211], v240, s[16:19], s65 offen sc1
    s_branch FE_78
FS_77:
    ds_write_b128 v243, v[208:211] offset:17664
FE_78:
    v_mfma_f32_16x16x32_bf16 v[44:47], v[104:107], a[40:43], v[44:47]
    v_mfma_f32_16x16x32_bf16 v[48:51], v[104:107], a[44:47], v[48:51]
    v_cvt_pk_bf16_f32 v212, v92, v93
    s_waitcnt lgkmcnt(4)
    v_mfma_f32_16x16x32_bf16 v[36:39], v[108:111], a[48:51], v[36:39]
    ds_read_b64_tr_b16 v[100:101], v251 offset:57344
    ds_read_b64_tr_b16 v[102:103], v251 offset:59392
    v_mfma_f32_16x16x32_bf16 v[40:43], v[108:111], a[52:55], v[40:43]
    v_cvt_pk_bf16_f32 v213, v94, v95
    v_mfma_f32_16x16x32_bf16 v[44:47], v[108:111], a[56:59], v[44:47]
    v_cvt_pk_bf16_f32 v214, v96, v97
    v_mfma_f32_16x16x32_bf16 v[48:51], v[108:111], a[60:63], v[48:51]
    v_cvt_pk_bf16_f32 v215, v98, v99
    s_waitcnt lgkmcnt(4)
    v_mfma_f32_16x16x32_bf16 v[36:39], v[112:115], a[64:67], v[36:39]
    ds_read_b64_tr_b16 v[104:105], v252 offset:0
    ds_read_b64_tr_b16 v[106:107], v252 offset:2048
    v_mfma_f32_16x16x32_bf16 v[40:43], v[112:115], a[68:71], v[40:43]
    s_add_u32 s65, s65, 4096
    v_mfma_f32_16x16x32_bf16 v[44:47], v[112:115], a[72:75], v[44:47]
    s_cmp_eq_u32 s91, 1
    s_cbranch_scc1 FS_79
    buffer_store_dwordx4 v[212:215], v240, s[16:19], s65 offen sc1
    s_branch FE_80
FS_79:
    ds_write_b128 v243, v[212:215] offset:17664
FE_80:
    v_mfma_f32_16x16x32_bf16 v[48:51], v[112:115], a[76:79], v[48:51]
    s_waitcnt lgkmcnt(4)
    v_mfma_f32_16x16x32_bf16 v[36:39], v[116:119], a[80:83], v[36:39]
    ds_read_b64_tr_b16 v[108:109], v252 offset:4096
    ds_read_b64_tr_b16 v[110:111], v252 offset:6144
    v_mfma_f32_16x16x32_bf16 v[40:43], v[116:119], a[84:87], v[40:43]
    v_mfma_f32_16x16x32_bf16 v[44:47], v[116:119], a[88:91], v[44:47]
    v_mfma_f32_16x16x32_bf16 v[48:51], v[116:119], a[92:95], v[48:51]
    s_waitcnt vmcnt(10)
    s_barrier
    s_waitcnt lgkmcnt(4)
    v_mfma_f32_16x16x32_bf16 v[36:39], v[100:103], a[96:99], v[36:39]
    ds_read_b64_tr_b16 v[112:113], v252 offset:8192
    ds_read_b64_tr_b16 v[114:115], v252 offset:10240
    v_mfma_f32_16x16x32_bf16 v[40:43], v[100:103], a[100:103], v[40:43]
    v_mfma_f32_16x16x32_bf16 v[44:47], v[100:103], a[104:107], v[44:47]
    v_mfma_f32_16x16x32_bf16 v[48:51], v[100:103], a[108:111], v[48:51]
    s_waitcnt lgkmcnt(4)
    v_mfma_f32_16x16x32_bf16 v[36:39], v[104:107], a[112:115], v[36:39]
    ds_read_b64_tr_b16 v[116:117], v252 offset:49152
    ds_read_b64_tr_b16 v[118:119], v252 offset:51200
    v_mfma_f32_16x16x32_bf16 v[40:43], v[104:107], a[116:119], v[40:43]
    v_mfma_f32_16x16x32_bf16 v[44:47], v[104:107], a[120:123], v[44:47]
    v_mfma_f32_16x16x32_bf16 v[48:51], v[104:107], a[124:127], v[48:51]
    s_waitcnt lgkmcnt(4)
    v_mfma_f32_16x16x32_bf16 v[36:39], v[108:111], a[128:131], v[36:39]
    ds_read_b64_tr_b16 v[100:101], v252 offset:53248
    ds_read_b64_tr_b16 v[102:103], v252 offset:55296
    v_mfma_f32_16x16x32_bf16 v[40:43], v[108:111], a[132:135], v[40:43]
    v_mfma_f32_16x16x32_bf16 v[44:47], v[108:111], a[136:139], v[44:47]
    v_mfma_f32_16x16x32_bf16 v[48:51], v[108:111], a[140:143], v[48:51]
    s_waitcnt lgkmcnt(4)
    v_mfma_f32_16x16x32_bf16 v[36:39], v[112:115], a[144:147], v[36:39]
    ds_read_b64_tr_b16 v[104:105], v252 offset:57344
    ds_read_b64_tr_b16 v[106:107], v252 offset:59392
    v_mfma_f32_16x16x32_bf16 v[40:43], v[112:115], a[148:151], v[40:43]
    v_mfma_f32_16x16x32_bf16 v[44:47], v[112:115], a[152:155], v[44:47]
    v_mfma_f32_16x16x32_bf16 v[48:51], v[112:115], a[156:159], v[48:51]
    s_waitcnt lgkmcnt(4)
    v_mfma_f32_16x16x32_bf16 v[36:39], v[116:119], a[160:163], v[36:39]
    ds_read_b64_tr_b16 v[108:109], v253 offset:0
    ds_read_b64_tr_b16 v[110:111], v253 offset:2048
    v_mfma_f32_16x16x32_bf16 v[40:43], v[116:119], a[164:167], v[40:43]
    v_mfma_f32_16x16x32_bf16 v[44:47], v[116:119], a[168:171], v[44:47]
    v_mfma_f32_16x16x32_bf16 v[48:51], v[116:119], a[172:175], v[48:51]
    s_waitcnt lgkmcnt(4)
    v_mfma_f32_16x16x32_bf16 v[36:39], v[100:103], a[176:179], v[36:39]
    ds_read_b64_tr_b16 v[112:113], v253 offset:4096
    ds_read_b64_tr_b16 v[114:115], v253 offset:6144
    v_mfma_f32_16x16x32_bf16 v[40:43], v[100:103], a[180:183], v[40:43]
    v_mfma_f32_16x16x32_bf16 v[44:47], v[100:103], a[184:187], v[44:47]
    v_mfma_f32_16x16x32_bf16 v[48:51], v[100:103], a[188:191], v[48:51]
    s_waitcnt vmcnt(2)
    s_barrier
    s_waitcnt lgkmcnt(4)
    v_mfma_f32_16x16x32_bf16 v[36:39], v[104:107], a[192:195], v[36:39]
    ds_read_b64_tr_b16 v[116:117], v253 offset:8192
    ds_read_b64_tr_b16 v[118:119], v253 offset:10240
    v_mfma_f32_16x16x32_bf16 v[40:43], v[104:107], a[196:199], v[40:43]
    v_mfma_f32_16x16x32_bf16 v[44:47], v[104:107], a[200:203], v[44:47]
    v_mfma_f32_16x16x32_bf16 v[48:51], v[104:107], a[204:207], v[48:51]
    s_waitcnt lgkmcnt(4)
    v_mfma_f32_16x16x32_bf16 v[36:39], v[108:111], a[208:211], v[36:39]
    ds_read_b64_tr_b16 v[100:101], v253 offset:12288
    ds_read_b64_tr_b16 v[102:103], v253 offset:14336
    v_mfma_f32_16x16x32_bf16 v[40:43], v[108:111], a[212:215], v[40:43]
    v_mfma_f32_16x16x32_bf16 v[44:47], v[108:111], a[216:219], v[44:47]
    v_mfma_f32_16x16x32_bf16 v[48:51], v[108:111], a[220:223], v[48:51]
    s_waitcnt lgkmcnt(4)
    v_mfma_f32_16x16x32_bf16 v[36:39], v[112:115], a[224:227], v[36:39]
    ds_read_b64_tr_b16 v[104:105], v253 offset:16384
    ds_read_b64_tr_b16 v[106:107], v253 offset:18432
    v_mfma_f32_16x16x32_bf16 v[40:43], v[112:115], a[228:231], v[40:43]
    v_mfma_f32_16x16x32_bf16 v[44:47], v[112:115], a[232:235], v[44:47]
    v_mfma_f32_16x16x32_bf16 v[48:51], v[112:115], a[236:239], v[48:51]
    s_waitcnt lgkmcnt(4)
    v_mfma_f32_16x16x32_bf16 v[36:39], v[116:119], a[240:243], v[36:39]
    v_mfma_f32_16x16x32_bf16 v[40:43], v[116:119], a[244:247], v[40:43]
    v_mfma_f32_16x16x32_bf16 v[44:47], v[116:119], a[248:251], v[44:47]
    v_mfma_f32_16x16x32_bf16 v[48:51], v[116:119], a[252:255], v[48:51]
    s_waitcnt lgkmcnt(2)
    v_mfma_f32_16x16x32_bf16 v[36:39], v[100:103], v[4:7], v[36:39]
    v_mfma_f32_16x16x32_bf16 v[40:43], v[100:103], v[8:11], v[40:43]
    v_mfma_f32_16x16x32_bf16 v[44:47], v[100:103], v[12:15], v[44:47]
    v_mfma_f32_16x16x32_bf16 v[48:51], v[100:103], v[16:19], v[48:51]
    s_waitcnt lgkmcnt(0)
    v_mfma_f32_16x16x32_bf16 v[36:39], v[104:107], v[20:23], v[36:39]
    v_mfma_f32_16x16x32_bf16 v[40:43], v[104:107], v[24:27], v[40:43]
    v_mfma_f32_16x16x32_bf16 v[44:47], v[104:107], v[28:31], v[44:47]
    v_mfma_f32_16x16x32_bf16 v[48:51], v[104:107], v[32:35], v[48:51]
    s_waitcnt vmcnt(0)
    s_waitcnt lgkmcnt(0)
    s_mov_b32 s5, 1
    s_add_u32 s6, s55, 8
    s_atomic_add s5, s[28:29], s6
    s_load_dword s4, s[28:29], s53 glc
    s_add_u32 s65, s48, s60
    v_cvt_pk_bf16_f32 v208, v36, v37
    v_cvt_pk_bf16_f32 v209, v38, v39
    v_cvt_pk_bf16_f32 v210, v40, v41
    v_cvt_pk_bf16_f32 v211, v42, v43
    s_cmp_eq_u32 s91, 0
    s_cbranch_scc1 FS_87
    buffer_store_dwordx4 v[208:211], v240, s[16:19], s65 offen sc1
    s_branch FE_88
FS_87:
    ds_write_b128 v243, v[208:211] offset:18688
FE_88:
    v_cvt_pk_bf16_f32 v212, v44, v45
    v_cvt_pk_bf16_f32 v213, v46, v47
    v_cvt_pk_bf16_f32 v214, v48, v49
    v_cvt_pk_bf16_f32 v215, v50, v51
    s_add_u32 s65, s65, 4096
    s_cmp_eq_u32 s91, 1
    s_cbranch_scc1 FS_89
    buffer_store_dwordx4 v[212:215], v240, s[16:19], s65 offen sc1
    s_branch FE_90
FS_89:
    ds_write_b128 v243, v[212:215] offset:18688
FE_90:
    s_mov_b32 s54, 0x3f80
    s_mov_b32 s27, 0x3f800000
    s_add_u32 s7, s56, 12
    s_nop 0
    v_lshlrev_b32 v68, 16, v120
    v_and_b32 v69, 0xffff0000, v120
    v_lshlrev_b32 v70, 16, v121
    v_and_b32 v71, 0xffff0000, v121
    v_lshlrev_b32 v72, 16, v122
    v_and_b32 v73, 0xffff0000, v122
    v_lshlrev_b32 v74, 16, v123
    v_and_b32 v75, 0xffff0000, v123
    v_dot2c_f32_bf16 v68, s54, v124
    v_dot2c_f32_bf16 v69, s27, v124
    v_dot2c_f32_bf16 v70, s54, v125
    v_dot2c_f32_bf16 v71, s27, v125
    v_dot2c_f32_bf16 v72, s54, v126
    v_dot2c_f32_bf16 v73, s27, v126
    v_dot2c_f32_bf16 v74, s54, v127
    v_dot2c_f32_bf16 v75, s27, v127
    s_waitcnt lgkmcnt(0)
    s_cmp_ge_u32 s4, 8
    s_cbranch_scc0 K3_p2
    s_lshl_b32 s65, s51, 13
    s_add_u32 s65, s65, s57
    s_add_u32 s64, s65, 18874368
    s_mul_i32 s6, s20, 2359296
    s_add_u32 s65, s65, s6
    s_add_u32 s6, s62, 1024
    v_add_u32 v248, s6, v240
    ds_read_b128 v[152:155], v248
    s_add_u32 s65, s65, 2359296
    s_cmp_ge_u32 s65, s64
    s_cselect_b32 s6, 18874368, 0
    s_sub_u32 s65, s65, s6
    buffer_load_dwordx4 v[156:159], v240, s[16:19], s65 offen sc1
    s_add_u32 s65, s65, 2359296
    s_cmp_ge_u32 s65, s64
    s_cselect_b32 s6, 18874368, 0
    s_sub_u32 s65, s65, s6
    buffer_load_dwordx4 v[160:163], v240, s[16:19], s65 offen sc1
    s_add_u32 s65, s65, 2359296
    s_cmp_ge_u32 s65, s64
    s_cselect_b32 s6, 18874368, 0
    s_sub_u32 s65, s65, s6
    buffer_load_dwordx4 v[164:167], v240, s[16:19], s65 offen sc1
    s_add_u32 s65, s65, 2359296
    s_cmp_ge_u32 s65, s64
    s_cselect_b32 s6, 18874368, 0
    s_sub_u32 s65, s65, s6
    buffer_load_dwordx4 v[168:171], v240, s[16:19], s65 offen sc1
    s_add_u32 s65, s65, 2359296
    s_cmp_ge_u32 s65, s64
    s_cselect_b32 s6, 18874368, 0
    s_sub_u32 s65, s65, s6
    buffer_load_dwordx4 v[172:175], v240, s[16:19], s65 offen sc1
    s_add_u32 s65, s65, 2359296
    s_cmp_ge_u32 s65, s64
    s_cselect_b32 s6, 18874368, 0
    s_sub_u32 s65, s65, s6
    buffer_load_dwordx4 v[176:179], v240, s[16:19], s65 offen sc1
    s_add_u32 s65, s65, 2359296
    s_cmp_ge_u32 s65, s64
    s_cselect_b32 s6, 18874368, 0
    s_sub_u32 s65, s65, s6
    buffer_load_dwordx4 v[180:183], v240, s[16:19], s65 offen sc1
    v_dot2c_f32_bf16 v68, s54, v128
    v_dot2c_f32_bf16 v69, s27, v128
    v_dot2c_f32_bf16 v70, s54, v129
    v_dot2c_f32_bf16 v71, s27, v129
    v_dot2c_f32_bf16 v72, s54, v130
    v_dot2c_f32_bf16 v73, s27, v130
    v_dot2c_f32_bf16 v74, s54, v131
    v_dot2c_f32_bf16 v75, s27, v131
    v_dot2c_f32_bf16 v68, s54, v132
    v_dot2c_f32_bf16 v69, s27, v132
    v_dot2c_f32_bf16 v70, s54, v133
    v_dot2c_f32_bf16 v71, s27, v133
    v_dot2c_f32_bf16 v72, s54, v134
    v_dot2c_f32_bf16 v73, s27, v134
    v_dot2c_f32_bf16 v74, s54, v135
    v_dot2c_f32_bf16 v75, s27, v135
    v_dot2c_f32_bf16 v68, s54, v136
    v_dot2c_f32_bf16 v69, s27, v136
    v_dot2c_f32_bf16 v70, s54, v137
    v_dot2c_f32_bf16 v71, s27, v137
    v_dot2c_f32_bf16 v72, s54, v138
    v_dot2c_f32_bf16 v73, s27, v138
    v_dot2c_f32_bf16 v74, s54, v139
    v_dot2c_f32_bf16 v75, s27, v139
    v_dot2c_f32_bf16 v68, s54, v140
    v_dot2c_f32_bf16 v69, s27, v140
    v_dot2c_f32_bf16 v70, s54, v141
    v_dot2c_f32_bf16 v71, s27, v141
    v_dot2c_f32_bf16 v72, s54, v142
    v_dot2c_f32_bf16 v73, s27, v142
    v_dot2c_f32_bf16 v74, s54, v143
    v_dot2c_f32_bf16 v75, s27, v143
    v_dot2c_f32_bf16 v68, s54, v144
    v_dot2c_f32_bf16 v69, s27, v144
    v_dot2c_f32_bf16 v70, s54, v145
    v_dot2c_f32_bf16 v71, s27, v145
    v_dot2c_f32_bf16 v72, s54, v146
    v_dot2c_f32_bf16 v73, s27, v146
    v_dot2c_f32_bf16 v74, s54, v147
    v_dot2c_f32_bf16 v75, s27, v147
    v_dot2c_f32_bf16 v68, s54, v148
    v_dot2c_f32_bf16 v69, s27, v148
    v_dot2c_f32_bf16 v70, s54, v149
    v_dot2c_f32_bf16 v71, s27, v149
    v_dot2c_f32_bf16 v72, s54, v150
    v_dot2c_f32_bf16 v73, s27, v150
    v_dot2c_f32_bf16 v74, s54, v151
    v_dot2c_f32_bf16 v75, s27, v151
    v_mul_f32 v68, v68, v220
    v_mul_f32 v69, v69, v220
    v_mul_f32 v70, v70, v220
    v_mul_f32 v71, v71, v220
    v_mul_f32 v72, v72, v221
    v_mul_f32 v73, v73, v221
    s_waitcnt vmcnt(7)
    s_waitcnt lgkmcnt(0)
    s_mov_b32 s5, 1
    s_add_u32 s6, s55, 12
    s_atomic_add s5, s[28:29], s6
    s_branch K3_join
K3_p2:
    s_load_dword s4, s[28:29], s53 glc
    v_dot2c_f32_bf16 v68, s54, v128
    v_dot2c_f32_bf16 v69, s27, v128
    v_dot2c_f32_bf16 v70, s54, v129
    v_dot2c_f32_bf16 v71, s27, v129
    v_dot2c_f32_bf16 v72, s54, v130
    v_dot2c_f32_bf16 v73, s27, v130
    v_dot2c_f32_bf16 v74, s54, v131
    v_dot2c_f32_bf16 v75, s27, v131
    v_dot2c_f32_bf16 v68, s54, v132
    v_dot2c_f32_bf16 v69, s27, v132
    v_dot2c_f32_bf16 v70, s54, v133
    v_dot2c_f32_bf16 v71, s27, v133
    v_dot2c_f32_bf16 v72, s54, v134
    v_dot2c_f32_bf16 v73, s27, v134
    v_dot2c_f32_bf16 v74, s54, v135
    v_dot2c_f32_bf16 v75, s27, v135
    v_dot2c_f32_bf16 v68, s54, v136
    v_dot2c_f32_bf16 v69, s27, v136
    v_dot2c_f32_bf16 v70, s54, v137
    v_dot2c_f32_bf16 v71, s27, v137
    v_dot2c_f32_bf16 v72, s54, v138
    v_dot2c_f32_bf16 v73, s27, v138
    v_dot2c_f32_bf16 v74, s54, v139
    v_dot2c_f32_bf16 v75, s27, v139
    v_dot2c_f32_bf16 v68, s54, v140
    v_dot2c_f32_bf16 v69, s27, v140
    v_dot2c_f32_bf16 v70, s54, v141
    v_dot2c_f32_bf16 v71, s27, v141
    v_dot2c_f32_bf16 v72, s54, v142
    v_dot2c_f32_bf16 v73, s27, v142
    v_dot2c_f32_bf16 v74, s54, v143
    v_dot2c_f32_bf16 v75, s27, v143
    v_dot2c_f32_bf16 v68, s54, v144
    v_dot2c_f32_bf16 v69, s27, v144
    v_dot2c_f32_bf16 v70, s54, v145
    v_dot2c_f32_bf16 v71, s27, v145
    v_dot2c_f32_bf16 v72, s54, v146
    v_dot2c_f32_bf16 v73, s27, v146
    v_dot2c_f32_bf16 v74, s54, v147
    v_dot2c_f32_bf16 v75, s27, v147
    v_dot2c_f32_bf16 v68, s54, v148
    v_dot2c_f32_bf16 v69, s27, v148
    v_dot2c_f32_bf16 v70, s54, v149
    v_dot2c_f32_bf16 v71, s27, v149
    v_dot2c_f32_bf16 v72, s54, v150
    v_dot2c_f32_bf16 v73, s27, v150
    v_dot2c_f32_bf16 v74, s54, v151
    v_dot2c_f32_bf16 v75, s27, v151
    v_mul_f32 v68, v68, v220
    v_mul_f32 v69, v69, v220
    v_mul_f32 v70, v70, v220
    v_mul_f32 v71, v71, v220
    v_mul_f32 v72, v72, v221
    v_mul_f32 v73, v73, v221
    s_waitcnt lgkmcnt(0)
    s_waitcnt vmcnt(0)
    s_waitcnt lgkmcnt(0)
    s_mov_b32 s5, 1
    s_add_u32 s6, s55, 12
    s_atomic_add s5, s[28:29], s6
    s_mov_b32 s58, 0
K3_sp_91:
    s_cmp_ge_u32 s4, 8
    s_cbranch_scc1 K3_ok_92
    s_add_u32 s58, s58, 1
    s_cmp_gt_u32 s58, 200000
    s_cbranch_scc1 K3_ok_92
    s_load_dword s4, s[28:29], s53 glc
    s_waitcnt lgkmcnt(0)
    s_branch K3_sp_91
K3_ok_92:
    s_lshl_b32 s65, s51, 13
    s_add_u32 s65, s65, s57
    s_add_u32 s64, s65, 18874368
    s_mul_i32 s6, s20, 2359296
    s_add_u32 s65, s65, s6
    s_add_u32 s6, s62, 1024
    v_add_u32 v248, s6, v240
    ds_read_b128 v[152:155], v248
    s_add_u32 s65, s65, 2359296
    s_cmp_ge_u32 s65, s64
    s_cselect_b32 s6, 18874368, 0
    s_sub_u32 s65, s65, s6
    buffer_load_dwordx4 v[156:159], v240, s[16:19], s65 offen sc1
    s_add_u32 s65, s65, 2359296
    s_cmp_ge_u32 s65, s64
    s_cselect_b32 s6, 18874368, 0
    s_sub_u32 s65, s65, s6
    buffer_load_dwordx4 v[160:163], v240, s[16:19], s65 offen sc1
    s_add_u32 s65, s65, 2359296
    s_cmp_ge_u32 s65, s64
    s_cselect_b32 s6, 18874368, 0
    s_sub_u32 s65, s65, s6
    buffer_load_dwordx4 v[164:167], v240, s[16:19], s65 offen sc1
    s_add_u32 s65, s65, 2359296
    s_cmp_ge_u32 s65, s64
    s_cselect_b32 s6, 18874368, 0
    s_sub_u32 s65, s65, s6
    buffer_load_dwordx4 v[168:171], v240, s[16:19], s65 offen sc1
    s_add_u32 s65, s65, 2359296
    s_cmp_ge_u32 s65, s64
    s_cselect_b32 s6, 18874368, 0
    s_sub_u32 s65, s65, s6
    buffer_load_dwordx4 v[172:175], v240, s[16:19], s65 offen sc1
    s_add_u32 s65, s65, 2359296
    s_cmp_ge_u32 s65, s64
    s_cselect_b32 s6, 18874368, 0
    s_sub_u32 s65, s65, s6
    buffer_load_dwordx4 v[176:179], v240, s[16:19], s65 offen sc1
    s_add_u32 s65, s65, 2359296
    s_cmp_ge_u32 s65, s64
    s_cselect_b32 s6, 18874368, 0
    s_sub_u32 s65, s65, s6
    buffer_load_dwordx4 v[180:183], v240, s[16:19], s65 offen sc1
K3_join:
    v_mul_f32 v74, v74, v221
    v_mul_f32 v75, v75, v221
    v_dot2c_f32_bf16 v68, s54, v224
    v_dot2c_f32_bf16 v69, s27, v224
    v_dot2c_f32_bf16 v70, s54, v225
    v_dot2c_f32_bf16 v71, s27, v225
    v_dot2c_f32_bf16 v72, s54, v226
    v_dot2c_f32_bf16 v73, s27, v226
    v_dot2c_f32_bf16 v74, s54, v227
    v_dot2c_f32_bf16 v75, s27, v227
    v_mul_f32 v76, 0xbfb8aa3b, v68
    v_mul_f32 v77, 0xbfb8aa3b, v69
    v_mul_f32 v78, 0xbfb8aa3b, v70
    v_mul_f32 v79, 0xbfb8aa3b, v71
    v_mul_f32 v80, 0xbfb8aa3b, v72
    v_mul_f32 v81, 0xbfb8aa3b, v73
    v_mul_f32 v82, 0xbfb8aa3b, v74
    v_mul_f32 v83, 0xbfb8aa3b, v75
    v_exp_f32 v76, v76
    v_exp_f32 v77, v77
    v_exp_f32 v78, v78
    v_exp_f32 v79, v79
    v_exp_f32 v80, v80
    v_exp_f32 v81, v81
    v_exp_f32 v82, v82
    v_exp_f32 v83, v83
    v_add_f32 v76, 1.0, v76
    v_add_f32 v77, 1.0, v77
    v_add_f32 v78, 1.0, v78
    v_add_f32 v79, 1.0, v79
    v_add_f32 v80, 1.0, v80
    v_add_f32 v81, 1.0, v81
    v_add_f32 v82, 1.0, v82
    v_add_f32 v83, 1.0, v83
    v_rcp_f32 v76, v76
    v_rcp_f32 v77, v77
    v_rcp_f32 v78, v78
    v_rcp_f32 v79, v79
    v_rcp_f32 v80, v80
    v_rcp_f32 v81, v81
    v_rcp_f32 v82, v82
    v_rcp_f32 v83, v83
    v_pk_mul_f32 v[68:69], v[68:69], v[76:77]
    v_pk_mul_f32 v[70:71], v[70:71], v[78:79]
    v_pk_mul_f32 v[72:73], v[72:73], v[80:81]
    v_pk_mul_f32 v[74:75], v[74:75], v[82:83]
    v_lshlrev_b32 v76, 16, v196
    v_and_b32 v77, 0xffff0000, v196
    v_lshlrev_b32 v78, 16, v197
    v_and_b32 v79, 0xffff0000, v197
    v_lshlrev_b32 v80, 16, v198
    v_and_b32 v81, 0xffff0000, v198
    v_lshlrev_b32 v82, 16, v199
    v_and_b32 v83, 0xffff0000, v199
    v_pk_mul_f32 v[68:69], v[68:69], v[76:77]
    v_pk_mul_f32 v[70:71], v[70:71], v[78:79]
    v_pk_mul_f32 v[72:73], v[72:73], v[80:81]
    v_pk_mul_f32 v[74:75], v[74:75], v[82:83]
    v_dot2c_f32_bf16 v68, s54, v184
    v_dot2c_f32_bf16 v69, s27, v184
    v_dot2c_f32_bf16 v70, s54, v185
    v_dot2c_f32_bf16 v71, s27, v185
    v_dot2c_f32_bf16 v72, s54, v186
    v_dot2c_f32_bf16 v73, s27, v186
    v_dot2c_f32_bf16 v74, s54, v187
    v_dot2c_f32_bf16 v75, s27, v187
    v_cvt_pk_bf16_f32 v24, v68, v69
    v_cvt_pk_bf16_f32 v25, v70, v71
    v_cvt_pk_bf16_f32 v26, v72, v73
    v_cvt_pk_bf16_f32 v27, v74, v75
    s_load_dword s4, s[28:29], s7 glc
    v_permlane16_swap_b32 v24, v26
    v_permlane16_swap_b32 v25, v27
    buffer_store_dwordx4 v[24:27], v204, s[8:11], 0 offen
    s_waitcnt lgkmcnt(0)
    s_cmp_ge_u32 s4, 8
    s_cbranch_scc0 K3_q2
    s_lshl_b32 s65, s52, 13
    s_add_u32 s65, s65, s57
    s_lshl_b32 s66, s23, 2
    s_add_u32 s65, s65, s66
    s_add_u32 s64, s65, 18874368
    s_mul_i32 s6, s20, 2359296
    s_add_u32 s65, s65, s6
    s_add_u32 s6, s63, 1024
    s_add_u32 s6, s6, s66
    v_add_u32 v248, s6, v240
    ds_read_b32 v4, v248
    s_add_u32 s65, s65, 2359296
    s_cmp_ge_u32 s65, s64
    s_cselect_b32 s6, 18874368, 0
    s_sub_u32 s65, s65, s6
    buffer_load_dword v5, v240, s[16:19], s65 offen sc1
    s_add_u32 s65, s65, 2359296
    s_cmp_ge_u32 s65, s64
    s_cselect_b32 s6, 18874368, 0
    s_sub_u32 s65, s65, s6
    buffer_load_dword v6, v240, s[16:19], s65 offen sc1
    s_add_u32 s65, s65, 2359296
    s_cmp_ge_u32 s65, s64
    s_cselect_b32 s6, 18874368, 0
    s_sub_u32 s65, s65, s6
    buffer_load_dword v7, v240, s[16:19], s65 offen sc1
    s_add_u32 s65, s65, 2359296
    s_cmp_ge_u32 s65, s64
    s_cselect_b32 s6, 18874368, 0
    s_sub_u32 s65, s65, s6
    buffer_load_dword v8, v240, s[16:19], s65 offen sc1
    s_add_u32 s65, s65, 2359296
    s_cmp_ge_u32 s65, s64
    s_cselect_b32 s6, 18874368, 0
    s_sub_u32 s65, s65, s6
    buffer_load_dword v9, v240, s[16:19], s65 offen sc1
    s_add_u32 s65, s65, 2359296
    s_cmp_ge_u32 s65, s64
    s_cselect_b32 s6, 18874368, 0
    s_sub_u32 s65, s65, s6
    buffer_load_dword v10, v240, s[16:19], s65 offen sc1
    s_add_u32 s65, s65, 2359296
    s_cmp_ge_u32 s65, s64
    s_cselect_b32 s6, 18874368, 0
    s_sub_u32 s65, s65, s6
    buffer_load_dword v11, v240, s[16:19], s65 offen sc1
    s_waitcnt vmcnt(14)
    s_waitcnt lgkmcnt(0)
    v_lshlrev_b32 v68, 16, v152
    v_and_b32 v69, 0xffff0000, v152
    v_lshlrev_b32 v70, 16, v153
    v_and_b32 v71, 0xffff0000, v153
    v_lshlrev_b32 v72, 16, v154
    v_and_b32 v73, 0xffff0000, v154
    v_lshlrev_b32 v74, 16, v155
    v_and_b32 v75, 0xffff0000, v155
    v_dot2c_f32_bf16 v68, s54, v156
    v_dot2c_f32_bf16 v69, s27, v156
    v_dot2c_f32_bf16 v70, s54, v157
    v_dot2c_f32_bf16 v71, s27, v157
    v_dot2c_f32_bf16 v72, s54, v158
    v_dot2c_f32_bf16 v73, s27, v158
    v_dot2c_f32_bf16 v74, s54, v159
    v_dot2c_f32_bf16 v75, s27, v159
    s_waitcnt vmcnt(13)
    v_dot2c_f32_bf16 v68, s54, v160
    v_dot2c_f32_bf16 v69, s27, v160
    v_dot2c_f32_bf16 v70, s54, v161
    v_dot2c_f32_bf16 v71, s27, v161
    v_dot2c_f32_bf16 v72, s54, v162
    v_dot2c_f32_bf16 v73, s27, v162
    v_dot2c_f32_bf16 v74, s54, v163
    v_dot2c_f32_bf16 v75, s27, v163
    s_waitcnt vmcnt(12)
    v_dot2c_f32_bf16 v68, s54, v164
    v_dot2c_f32_bf16 v69, s27, v164
    v_dot2c_f32_bf16 v70, s54, v165
    v_dot2c_f32_bf16 v71, s27, v165
    v_dot2c_f32_bf16 v72, s54, v166
    v_dot2c_f32_bf16 v73, s27, v166
    v_dot2c_f32_bf16 v74, s54, v167
    v_dot2c_f32_bf16 v75, s27, v167
    s_waitcnt vmcnt(11)
    v_dot2c_f32_bf16 v68, s54, v168
    v_dot2c_f32_bf16 v69, s27, v168
    v_dot2c_f32_bf16 v70, s54, v169
    v_dot2c_f32_bf16 v71, s27, v169
    v_dot2c_f32_bf16 v72, s54, v170
    v_dot2c_f32_bf16 v73, s27, v170
    v_dot2c_f32_bf16 v74, s54, v171
    v_dot2c_f32_bf16 v75, s27, v171
    s_waitcnt vmcnt(10)
    v_dot2c_f32_bf16 v68, s54, v172
    v_dot2c_f32_bf16 v69, s27, v172
    v_dot2c_f32_bf16 v70, s54, v173
    v_dot2c_f32_bf16 v71, s27, v173
    v_dot2c_f32_bf16 v72, s54, v174
    v_dot2c_f32_bf16 v73, s27, v174
    v_dot2c_f32_bf16 v74, s54, v175
    v_dot2c_f32_bf16 v75, s27, v175
    s_waitcnt vmcnt(9)
    v_dot2c_f32_bf16 v68, s54, v176
    v_dot2c_f32_bf16 v69, s27, v176
    v_dot2c_f32_bf16 v70, s54, v177
    v_dot2c_f32_bf16 v71, s27, v177
    v_dot2c_f32_bf16 v72, s54, v178
    v_dot2c_f32_bf16 v73, s27, v178
    v_dot2c_f32_bf16 v74, s54, v179
    v_dot2c_f32_bf16 v75, s27, v179
    s_waitcnt vmcnt(8)
    v_dot2c_f32_bf16 v68, s54, v180
    v_dot2c_f32_bf16 v69, s27, v180
    v_dot2c_f32_bf16 v70, s54, v181
    v_dot2c_f32_bf16 v71, s27, v181
    v_dot2c_f32_bf16 v72, s54, v182
    v_dot2c_f32_bf16 v73, s27, v182
    v_dot2c_f32_bf16 v74, s54, v183
    v_dot2c_f32_bf16 v75, s27, v183
    v_mul_f32 v68, v68, v220
    v_mul_f32 v69, v69, v220
    v_mul_f32 v70, v70, v220
    v_mul_f32 v71, v71, v220
    v_mul_f32 v72, v72, v221
    v_mul_f32 v73, v73, v221
    v_mul_f32 v74, v74, v221
    v_mul_f32 v75, v75, v221
    v_dot2c_f32_bf16 v68, s54, v228
    v_dot2c_f32_bf16 v69, s27, v228
    v_dot2c_f32_bf16 v70, s54, v229
    v_dot2c_f32_bf16 v71, s27, v229
    v_dot2c_f32_bf16 v72, s54, v230
    v_dot2c_f32_bf16 v73, s27, v230
    v_dot2c_f32_bf16 v74, s54, v231
    v_dot2c_f32_bf16 v75, s27, v231
    v_mul_f32 v76, 0xbfb8aa3b, v68
    v_mul_f32 v77, 0xbfb8aa3b, v69
    v_mul_f32 v78, 0xbfb8aa3b, v70
    v_mul_f32 v79, 0xbfb8aa3b, v71
    v_mul_f32 v80, 0xbfb8aa3b, v72
    v_mul_f32 v81, 0xbfb8aa3b, v73
    v_mul_f32 v82, 0xbfb8aa3b, v74
    v_mul_f32 v83, 0xbfb8aa3b, v75
    v_exp_f32 v76, v76
    v_exp_f32 v77, v77
    v_exp_f32 v78, v78
    v_exp_f32 v79, v79
    v_exp_f32 v80, v80
    v_exp_f32 v81, v81
    v_exp_f32 v82, v82
    v_exp_f32 v83, v83
    v_add_f32 v76, 1.0, v76
    v_add_f32 v77, 1.0, v77
    v_add_f32 v78, 1.0, v78
    v_add_f32 v79, 1.0, v79
    v_add_f32 v80, 1.0, v80
    v_add_f32 v81, 1.0, v81
    v_add_f32 v82, 1.0, v82
    v_add_f32 v83, 1.0, v83
    v_rcp_f32 v76, v76
    v_rcp_f32 v77, v77
    v_rcp_f32 v78, v78
    v_rcp_f32 v79, v79
    v_rcp_f32 v80, v80
    v_rcp_f32 v81, v81
    v_rcp_f32 v82, v82
    v_rcp_f32 v83, v83
    v_pk_mul_f32 v[68:69], v[68:69], v[76:77]
    v_pk_mul_f32 v[70:71], v[70:71], v[78:79]
    v_pk_mul_f32 v[72:73], v[72:73], v[80:81]
    v_pk_mul_f32 v[74:75], v[74:75], v[82:83]
    v_lshlrev_b32 v76, 16, v200
    v_and_b32 v77, 0xffff0000, v200
    v_lshlrev_b32 v78, 16, v201
    v_and_b32 v79, 0xffff0000, v201
    v_lshlrev_b32 v80, 16, v202
    v_and_b32 v81, 0xffff0000, v202
    v_lshlrev_b32 v82, 16, v203
    v_and_b32 v83, 0xffff0000, v203
    v_pk_mul_f32 v[68:69], v[68:69], v[76:77]
    v_pk_mul_f32 v[70:71], v[70:71], v[78:79]
    v_pk_mul_f32 v[72:73], v[72:73], v[80:81]
    v_pk_mul_f32 v[74:75], v[74:75], v[82:83]
    v_dot2c_f32_bf16 v68, s54, v188
    v_dot2c_f32_bf16 v69, s27, v188
    v_dot2c_f32_bf16 v70, s54, v189
    v_dot2c_f32_bf16 v71, s27, v189
    v_dot2c_f32_bf16 v72, s54, v190
    v_dot2c_f32_bf16 v73, s27, v190
    v_dot2c_f32_bf16 v74, s54, v191
    v_dot2c_f32_bf16 v75, s27, v191
    v_cvt_pk_bf16_f32 v28, v68, v69
    v_cvt_pk_bf16_f32 v29, v70, v71
    v_cvt_pk_bf16_f32 v30, v72, v73
    v_cvt_pk_bf16_f32 v31, v74, v75
    s_branch K3_join2
K3_q2:
    s_load_dword s4, s[28:29], s7 glc
    s_waitcnt vmcnt(7)
    s_waitcnt lgkmcnt(0)
    v_lshlrev_b32 v68, 16, v152
    v_and_b32 v69, 0xffff0000, v152
    v_lshlrev_b32 v70, 16, v153
    v_and_b32 v71, 0xffff0000, v153
    v_lshlrev_b32 v72, 16, v154
    v_and_b32 v73, 0xffff0000, v154
    v_lshlrev_b32 v74, 16, v155
    v_and_b32 v75, 0xffff0000, v155
    v_dot2c_f32_bf16 v68, s54, v156
    v_dot2c_f32_bf16 v69, s27, v156
    v_dot2c_f32_bf16 v70, s54, v157
    v_dot2c_f32_bf16 v71, s27, v157
    v_dot2c_f32_bf16 v72, s54, v158
    v_dot2c_f32_bf16 v73, s27, v158
    v_dot2c_f32_bf16 v74, s54, v159
    v_dot2c_f32_bf16 v75, s27, v159
    s_waitcnt vmcnt(6)
    v_dot2c_f32_bf16 v68, s54, v160
    v_dot2c_f32_bf16 v69, s27, v160
    v_dot2c_f32_bf16 v70, s54, v161
    v_dot2c_f32_bf16 v71, s27, v161
    v_dot2c_f32_bf16 v72, s54, v162
    v_dot2c_f32_bf16 v73, s27, v162
    v_dot2c_f32_bf16 v74, s54, v163
    v_dot2c_f32_bf16 v75, s27, v163
    s_waitcnt vmcnt(5)
    v_dot2c_f32_bf16 v68, s54, v164
    v_dot2c_f32_bf16 v69, s27, v164
    v_dot2c_f32_bf16 v70, s54, v165
    v_dot2c_f32_bf16 v71, s27, v165
    v_dot2c_f32_bf16 v72, s54, v166
    v_dot2c_f32_bf16 v73, s27, v166
    v_dot2c_f32_bf16 v74, s54, v167
    v_dot2c_f32_bf16 v75, s27, v167
    s_waitcnt vmcnt(4)
    v_dot2c_f32_bf16 v68, s54, v168
    v_dot2c_f32_bf16 v69, s27, v168
    v_dot2c_f32_bf16 v70, s54, v169
    v_dot2c_f32_bf16 v71, s27, v169
    v_dot2c_f32_bf16 v72, s54, v170
    v_dot2c_f32_bf16 v73, s27, v170
    v_dot2c_f32_bf16 v74, s54, v171
    v_dot2c_f32_bf16 v75, s27, v171
    s_waitcnt vmcnt(3)
    v_dot2c_f32_bf16 v68, s54, v172
    v_dot2c_f32_bf16 v69, s27, v172
    v_dot2c_f32_bf16 v70, s54, v173
    v_dot2c_f32_bf16 v71, s27, v173
    v_dot2c_f32_bf16 v72, s54, v174
    v_dot2c_f32_bf16 v73, s27, v174
    v_dot2c_f32_bf16 v74, s54, v175
    v_dot2c_f32_bf16 v75, s27, v175
    s_waitcnt vmcnt(2)
    v_dot2c_f32_bf16 v68, s54, v176
    v_dot2c_f32_bf16 v69, s27, v176
    v_dot2c_f32_bf16 v70, s54, v177
    v_dot2c_f32_bf16 v71, s27, v177
    v_dot2c_f32_bf16 v72, s54, v178
    v_dot2c_f32_bf16 v73, s27, v178
    v_dot2c_f32_bf16 v74, s54, v179
    v_dot2c_f32_bf16 v75, s27, v179
    s_waitcnt vmcnt(1)
    v_dot2c_f32_bf16 v68, s54, v180
    v_dot2c_f32_bf16 v69, s27, v180
    v_dot2c_f32_bf16 v70, s54, v181
    v_dot2c_f32_bf16 v71, s27, v181
    v_dot2c_f32_bf16 v72, s54, v182
    v_dot2c_f32_bf16 v73, s27, v182
    v_dot2c_f32_bf16 v74, s54, v183
    v_dot2c_f32_bf16 v75, s27, v183
    v_mul_f32 v68, v68, v220
    v_mul_f32 v69, v69, v220
    v_mul_f32 v70, v70, v220
    v_mul_f32 v71, v71, v220
    v_mul_f32 v72, v72, v221
    v_mul_f32 v73, v73, v221
    v_mul_f32 v74, v74, v221
    v_mul_f32 v75, v75, v221
    v_dot2c_f32_bf16 v68, s54, v228
    v_dot2c_f32_bf16 v69, s27, v228
    v_dot2c_f32_bf16 v70, s54, v229
    v_dot2c_f32_bf16 v71, s27, v229
    v_dot2c_f32_bf16 v72, s54, v230
    v_dot2c_f32_bf16 v73, s27, v230
    v_dot2c_f32_bf16 v74, s54, v231
    v_dot2c_f32_bf16 v75, s27, v231
    v_mul_f32 v76, 0xbfb8aa3b, v68
    v_mul_f32 v77, 0xbfb8aa3b, v69
    v_mul_f32 v78, 0xbfb8aa3b, v70
    v_mul_f32 v79, 0xbfb8aa3b, v71
    v_mul_f32 v80, 0xbfb8aa3b, v72
    v_mul_f32 v81, 0xbfb8aa3b, v73
    v_mul_f32 v82, 0xbfb8aa3b, v74
    v_mul_f32 v83, 0xbfb8aa3b, v75
    v_exp_f32 v76, v76
    v_exp_f32 v77, v77
    v_exp_f32 v78, v78
    v_exp_f32 v79, v79
    v_exp_f32 v80, v80
    v_exp_f32 v81, v81
    v_exp_f32 v82, v82
    v_exp_f32 v83, v83
    v_add_f32 v76, 1.0, v76
    v_add_f32 v77, 1.0, v77
    v_add_f32 v78, 1.0, v78
    v_add_f32 v79, 1.0, v79
    v_add_f32 v80, 1.0, v80
    v_add_f32 v81, 1.0, v81
    v_add_f32 v82, 1.0, v82
    v_add_f32 v83, 1.0, v83
    v_rcp_f32 v76, v76
    v_rcp_f32 v77, v77
    v_rcp_f32 v78, v78
    v_rcp_f32 v79, v79
    v_rcp_f32 v80, v80
    v_rcp_f32 v81, v81
    v_rcp_f32 v82, v82
    v_rcp_f32 v83, v83
    v_pk_mul_f32 v[68:69], v[68:69], v[76:77]
    v_pk_mul_f32 v[70:71], v[70:71], v[78:79]
    v_pk_mul_f32 v[72:73], v[72:73], v[80:81]
    v_pk_mul_f32 v[74:75], v[74:75], v[82:83]
    v_lshlrev_b32 v76, 16, v200
    v_and_b32 v77, 0xffff0000, v200
    v_lshlrev_b32 v78, 16, v201
    v_and_b32 v79, 0xffff0000, v201
    v_lshlrev_b32 v80, 16, v202
    v_and_b32 v81, 0xffff0000, v202
    v_lshlrev_b32 v82, 16, v203
    v_and_b32 v83, 0xffff0000, v203
    v_pk_mul_f32 v[68:69], v[68:69], v[76:77]
    v_pk_mul_f32 v[70:71], v[70:71], v[78:79]
    v_pk_mul_f32 v[72:73], v[72:73], v[80:81]
    v_pk_mul_f32 v[74:75], v[74:75], v[82:83]
    v_dot2c_f32_bf16 v68, s54, v188
    v_dot2c_f32_bf16 v69, s27, v188
    v_dot2c_f32_bf16 v70, s54, v189
    v_dot2c_f32_bf16 v71, s27, v189
    v_dot2c_f32_bf16 v72, s54, v190
    v_dot2c_f32_bf16 v73, s27, v190
    v_dot2c_f32_bf16 v74, s54, v191
    v_dot2c_f32_bf16 v75, s27, v191
    v_cvt_pk_bf16_f32 v28, v68, v69
    v_cvt_pk_bf16_f32 v29, v70, v71
    v_cvt_pk_bf16_f32 v30, v72, v73
    v_cvt_pk_bf16_f32 v31, v74, v75
    s_waitcnt lgkmcnt(0)
    s_mov_b32 s58, 0
K3_sp_93:
    s_cmp_ge_u32 s4, 8
    s_cbranch_scc1 K3_ok_94
    s_add_u32 s58, s58, 1
    s_cmp_gt_u32 s58, 200000
    s_cbranch_scc1 K3_ok_94
    s_load_dword s4, s[28:29], s7 glc
    s_waitcnt lgkmcnt(0)
    s_branch K3_sp_93
K3_ok_94:
    s_lshl_b32 s65, s52, 13
    s_add_u32 s65, s65, s57
    s_lshl_b32 s66, s23, 2
    s_add_u32 s65, s65, s66
    s_add_u32 s64, s65, 18874368
    s_mul_i32 s6, s20, 2359296
    s_add_u32 s65, s65, s6
    s_add_u32 s6, s63, 1024
    s_add_u32 s6, s6, s66
    v_add_u32 v248, s6, v240
    ds_read_b32 v4, v248
    s_add_u32 s65, s65, 2359296
    s_cmp_ge_u32 s65, s64
    s_cselect_b32 s6, 18874368, 0
    s_sub_u32 s65, s65, s6
    buffer_load_dword v5, v240, s[16:19], s65 offen sc1
    s_add_u32 s65, s65, 2359296
    s_cmp_ge_u32 s65, s64
    s_cselect_b32 s6, 18874368, 0
    s_sub_u32 s65, s65, s6
    buffer_load_dword v6, v240, s[16:19], s65 offen sc1
    s_add_u32 s65, s65, 2359296
    s_cmp_ge_u32 s65, s64
    s_cselect_b32 s6, 18874368, 0
    s_sub_u32 s65, s65, s6
    buffer_load_dword v7, v240, s[16:19], s65 offen sc1
    s_add_u32 s65, s65, 2359296
    s_cmp_ge_u32 s65, s64
    s_cselect_b32 s6, 18874368, 0
    s_sub_u32 s65, s65, s6
    buffer_load_dword v8, v240, s[16:19], s65 offen sc1
    s_add_u32 s65, s65, 2359296
    s_cmp_ge_u32 s65, s64
    s_cselect_b32 s6, 18874368, 0
    s_sub_u32 s65, s65, s6
    buffer_load_dword v9, v240, s[16:19], s65 offen sc1
    s_add_u32 s65, s65, 2359296
    s_cmp_ge_u32 s65, s64
    s_cselect_b32 s6, 18874368, 0
    s_sub_u32 s65, s65, s6
    buffer_load_dword v10, v240, s[16:19], s65 offen sc1
    s_add_u32 s65, s65, 2359296
    s_cmp_ge_u32 s65, s64
    s_cselect_b32 s6, 18874368, 0
    s_sub_u32 s65, s65, s6
    buffer_load_dword v11, v240, s[16:19], s65 offen sc1
K3_join2:
    s_nop 1
    v_permlane16_swap_b32 v28, v30
    v_permlane16_swap_b32 v29, v31
    buffer_store_dwordx4 v[28:31], v205, s[8:11], 0 offen
    s_waitcnt vmcnt(7)
    s_waitcnt lgkmcnt(0)
    v_lshlrev_b32 v68, 16, v4
    v_and_b32 v69, 0xffff0000, v4
    v_dot2c_f32_bf16 v68, s54, v5
    v_dot2c_f32_bf16 v69, s27, v5
    s_waitcnt vmcnt(6)
    v_dot2c_f32_bf16 v68, s54, v6
    v_dot2c_f32_bf16 v69, s27, v6
    s_waitcnt vmcnt(5)
    v_dot2c_f32_bf16 v68, s54, v7
    v_dot2c_f32_bf16 v69, s27, v7
    s_waitcnt vmcnt(4)
    v_dot2c_f32_bf16 v68, s54, v8
    v_dot2c_f32_bf16 v69, s27, v8
    s_waitcnt vmcnt(3)
    v_dot2c_f32_bf16 v68, s54, v9
    v_dot2c_f32_bf16 v69, s27, v9
    s_waitcnt vmcnt(2)
    v_dot2c_f32_bf16 v68, s54, v10
    v_dot2c_f32_bf16 v69, s27, v10
    s_waitcnt vmcnt(1)
    v_dot2c_f32_bf16 v68, s54, v11
    v_dot2c_f32_bf16 v69, s27, v11
    s_nop 1
    v_mul_f32 v68, v68, v222
    v_mul_f32 v69, v69, v222
    v_dot2c_f32_bf16 v68, s54, v232
    v_dot2c_f32_bf16 v69, s27, v232
    s_nop 1
    v_mul_f32 v76, 0xbfb8aa3b, v68
    v_mul_f32 v77, 0xbfb8aa3b, v69
    v_exp_f32 v76, v76
    v_exp_f32 v77, v77
    v_add_f32 v76, 1.0, v76
    v_add_f32 v77, 1.0, v77
    v_rcp_f32 v76, v76
    v_rcp_f32 v77, v77
    s_nop 0
    v_pk_mul_f32 v[68:69], v[68:69], v[76:77]
    v_lshlrev_b32 v76, 16, v194
    v_and_b32 v77, 0xffff0000, v194
    v_pk_mul_f32 v[68:69], v[68:69], v[76:77]
    v_dot2c_f32_bf16 v68, s54, v192
    v_dot2c_f32_bf16 v69, s27, v192
    s_nop 2
    v_cvt_pk_bf16_f32 v32, v68, v69
    buffer_store_dword v32, v206, s[8:11], 0 offen
K_end:
    s_endpgm
    .fill 64, 4, 0xbf800000
KEND:

.section .rodata,"a"
.p2align 6
.amdhsa_kernel recurrent_scan__ssm_conv_h3__mixer_s_mlp__prompt_kernel
  .amdhsa_next_free_vgpr 512
  .amdhsa_next_free_sgpr 102
  .amdhsa_accum_offset 256
  .amdhsa_group_segment_fixed_size 0
  .amdhsa_kernarg_size 112
  .amdhsa_user_sgpr_count 2
  .amdhsa_user_sgpr_kernarg_segment_ptr 1
  .amdhsa_system_sgpr_workgroup_id_x 1
.end_amdhsa_kernel
```
